```python
import torch

def _softmax(x, axis=-1):
    return torch.softmax(x, dim=axis)
def _gelu(x):
    return torch.nn.functional.gelu(x, approximate="tanh")
def _silu(x):
    return torch.nn.functional.silu(x)
def _sigmoid(x):
    return torch.sigmoid(x)
def _layernorm(x, axis=-1, eps=1e-5):
    m = x.mean(dim=axis, keepdim=True)
    v = x.var(dim=axis, keepdim=True, unbiased=False)
    return (x - m) / torch.sqrt(v + eps)
def _scatter_add(tgt, idx, src, axis=0):
    return tgt.clone().index_add_(axis, idx, src)
def _segment_sum(src, seg, n):
    out = torch.zeros((n,) + src.shape[1:], dtype=src.dtype)
    return out.index_add_(0, seg, src)
def _pad(x, pw):
    flat = tuple(v for pair in reversed(pw) for v in pair)
    return torch.nn.functional.pad(x, flat)

kernel_name = 'standalone__mha_block_cached__near_ridge'

def setup_inputs():

    _w = (lambda a: (lambda t: t.to(torch.bfloat16) if t.is_floating_point() else t)(torch.as_tensor(a)))
    B, Sq, D = 8, 160, 640
    H, Sk, Dh = 32, 512, 192
    return {
        "x": _w((lambda *s: torch.randn(*s, dtype=torch.bfloat16) * 0.8)(B, Sq, D)),
        "k_cache": _w((lambda *s: torch.randn(*s, dtype=torch.bfloat16) * 0.8)(B, H, Sk, Dh)),
        "v_cache": _w((lambda *s: torch.randn(*s, dtype=torch.bfloat16) * 0.05)(B, H, Sk, Dh)),
        "wq": _w((lambda *s: torch.randn(*s, dtype=torch.bfloat16) * 0.8)(D, H * Dh) * (D ** -0.5)),
        "wo": _w((lambda *s: torch.randn(*s, dtype=torch.bfloat16) * 0.05)(H * Dh, D) * ((H * Dh) ** -0.5)),
    }

def reference(x, k_cache, v_cache, wq, wo):
    B, Sq, D = x.shape
    H, Dh = 32, 192
    q = (lambda x, *d: x.permute(*d))((x @ wq).reshape(B, Sq, H, Dh), 0, 2, 1, 3)
    scores = torch.einsum("bhqd,bhkd->bhqk", q, k_cache) * (Dh ** -0.5)
    p = _softmax(scores, axis=-1)
    o = torch.einsum("bhqk,bhkd->bhqd", p, v_cache)
    return (lambda x, *d: x.permute(*d))(o, 0, 2, 1, 3).reshape(B, Sq, H * Dh) @ wo
```

```asm
; @launch grid=(256,1,1) block=(256,1,1) lds=163840
.amdgcn_target "amdgcn-amd-amdhsa--gfx950"
.text
.globl standalone__mha_block_cached__near_ridge_kernel
.p2align 8
.type standalone__mha_block_cached__near_ridge_kernel,@function
standalone__mha_block_cached__near_ridge_kernel:
    s_cmp_ge_u32 s2, 256
    s_cbranch_scc1 K_END
    s_load_dwordx16 s[64:79], s[0:1], 0
    v_lshrrev_b32 v1, 6, v0
    v_and_b32 v0, 63, v0
    v_readfirstlane_b32 s28, v1
    s_and_b32 s33, s2, 7
    s_lshr_b32 s3, s2, 3
    s_lshr_b32 s31, s3, 2
    s_and_b32 s3, s3, 3
    s_lshl_b32 s33, s33, 2
    s_add_u32 s32, s33, s3
    s_getpc_b64 s[90:91]
CODE_REF:
    v_and_b32 v110, 15, v0
    s_lshr_b32 s92, s2, 3
    s_and_b32 s92, s92, 31
    s_lshl_b32 s92, s92, 4
    v_add_u32 v110, s92, v110
    v_lshlrev_b32 v110, 7, v110
    v_min_u32 v110, CODE_END-CODE_REF-4, v110
    v_and_b32 v110, 0xfffffffc, v110
    v_mov_b32 v113, s91
    v_add_co_u32 v112, vcc, s90, v110
    s_nop 1
    v_addc_co_u32 v113, vcc, 0, v113, vcc
    global_load_dword v111, v[112:113], off
    s_and_b32 s29, s28, 1
    s_lshr_b32 s30, s28, 1
    s_mul_i32 s34, s28, 5120
    s_mul_i32 s35, s28, 6144
    s_add_u32 s35, s35, 20480
    s_mul_i32 s36, s28, 3072
    s_lshl_b32 s37, s28, 12
    v_lshrrev_b32 v59, 3, v0
    v_mul_u32_u24 v59, 1280, v59
    v_lshrrev_b32 v60, 4, v0
    v_and_b32 v61, 7, v0
    v_xor_b32 v60, v60, v61
    v_lshl_add_u32 v59, v60, 4, v59
    v_xor_b32 v61, 64, v59
    s_mul_i32 s3, s28, 51200
    s_bitcmp1_b32 s28, 0
    s_cselect_b64 vcc, -1, 0
    v_cndmask_b32 v62, v59, v61, vcc
    v_cndmask_b32 v63, v61, v59, vcc
    v_add_u32 v62, s3, v62
    v_add_u32 v63, s3, v63
    v_mov_b32 v24, v62
    v_add_u32 v25, 9216, v63
    v_add_u32 v26, 18432, v62
    v_add_u32 v27, 27648, v63
    v_add_u32 v28, 40960, v62
    s_mul_i32 s3, s28, 196608
    v_mov_b32 v62, v0
    v_mul_u32_u24 v65, 2731, v62
    v_lshrrev_b32 v65, 16, v65
    v_mul_u32_u24 v59, 24, v65
    v_sub_u32 v68, v62, v59
    v_and_b32 v59, 2, v65
    v_lshrrev_b32 v60, 1, v65
    v_and_or_b32 v59, v60, 4, v59
    v_xor_b32 v59, v59, v68
    v_mul_u32_u24 v60, 12288, v65
    v_lshl_add_u32 v59, v59, 4, v60
    v_add_u32 v59, s3, v59
    v_xor_b32 v32, 64, v59
    v_add_u32 v32, 95232, v32
    v_mov_b32 v29, v59
    v_add_u32 v63, 64, v0
    v_mul_u32_u24 v66, 2731, v63
    v_lshrrev_b32 v66, 16, v66
    v_mul_u32_u24 v59, 24, v66
    v_sub_u32 v69, v63, v59
    v_and_b32 v59, 2, v66
    v_lshrrev_b32 v60, 1, v66
    v_and_or_b32 v59, v60, 4, v59
    v_xor_b32 v59, v59, v69
    v_mul_u32_u24 v60, 12288, v66
    v_lshl_add_u32 v59, v59, 4, v60
    v_add_u32 v59, s3, v59
    v_xor_b32 v33, 64, v59
    v_add_u32 v33, 98304, v33
    v_subrev_u32 v30, 1024, v59
    v_add_u32 v64, 128, v0
    v_mul_u32_u24 v67, 2731, v64
    v_lshrrev_b32 v67, 16, v67
    v_mul_u32_u24 v59, 24, v67
    v_sub_u32 v70, v64, v59
    v_and_b32 v59, 2, v67
    v_lshrrev_b32 v60, 1, v67
    v_and_or_b32 v59, v60, 4, v59
    v_xor_b32 v59, v59, v70
    v_mul_u32_u24 v60, 12288, v67
    v_lshl_add_u32 v59, v59, 4, v60
    v_add_u32 v59, s3, v59
    v_xor_b32 v34, 64, v59
    v_add_u32 v34, 97280, v34
    v_subrev_u32 v31, 2048, v59
    v_mov_b32 v71, 0x40000000
    s_lshl_b32 s33, s2, 7
    v_mov_b32 v59, s33
    v_cmp_eq_u32 vcc, 0, v0
    s_cmp_eq_u32 s28, 0
    s_cselect_b64 s[80:81], -1, 0
    s_nop 1
    s_and_b64 vcc, vcc, s[80:81]
    v_cndmask_b32 v71, v71, v59, vcc
    v_mov_b32 v60, 0
    s_waitcnt lgkmcnt(0)
    s_mov_b32 s0, 0
    s_add_u32 s4, s78, 50331648
    s_addc_u32 s5, s79, 0
    s_and_b32 s5, s5, 0xffff
    s_mov_b32 s6, 32768
    s_mov_b32 s7, 0x00020000
    buffer_store_dword v60, v71, s[4:7], 0 offen sc1
    s_mul_i32 s33, s31, 204800
    s_add_u32 s8, s64, s33
    s_addc_u32 s9, s65, 0
    s_and_b32 s9, s9, 0xffff
    s_mov_b32 s10, 204800
    s_mov_b32 s11, 0x00020000
    s_mul_i32 s33, s32, 384
    s_add_u32 s12, s70, s33
    s_addc_u32 s13, s71, 0
    s_and_b32 s13, s13, 0xffff
    s_mov_b32 s14, 7852416
    s_mov_b32 s15, 0x00020000
    s_and_b32 s33, s32, 3
    s_mul_i32 s33, s33, 51200
    v_mul_u32_u24 v107, 1280, v0
    v_add_u32 v107, s33, v107
    v_subrev_u32 v108, 40, v0
    v_mul_u32_u24 v109, 86, v108
    v_lshrrev_b32 v109, 8, v109
    v_mul_u32_u24 v102, 3, v109
    v_sub_u32 v108, v108, v102
    s_lshl_b32 s33, s31, 3
    v_add_u32 v109, s33, v109
    v_mul_u32_u24 v109, 12288, v109
    v_lshl_add_u32 v108, v108, 7, v109
    v_cmp_gt_u32 vcc, 40, v0
    s_nop 1
    v_cndmask_b32 v107, v108, v107, vcc
    v_mov_b32 v108, s8
    v_mov_b32 v109, s12
    v_cndmask_b32 v100, v109, v108, vcc
    v_mov_b32 v108, s9
    v_mov_b32 v109, s13
    v_cndmask_b32 v101, v109, v108, vcc
    v_mov_b32 v108, 128
    v_mov_b32 v109, 786432
    v_cndmask_b32 v102, v109, v108, vcc
    v_mul_lo_u32 v108, v102, s28
    v_add_u32 v107, v107, v108
    v_add_co_u32 v100, vcc, v100, v107
    s_nop 1
    v_addc_co_u32 v101, vcc, 0, v101, vcc
    v_lshlrev_b32 v102, 2, v102
    global_load_dword v104, v[100:101], off
    s_mov_b32 s38, 0
    s_add_u32 m0, s34, 90112
    s_nop 0
    buffer_load_dwordx4 v24, s[8:11], s38 offen lds
    buffer_load_dwordx4 v25, s[8:11], s38 offen offset:1024 lds
    buffer_load_dwordx4 v26, s[8:11], s38 offen offset:2048 lds
    buffer_load_dwordx4 v27, s[8:11], s38 offen offset:3072 lds
    s_add_u32 m0, s34, 94208
    s_nop 0
    buffer_load_dwordx4 v28, s[8:11], s38 offen lds
    s_mov_b32 s39, 0
    s_add_u32 m0, s35, 90112
    s_nop 0
    buffer_load_dwordx4 v29, s[12:15], s39 offen lds
    buffer_load_dwordx4 v30, s[12:15], s39 offen offset:1024 lds
    buffer_load_dwordx4 v31, s[12:15], s39 offen offset:2048 lds
    buffer_load_dwordx4 v32, s[12:15], s39 offen offset:3072 lds
    s_add_u32 m0, s35, 94208
    s_nop 0
    buffer_load_dwordx4 v33, s[12:15], s39 offen lds
    buffer_load_dwordx4 v34, s[12:15], s39 offen offset:1024 lds
    s_lshl_b32 s33, s31, 5
    s_add_u32 s33, s33, s32
    s_mul_i32 s43, s33, 61440
    s_mul_i32 s33, s33, 196608
    s_add_u32 s16, s66, s33
    s_addc_u32 s17, s67, 0
    s_and_b32 s17, s17, 0xffff
    s_mov_b32 s18, 196608
    s_mov_b32 s19, 0x00020000
    s_add_u32 s20, s68, s33
    s_addc_u32 s21, s69, 0
    s_and_b32 s21, s21, 0xffff
    s_mov_b32 s22, 196608
    s_mov_b32 s23, 0x00020000
    s_add_u32 s24, s78, s43
    s_addc_u32 s25, s79, 0
    s_and_b32 s25, s25, 0xffff
    s_mov_b32 s26, 61440
    s_mov_b32 s27, 0x00020000
    s_lshr_b32 s3, s32, 2
    s_and_b32 s43, s32, 3
    s_mul_i32 s33, s3, 983040
    s_mul_i32 s42, s43, 320
    s_add_u32 s33, s33, s42
    s_add_u32 s44, s72, s33
    s_addc_u32 s45, s73, 0
    s_and_b32 s45, s45, 0xffff
    s_mov_b32 s46, 982080
    s_mov_b32 s47, 0x00020000
    s_lshl_b32 s33, s31, 5
    s_lshl_b32 s42, s3, 2
    s_add_u32 s33, s33, s42
    s_mul_i32 s33, s33, 61440
    s_add_u32 s48, s78, s33
    s_addc_u32 s49, s79, 0
    s_and_b32 s49, s49, 0xffff
    s_mov_b32 s50, 245760
    s_mov_b32 s51, 0x00020000
    s_lshl_b32 s33, s31, 2
    s_add_u32 s33, s33, s43
    s_mul_i32 s33, s33, 409600
    s_add_u32 s33, s33, 16777216
    s_add_u32 s52, s78, s33
    s_addc_u32 s53, s79, 0
    s_and_b32 s53, s53, 0xffff
    s_mov_b32 s54, 409600
    s_mov_b32 s55, 0x00020000
    s_mov_b32 s56, s74
    s_and_b32 s57, s75, 0xffff
    s_mov_b32 s58, 1638400
    s_mov_b32 s59, 0x00020000
    s_mov_b32 s60, s76
    s_and_b32 s61, s77, 0xffff
    s_mov_b32 s62, 256
    s_mov_b32 s63, 0x00020000
    s_mov_b32 s72, s3
    s_mov_b32 s73, s43
    s_add_u32 s33, s73, 0
    s_and_b32 s33, s33, 3
    s_mul_i32 s64, s33, 245760
    s_mul_i32 s68, s33, 61440
    s_add_u32 s33, s73, 1
    s_and_b32 s33, s33, 3
    s_mul_i32 s65, s33, 245760
    s_mul_i32 s69, s33, 61440
    s_add_u32 s33, s73, 2
    s_and_b32 s33, s33, 3
    s_mul_i32 s66, s33, 245760
    s_mul_i32 s70, s33, 61440
    s_add_u32 s33, s73, 3
    s_and_b32 s33, s33, 3
    s_mul_i32 s67, s33, 245760
    s_mul_i32 s71, s33, 61440
    s_mul_i32 s75, s28, 5120
    s_add_u32 s76, s75, 20480
    s_and_b32 s33, s28, 1
    s_lshl_b32 s33, s33, 2
    s_mul_i32 s3, s28, 3072
    v_bfe_u32 v59, v65, 1, 2
    v_or_b32 v59, s33, v59
    v_xor_b32 v59, v59, v68
    v_mul_u32_u24 v60, 384, v65
    v_lshl_add_u32 v59, v59, 4, v60
    v_add_u32 v59, s3, v59
    v_mov_b32 v2, v59
    v_bfe_u32 v59, v66, 1, 2
    v_or_b32 v59, s33, v59
    v_xor_b32 v59, v59, v69
    v_mul_u32_u24 v60, 384, v66
    v_lshl_add_u32 v59, v59, 4, v60
    v_add_u32 v59, s3, v59
    v_subrev_u32 v3, 1024, v59
    v_bfe_u32 v59, v67, 1, 2
    v_or_b32 v59, s33, v59
    v_xor_b32 v59, v59, v70
    v_mul_u32_u24 v60, 384, v67
    v_lshl_add_u32 v59, v59, 4, v60
    v_add_u32 v59, s3, v59
    v_subrev_u32 v4, 2048, v59
    v_lshrrev_b32 v59, 3, v0
    v_mul_u32_u24 v59, 384, v59
    v_lshrrev_b32 v60, 4, v0
    v_lshlrev_b32 v60, 1, v60
    v_and_b32 v61, 7, v0
    v_xor_b32 v60, v60, v61
    v_lshl_add_u32 v59, v60, 4, v59
    s_mul_i32 s3, s28, 12288
    v_add_u32 v5, s3, v59
    v_and_b32 v62, 15, v0
    v_lshrrev_b32 v63, 4, v0
    v_bfe_u32 v64, v0, 2, 2
    v_and_b32 v65, 3, v0
    v_lshrrev_b32 v66, 1, v62
    s_mul_i32 s33, s29, 80
    v_add_u32 v67, s33, v62
    v_xor_b32 v59, v63, v66
    v_lshlrev_b32 v60, 7, v67
    v_lshl_add_u32 v35, v59, 4, v60
    v_xor_b32 v36, 64, v35
    v_mul_u32_u24 v60, 384, v67
    v_add_u32 v68, 73728, v60
    v_lshl_add_u32 v57, v59, 4, v68
    v_xor_b32 v58, 64, v57
    v_and_b32 v59, 1, v63
    v_lshl_add_u32 v68, v59, 3, v68
    v_lshrrev_b32 v69, 1, v63
    s_mul_i32 s33, s30, 12
    s_add_u32 s33, s33, 0
    v_add_u32 v59, s33, v69
    v_xor_b32 v59, v59, v66
    v_lshl_add_u32 v51, v59, 4, v68
    s_mul_i32 s33, s30, 12
    s_add_u32 s33, s33, 2
    v_add_u32 v59, s33, v69
    v_xor_b32 v59, v59, v66
    v_lshl_add_u32 v52, v59, 4, v68
    s_mul_i32 s33, s30, 12
    s_add_u32 s33, s33, 4
    v_add_u32 v59, s33, v69
    v_xor_b32 v59, v59, v66
    v_lshl_add_u32 v53, v59, 4, v68
    s_mul_i32 s33, s30, 12
    s_add_u32 s33, s33, 6
    v_add_u32 v59, s33, v69
    v_xor_b32 v59, v59, v66
    v_lshl_add_u32 v54, v59, 4, v68
    s_mul_i32 s33, s30, 12
    s_add_u32 s33, s33, 8
    v_add_u32 v59, s33, v69
    v_xor_b32 v59, v59, v66
    v_lshl_add_u32 v55, v59, 4, v68
    s_mul_i32 s33, s30, 12
    s_add_u32 s33, s33, 10
    v_add_u32 v59, s33, v69
    v_xor_b32 v59, v59, v66
    v_lshl_add_u32 v56, v59, 4, v68
    v_lshl_add_u32 v59, v63, 3, v64
    v_mul_u32_u24 v59, 384, v59
    v_lshl_add_u32 v59, v65, 3, v59
    v_add_u32 v70, 20480, v59
    v_lshrrev_b32 v59, 1, v64
    v_and_b32 v60, 1, v63
    v_lshl_or_b32 v69, v60, 1, v59
    s_mul_i32 s33, s30, 6
    s_add_u32 s33, s33, 0
    v_xor_b32 v59, s33, v69
    v_lshl_add_u32 v39, v59, 5, v70
    s_mul_i32 s33, s30, 6
    s_add_u32 s33, s33, 1
    v_xor_b32 v59, s33, v69
    v_lshl_add_u32 v40, v59, 5, v70
    s_mul_i32 s33, s30, 6
    s_add_u32 s33, s33, 2
    v_xor_b32 v59, s33, v69
    v_lshl_add_u32 v41, v59, 5, v70
    s_mul_i32 s33, s30, 6
    s_add_u32 s33, s33, 3
    v_xor_b32 v59, s33, v69
    v_lshl_add_u32 v42, v59, 5, v70
    s_mul_i32 s33, s30, 6
    s_add_u32 s33, s33, 4
    v_xor_b32 v59, s33, v69
    v_lshl_add_u32 v43, v59, 5, v70
    s_mul_i32 s33, s30, 6
    s_add_u32 s33, s33, 5
    v_xor_b32 v59, s33, v69
    v_lshl_add_u32 v44, v59, 5, v70
    s_lshl_b32 s33, s30, 4
    v_add_u32 v59, s33, v62
    v_mul_u32_u24 v59, 384, v59
    v_xor_b32 v60, v63, v66
    v_lshl_add_u32 v59, v60, 4, v59
    v_add_u32 v9, 135168, v59
    v_xor_b32 v10, 64, v9
    v_lshl_add_u32 v59, v63, 2, v64
    v_add_u32 v59, s33, v59
    v_lshlrev_b32 v59, 7, v59
    v_lshl_add_u32 v59, v65, 3, v59
    v_add_u32 v70, 12288, v59
    v_lshrrev_b32 v59, 1, v64
    v_lshl_add_u32 v59, v63, 1, v59
    v_and_b32 v69, 3, v59
    s_lshl_b32 s33, s30, 1
    s_xor_b32 s33, s33, 0
    v_xor_b32 v59, s33, v69
    v_lshl_add_u32 v20, v59, 5, v70
    s_lshl_b32 s33, s30, 1
    s_xor_b32 s33, s33, 1
    v_xor_b32 v59, s33, v69
    v_lshl_add_u32 v21, v59, 5, v70
    s_lshl_b32 s33, s30, 1
    s_xor_b32 s33, s33, 2
    v_xor_b32 v59, s33, v69
    v_lshl_add_u32 v22, v59, 5, v70
    s_lshl_b32 s33, s30, 1
    s_xor_b32 s33, s33, 3
    v_xor_b32 v59, s33, v69
    v_lshl_add_u32 v23, v59, 5, v70
    s_mov_b32 s42, 0x3dd53b95
    s_and_b32 s33, s2, 3
    s_lshl_b32 s33, s33, 6
    v_mov_b32 v114, s33
    v_cmp_gt_u32 vcc, 0x3ffffff0, v71
    s_nop 1
    v_cndmask_b32 v114, v71, v114, vcc
    v_mov_b32 v115, 1
    s_mov_b32 s38, 128
    s_add_u32 m0, s34, 0
    s_nop 0
    buffer_load_dwordx4 v24, s[8:11], s38 offen lds
    buffer_load_dwordx4 v25, s[8:11], s38 offen offset:1024 lds
    buffer_load_dwordx4 v26, s[8:11], s38 offen offset:2048 lds
    buffer_load_dwordx4 v27, s[8:11], s38 offen offset:3072 lds
    s_add_u32 m0, s34, 4096
    s_nop 0
    buffer_load_dwordx4 v28, s[8:11], s38 offen lds
    s_mov_b32 s39, 786432
    s_add_u32 m0, s35, 0
    s_nop 0
    buffer_load_dwordx4 v29, s[12:15], s39 offen lds
    buffer_load_dwordx4 v30, s[12:15], s39 offen offset:1024 lds
    buffer_load_dwordx4 v31, s[12:15], s39 offen offset:2048 lds
    buffer_load_dwordx4 v32, s[12:15], s39 offen offset:3072 lds
    s_add_u32 m0, s35, 4096
    s_nop 0
    buffer_load_dwordx4 v33, s[12:15], s39 offen lds
    buffer_load_dwordx4 v34, s[12:15], s39 offen offset:1024 lds
    s_waitcnt vmcnt(11)
    s_barrier
    v_add_u32 v37, 90112, v35
    v_add_u32 v38, 90112, v36
    v_add_u32 v45, 90112, v39
    v_add_u32 v46, 90112, v40
    v_add_u32 v47, 90112, v41
    v_add_u32 v48, 90112, v42
    v_add_u32 v49, 90112, v43
    v_add_u32 v50, 90112, v44
    ds_read_b64_tr_b16 a[20:21], v45
    ds_read_b64_tr_b16 a[22:23], v45 offset:1536
    ds_read_b128 a[0:3], v37
    ds_read_b64_tr_b16 a[24:25], v46
    ds_read_b64_tr_b16 a[26:27], v46 offset:1536
    ds_read_b128 a[4:7], v37 offset:2048
    ds_read_b64_tr_b16 a[28:29], v47
    ds_read_b64_tr_b16 a[30:31], v47 offset:1536
    ds_read_b128 a[8:11], v37 offset:4096
    ds_read_b64_tr_b16 a[32:33], v48
    ds_read_b64_tr_b16 a[34:35], v48 offset:1536
    ds_read_b128 a[12:15], v37 offset:6144
    ds_read_b64_tr_b16 a[36:37], v49
    ds_read_b64_tr_b16 a[38:39], v49 offset:1536
    ds_read_b128 a[16:19], v37 offset:8192
    ds_read_b64_tr_b16 a[40:41], v50
    ds_read_b64_tr_b16 a[42:43], v50 offset:1536
    s_waitcnt lgkmcnt(14)
    v_mfma_f32_16x16x32_bf16 v[136:139], a[20:23], a[0:3], 0
    ds_read_b64_tr_b16 a[64:65], v45 offset:12288
    s_waitcnt lgkmcnt(12)
    v_mfma_f32_16x16x32_bf16 v[140:143], a[20:23], a[4:7], 0
    s_mov_b32 s38, 256
    s_add_u32 m0, s34, 45056
    s_nop 0
    buffer_load_dwordx4 v24, s[8:11], s38 offen lds
    s_waitcnt lgkmcnt(9)
    v_mfma_f32_16x16x32_bf16 v[144:147], a[20:23], a[8:11], 0
    ds_read_b64_tr_b16 a[66:67], v45 offset:13824
    s_waitcnt lgkmcnt(7)
    v_mfma_f32_16x16x32_bf16 v[148:151], a[20:23], a[12:15], 0
    ds_read_b128 a[44:47], v38
    s_waitcnt lgkmcnt(5)
    v_mfma_f32_16x16x32_bf16 v[152:155], a[20:23], a[16:19], 0
    ds_read_b64_tr_b16 a[68:69], v46 offset:12288
    v_mfma_f32_16x16x32_bf16 v[156:159], a[24:27], a[0:3], 0
    buffer_load_dwordx4 v25, s[8:11], s38 offen offset:1024 lds
    v_mfma_f32_16x16x32_bf16 v[160:163], a[24:27], a[4:7], 0
    ds_read_b64_tr_b16 a[70:71], v46 offset:13824
    v_mfma_f32_16x16x32_bf16 v[164:167], a[24:27], a[8:11], 0
    ds_read_b128 a[48:51], v38 offset:2048
    v_mfma_f32_16x16x32_bf16 v[168:171], a[24:27], a[12:15], 0
    buffer_load_dwordx4 v26, s[8:11], s38 offen offset:2048 lds
    v_mfma_f32_16x16x32_bf16 v[172:175], a[24:27], a[16:19], 0
    ds_read_b64_tr_b16 a[72:73], v47 offset:12288
    v_mfma_f32_16x16x32_bf16 v[176:179], a[28:31], a[0:3], 0
    ds_read_b64_tr_b16 a[74:75], v47 offset:13824
    v_mfma_f32_16x16x32_bf16 v[180:183], a[28:31], a[4:7], 0
    ds_read_b128 a[52:55], v38 offset:4096
    v_mfma_f32_16x16x32_bf16 v[184:187], a[28:31], a[8:11], 0
    buffer_load_dwordx4 v27, s[8:11], s38 offen offset:3072 lds
    v_mfma_f32_16x16x32_bf16 v[188:191], a[28:31], a[12:15], 0
    ds_read_b64_tr_b16 a[76:77], v48 offset:12288
    v_mfma_f32_16x16x32_bf16 v[192:195], a[28:31], a[16:19], 0
    ds_read_b64_tr_b16 a[78:79], v48 offset:13824
    v_mfma_f32_16x16x32_bf16 v[196:199], a[32:35], a[0:3], 0
    s_add_u32 m0, s34, 49152
    s_nop 0
    buffer_load_dwordx4 v28, s[8:11], s38 offen lds
    v_mfma_f32_16x16x32_bf16 v[200:203], a[32:35], a[4:7], 0
    ds_read_b128 a[56:59], v38 offset:6144
    v_mfma_f32_16x16x32_bf16 v[204:207], a[32:35], a[8:11], 0
    ds_read_b64_tr_b16 a[80:81], v49 offset:12288
    v_mfma_f32_16x16x32_bf16 v[208:211], a[32:35], a[12:15], 0
    s_mov_b32 s39, 1572864
    s_add_u32 m0, s35, 45056
    s_nop 0
    buffer_load_dwordx4 v29, s[12:15], s39 offen lds
    v_mfma_f32_16x16x32_bf16 v[212:215], a[32:35], a[16:19], 0
    ds_read_b64_tr_b16 a[82:83], v49 offset:13824
    v_mfma_f32_16x16x32_bf16 v[216:219], a[36:39], a[0:3], 0
    ds_read_b128 a[60:63], v38 offset:8192
    v_mfma_f32_16x16x32_bf16 v[220:223], a[36:39], a[4:7], 0
    ds_read_b64_tr_b16 a[84:85], v50 offset:12288
    v_mfma_f32_16x16x32_bf16 v[224:227], a[36:39], a[8:11], 0
    buffer_load_dwordx4 v30, s[12:15], s39 offen offset:1024 lds
    v_mfma_f32_16x16x32_bf16 v[228:231], a[36:39], a[12:15], 0
    ds_read_b64_tr_b16 a[86:87], v50 offset:13824
    v_mfma_f32_16x16x32_bf16 v[232:235], a[36:39], a[16:19], 0
    s_waitcnt lgkmcnt(15)
    v_mfma_f32_16x16x32_bf16 v[236:239], a[40:43], a[0:3], 0
    v_mfma_f32_16x16x32_bf16 v[240:243], a[40:43], a[4:7], 0
    v_mfma_f32_16x16x32_bf16 v[244:247], a[40:43], a[8:11], 0
    v_mfma_f32_16x16x32_bf16 v[248:251], a[40:43], a[12:15], 0
    v_mfma_f32_16x16x32_bf16 v[252:255], a[40:43], a[16:19], 0
    s_waitcnt lgkmcnt(0)
    s_waitcnt vmcnt(7)
    s_barrier
    v_mfma_f32_16x16x32_bf16 v[136:139], a[64:67], a[44:47], v[136:139]
    v_add_u32 v37, 0, v35
    v_add_u32 v38, 0, v36
    v_mfma_f32_16x16x32_bf16 v[140:143], a[64:67], a[48:51], v[140:143]
    v_add_u32 v45, 0, v39
    v_mfma_f32_16x16x32_bf16 v[144:147], a[64:67], a[52:55], v[144:147]
    buffer_load_dwordx4 v31, s[12:15], s39 offen offset:2048 lds
    v_mfma_f32_16x16x32_bf16 v[148:151], a[64:67], a[56:59], v[148:151]
    v_add_u32 v46, 0, v40
    v_mfma_f32_16x16x32_bf16 v[152:155], a[64:67], a[60:63], v[152:155]
    v_add_u32 v47, 0, v41
    v_mfma_f32_16x16x32_bf16 v[156:159], a[68:71], a[44:47], v[156:159]
    v_add_u32 v48, 0, v42
    v_mfma_f32_16x16x32_bf16 v[160:163], a[68:71], a[48:51], v[160:163]
    v_add_u32 v49, 0, v43
    v_add_u32 v50, 0, v44
    v_mfma_f32_16x16x32_bf16 v[164:167], a[68:71], a[52:55], v[164:167]
    buffer_load_dwordx4 v32, s[12:15], s39 offen offset:3072 lds
    v_mfma_f32_16x16x32_bf16 v[168:171], a[68:71], a[56:59], v[168:171]
    ds_read_b64_tr_b16 a[20:21], v45
    v_mfma_f32_16x16x32_bf16 v[172:175], a[68:71], a[60:63], v[172:175]
    ds_read_b64_tr_b16 a[22:23], v45 offset:1536
    v_mfma_f32_16x16x32_bf16 v[176:179], a[72:75], a[44:47], v[176:179]
    ds_read_b128 a[0:3], v37
    v_mfma_f32_16x16x32_bf16 v[180:183], a[72:75], a[48:51], v[180:183]
    ds_read_b64_tr_b16 a[24:25], v46
    v_mfma_f32_16x16x32_bf16 v[184:187], a[72:75], a[52:55], v[184:187]
    ds_read_b64_tr_b16 a[26:27], v46 offset:1536
    v_mfma_f32_16x16x32_bf16 v[188:191], a[72:75], a[56:59], v[188:191]
    s_add_u32 m0, s35, 49152
    s_nop 0
    buffer_load_dwordx4 v33, s[12:15], s39 offen lds
    ds_read_b128 a[4:7], v37 offset:2048
    v_mfma_f32_16x16x32_bf16 v[192:195], a[72:75], a[60:63], v[192:195]
    ds_read_b64_tr_b16 a[28:29], v47
    v_mfma_f32_16x16x32_bf16 v[196:199], a[76:79], a[44:47], v[196:199]
    ds_read_b64_tr_b16 a[30:31], v47 offset:1536
    v_mfma_f32_16x16x32_bf16 v[200:203], a[76:79], a[48:51], v[200:203]
    ds_read_b128 a[8:11], v37 offset:4096
    v_mfma_f32_16x16x32_bf16 v[204:207], a[76:79], a[52:55], v[204:207]
    ds_read_b64_tr_b16 a[32:33], v48
    v_mfma_f32_16x16x32_bf16 v[208:211], a[76:79], a[56:59], v[208:211]
    buffer_load_dwordx4 v34, s[12:15], s39 offen offset:1024 lds
    v_mfma_f32_16x16x32_bf16 v[212:215], a[76:79], a[60:63], v[212:215]
    ds_read_b64_tr_b16 a[34:35], v48 offset:1536
    ds_read_b128 a[12:15], v37 offset:6144
    v_mfma_f32_16x16x32_bf16 v[216:219], a[80:83], a[44:47], v[216:219]
    ds_read_b64_tr_b16 a[36:37], v49
    v_mfma_f32_16x16x32_bf16 v[220:223], a[80:83], a[48:51], v[220:223]
    ds_read_b64_tr_b16 a[38:39], v49 offset:1536
    v_mfma_f32_16x16x32_bf16 v[224:227], a[80:83], a[52:55], v[224:227]
    ds_read_b128 a[16:19], v37 offset:8192
    v_mfma_f32_16x16x32_bf16 v[228:231], a[80:83], a[56:59], v[228:231]
    s_mov_b32 s38, 384
    s_add_u32 m0, s34, 90112
    s_nop 0
    buffer_load_dwordx4 v24, s[8:11], s38 offen lds
    v_mfma_f32_16x16x32_bf16 v[232:235], a[80:83], a[60:63], v[232:235]
    ds_read_b64_tr_b16 a[40:41], v50
    v_mfma_f32_16x16x32_bf16 v[236:239], a[84:87], a[44:47], v[236:239]
    ds_read_b64_tr_b16 a[42:43], v50 offset:1536
    v_mfma_f32_16x16x32_bf16 v[240:243], a[84:87], a[48:51], v[240:243]
    v_mfma_f32_16x16x32_bf16 v[244:247], a[84:87], a[52:55], v[244:247]
    v_mfma_f32_16x16x32_bf16 v[248:251], a[84:87], a[56:59], v[248:251]
    v_mfma_f32_16x16x32_bf16 v[252:255], a[84:87], a[60:63], v[252:255]
    s_waitcnt lgkmcnt(14)
    v_mfma_f32_16x16x32_bf16 v[136:139], a[20:23], a[0:3], v[136:139]
    ds_read_b64_tr_b16 a[64:65], v45 offset:12288
    s_waitcnt lgkmcnt(12)
    v_mfma_f32_16x16x32_bf16 v[140:143], a[20:23], a[4:7], v[140:143]
    buffer_load_dwordx4 v25, s[8:11], s38 offen offset:1024 lds
    s_waitcnt lgkmcnt(9)
    v_mfma_f32_16x16x32_bf16 v[144:147], a[20:23], a[8:11], v[144:147]
    ds_read_b64_tr_b16 a[66:67], v45 offset:13824
    s_waitcnt lgkmcnt(7)
    v_mfma_f32_16x16x32_bf16 v[148:151], a[20:23], a[12:15], v[148:151]
    ds_read_b128 a[44:47], v38
    s_waitcnt lgkmcnt(5)
    v_mfma_f32_16x16x32_bf16 v[152:155], a[20:23], a[16:19], v[152:155]
    ds_read_b64_tr_b16 a[68:69], v46 offset:12288
    v_mfma_f32_16x16x32_bf16 v[156:159], a[24:27], a[0:3], v[156:159]
    buffer_load_dwordx4 v26, s[8:11], s38 offen offset:2048 lds
    v_mfma_f32_16x16x32_bf16 v[160:163], a[24:27], a[4:7], v[160:163]
    ds_read_b64_tr_b16 a[70:71], v46 offset:13824
    v_mfma_f32_16x16x32_bf16 v[164:167], a[24:27], a[8:11], v[164:167]
    ds_read_b128 a[48:51], v38 offset:2048
    v_mfma_f32_16x16x32_bf16 v[168:171], a[24:27], a[12:15], v[168:171]
    buffer_load_dwordx4 v27, s[8:11], s38 offen offset:3072 lds
    v_mfma_f32_16x16x32_bf16 v[172:175], a[24:27], a[16:19], v[172:175]
    ds_read_b64_tr_b16 a[72:73], v47 offset:12288
    v_mfma_f32_16x16x32_bf16 v[176:179], a[28:31], a[0:3], v[176:179]
    ds_read_b64_tr_b16 a[74:75], v47 offset:13824
    v_mfma_f32_16x16x32_bf16 v[180:183], a[28:31], a[4:7], v[180:183]
    ds_read_b128 a[52:55], v38 offset:4096
    v_mfma_f32_16x16x32_bf16 v[184:187], a[28:31], a[8:11], v[184:187]
    s_add_u32 m0, s34, 94208
    s_nop 0
    buffer_load_dwordx4 v28, s[8:11], s38 offen lds
    v_mfma_f32_16x16x32_bf16 v[188:191], a[28:31], a[12:15], v[188:191]
    ds_read_b64_tr_b16 a[76:77], v48 offset:12288
    v_mfma_f32_16x16x32_bf16 v[192:195], a[28:31], a[16:19], v[192:195]
    ds_read_b64_tr_b16 a[78:79], v48 offset:13824
    v_mfma_f32_16x16x32_bf16 v[196:199], a[32:35], a[0:3], v[196:199]
    s_mov_b32 s39, 2359296
    s_add_u32 m0, s35, 90112
    s_nop 0
    buffer_load_dwordx4 v29, s[12:15], s39 offen lds
    v_mfma_f32_16x16x32_bf16 v[200:203], a[32:35], a[4:7], v[200:203]
    ds_read_b128 a[56:59], v38 offset:6144
    v_mfma_f32_16x16x32_bf16 v[204:207], a[32:35], a[8:11], v[204:207]
    ds_read_b64_tr_b16 a[80:81], v49 offset:12288
    v_mfma_f32_16x16x32_bf16 v[208:211], a[32:35], a[12:15], v[208:211]
    buffer_load_dwordx4 v30, s[12:15], s39 offen offset:1024 lds
    v_mfma_f32_16x16x32_bf16 v[212:215], a[32:35], a[16:19], v[212:215]
    ds_read_b64_tr_b16 a[82:83], v49 offset:13824
    v_mfma_f32_16x16x32_bf16 v[216:219], a[36:39], a[0:3], v[216:219]
    ds_read_b128 a[60:63], v38 offset:8192
    v_mfma_f32_16x16x32_bf16 v[220:223], a[36:39], a[4:7], v[220:223]
    ds_read_b64_tr_b16 a[84:85], v50 offset:12288
    v_mfma_f32_16x16x32_bf16 v[224:227], a[36:39], a[8:11], v[224:227]
    buffer_load_dwordx4 v31, s[12:15], s39 offen offset:2048 lds
    v_mfma_f32_16x16x32_bf16 v[228:231], a[36:39], a[12:15], v[228:231]
    ds_read_b64_tr_b16 a[86:87], v50 offset:13824
    v_mfma_f32_16x16x32_bf16 v[232:235], a[36:39], a[16:19], v[232:235]
    s_waitcnt lgkmcnt(15)
    v_mfma_f32_16x16x32_bf16 v[236:239], a[40:43], a[0:3], v[236:239]
    v_mfma_f32_16x16x32_bf16 v[240:243], a[40:43], a[4:7], v[240:243]
    v_mfma_f32_16x16x32_bf16 v[244:247], a[40:43], a[8:11], v[244:247]
    v_mfma_f32_16x16x32_bf16 v[248:251], a[40:43], a[12:15], v[248:251]
    v_mfma_f32_16x16x32_bf16 v[252:255], a[40:43], a[16:19], v[252:255]
    s_waitcnt lgkmcnt(0)
    s_waitcnt vmcnt(8)
    s_barrier
    v_mfma_f32_16x16x32_bf16 v[136:139], a[64:67], a[44:47], v[136:139]
    v_add_u32 v37, 45056, v35
    v_add_u32 v38, 45056, v36
    v_mfma_f32_16x16x32_bf16 v[140:143], a[64:67], a[48:51], v[140:143]
    v_add_u32 v45, 45056, v39
    v_mfma_f32_16x16x32_bf16 v[144:147], a[64:67], a[52:55], v[144:147]
    buffer_load_dwordx4 v32, s[12:15], s39 offen offset:3072 lds
    v_mfma_f32_16x16x32_bf16 v[148:151], a[64:67], a[56:59], v[148:151]
    v_add_u32 v46, 45056, v40
    v_mfma_f32_16x16x32_bf16 v[152:155], a[64:67], a[60:63], v[152:155]
    v_add_u32 v47, 45056, v41
    v_mfma_f32_16x16x32_bf16 v[156:159], a[68:71], a[44:47], v[156:159]
    v_add_u32 v48, 45056, v42
    v_mfma_f32_16x16x32_bf16 v[160:163], a[68:71], a[48:51], v[160:163]
    v_add_u32 v49, 45056, v43
    v_add_u32 v50, 45056, v44
    v_mfma_f32_16x16x32_bf16 v[164:167], a[68:71], a[52:55], v[164:167]
    s_add_u32 m0, s35, 94208
    s_nop 0
    buffer_load_dwordx4 v33, s[12:15], s39 offen lds
    v_mfma_f32_16x16x32_bf16 v[168:171], a[68:71], a[56:59], v[168:171]
    ds_read_b64_tr_b16 a[20:21], v45
    v_mfma_f32_16x16x32_bf16 v[172:175], a[68:71], a[60:63], v[172:175]
    ds_read_b64_tr_b16 a[22:23], v45 offset:1536
    v_mfma_f32_16x16x32_bf16 v[176:179], a[72:75], a[44:47], v[176:179]
    ds_read_b128 a[0:3], v37
    v_mfma_f32_16x16x32_bf16 v[180:183], a[72:75], a[48:51], v[180:183]
    ds_read_b64_tr_b16 a[24:25], v46
    v_mfma_f32_16x16x32_bf16 v[184:187], a[72:75], a[52:55], v[184:187]
    ds_read_b64_tr_b16 a[26:27], v46 offset:1536
    v_mfma_f32_16x16x32_bf16 v[188:191], a[72:75], a[56:59], v[188:191]
    buffer_load_dwordx4 v34, s[12:15], s39 offen offset:1024 lds
    ds_read_b128 a[4:7], v37 offset:2048
    v_mfma_f32_16x16x32_bf16 v[192:195], a[72:75], a[60:63], v[192:195]
    ds_read_b64_tr_b16 a[28:29], v47
    v_mfma_f32_16x16x32_bf16 v[196:199], a[76:79], a[44:47], v[196:199]
    ds_read_b64_tr_b16 a[30:31], v47 offset:1536
    v_mfma_f32_16x16x32_bf16 v[200:203], a[76:79], a[48:51], v[200:203]
    ds_read_b128 a[8:11], v37 offset:4096
    v_mfma_f32_16x16x32_bf16 v[204:207], a[76:79], a[52:55], v[204:207]
    ds_read_b64_tr_b16 a[32:33], v48
    v_mfma_f32_16x16x32_bf16 v[208:211], a[76:79], a[56:59], v[208:211]
    v_add_co_u32 v100, vcc, v100, v102
    s_nop 1
    v_addc_co_u32 v101, vcc, 0, v101, vcc
    global_load_dword v105, v[100:101], off
    v_mfma_f32_16x16x32_bf16 v[212:215], a[76:79], a[60:63], v[212:215]
    ds_read_b64_tr_b16 a[34:35], v48 offset:1536
    ds_read_b128 a[12:15], v37 offset:6144
    v_mfma_f32_16x16x32_bf16 v[216:219], a[80:83], a[44:47], v[216:219]
    ds_read_b64_tr_b16 a[36:37], v49
    v_mfma_f32_16x16x32_bf16 v[220:223], a[80:83], a[48:51], v[220:223]
    ds_read_b64_tr_b16 a[38:39], v49 offset:1536
    v_mfma_f32_16x16x32_bf16 v[224:227], a[80:83], a[52:55], v[224:227]
    ds_read_b128 a[16:19], v37 offset:8192
    v_mfma_f32_16x16x32_bf16 v[228:231], a[80:83], a[56:59], v[228:231]
    s_mov_b32 s38, 512
    s_add_u32 m0, s34, 0
    s_nop 0
    buffer_load_dwordx4 v24, s[8:11], s38 offen lds
    v_mfma_f32_16x16x32_bf16 v[232:235], a[80:83], a[60:63], v[232:235]
    ds_read_b64_tr_b16 a[40:41], v50
    v_mfma_f32_16x16x32_bf16 v[236:239], a[84:87], a[44:47], v[236:239]
    ds_read_b64_tr_b16 a[42:43], v50 offset:1536
    v_mfma_f32_16x16x32_bf16 v[240:243], a[84:87], a[48:51], v[240:243]
    v_mfma_f32_16x16x32_bf16 v[244:247], a[84:87], a[52:55], v[244:247]
    v_mfma_f32_16x16x32_bf16 v[248:251], a[84:87], a[56:59], v[248:251]
    v_mfma_f32_16x16x32_bf16 v[252:255], a[84:87], a[60:63], v[252:255]
    s_waitcnt lgkmcnt(14)
    v_mfma_f32_16x16x32_bf16 v[136:139], a[20:23], a[0:3], v[136:139]
    ds_read_b64_tr_b16 a[64:65], v45 offset:12288
    s_waitcnt lgkmcnt(12)
    v_mfma_f32_16x16x32_bf16 v[140:143], a[20:23], a[4:7], v[140:143]
    buffer_load_dwordx4 v25, s[8:11], s38 offen offset:1024 lds
    s_waitcnt lgkmcnt(9)
    v_mfma_f32_16x16x32_bf16 v[144:147], a[20:23], a[8:11], v[144:147]
    ds_read_b64_tr_b16 a[66:67], v45 offset:13824
    s_waitcnt lgkmcnt(7)
    v_mfma_f32_16x16x32_bf16 v[148:151], a[20:23], a[12:15], v[148:151]
    ds_read_b128 a[44:47], v38
    s_waitcnt lgkmcnt(5)
    v_mfma_f32_16x16x32_bf16 v[152:155], a[20:23], a[16:19], v[152:155]
    ds_read_b64_tr_b16 a[68:69], v46 offset:12288
    v_mfma_f32_16x16x32_bf16 v[156:159], a[24:27], a[0:3], v[156:159]
    buffer_load_dwordx4 v26, s[8:11], s38 offen offset:2048 lds
    v_mfma_f32_16x16x32_bf16 v[160:163], a[24:27], a[4:7], v[160:163]
    ds_read_b64_tr_b16 a[70:71], v46 offset:13824
    v_mfma_f32_16x16x32_bf16 v[164:167], a[24:27], a[8:11], v[164:167]
    ds_read_b128 a[48:51], v38 offset:2048
    v_mfma_f32_16x16x32_bf16 v[168:171], a[24:27], a[12:15], v[168:171]
    buffer_load_dwordx4 v27, s[8:11], s38 offen offset:3072 lds
    v_mfma_f32_16x16x32_bf16 v[172:175], a[24:27], a[16:19], v[172:175]
    ds_read_b64_tr_b16 a[72:73], v47 offset:12288
    v_mfma_f32_16x16x32_bf16 v[176:179], a[28:31], a[0:3], v[176:179]
    ds_read_b64_tr_b16 a[74:75], v47 offset:13824
    v_mfma_f32_16x16x32_bf16 v[180:183], a[28:31], a[4:7], v[180:183]
    ds_read_b128 a[52:55], v38 offset:4096
    v_mfma_f32_16x16x32_bf16 v[184:187], a[28:31], a[8:11], v[184:187]
    s_add_u32 m0, s34, 4096
    s_nop 0
    buffer_load_dwordx4 v28, s[8:11], s38 offen lds
    v_mfma_f32_16x16x32_bf16 v[188:191], a[28:31], a[12:15], v[188:191]
    ds_read_b64_tr_b16 a[76:77], v48 offset:12288
    v_mfma_f32_16x16x32_bf16 v[192:195], a[28:31], a[16:19], v[192:195]
    ds_read_b64_tr_b16 a[78:79], v48 offset:13824
    v_mfma_f32_16x16x32_bf16 v[196:199], a[32:35], a[0:3], v[196:199]
    s_mov_b32 s39, 3145728
    s_add_u32 m0, s35, 0
    s_nop 0
    buffer_load_dwordx4 v29, s[12:15], s39 offen lds
    v_mfma_f32_16x16x32_bf16 v[200:203], a[32:35], a[4:7], v[200:203]
    ds_read_b128 a[56:59], v38 offset:6144
    v_mfma_f32_16x16x32_bf16 v[204:207], a[32:35], a[8:11], v[204:207]
    ds_read_b64_tr_b16 a[80:81], v49 offset:12288
    v_mfma_f32_16x16x32_bf16 v[208:211], a[32:35], a[12:15], v[208:211]
    buffer_load_dwordx4 v30, s[12:15], s39 offen offset:1024 lds
    v_mfma_f32_16x16x32_bf16 v[212:215], a[32:35], a[16:19], v[212:215]
    ds_read_b64_tr_b16 a[82:83], v49 offset:13824
    v_mfma_f32_16x16x32_bf16 v[216:219], a[36:39], a[0:3], v[216:219]
    ds_read_b128 a[60:63], v38 offset:8192
    v_mfma_f32_16x16x32_bf16 v[220:223], a[36:39], a[4:7], v[220:223]
    ds_read_b64_tr_b16 a[84:85], v50 offset:12288
    v_mfma_f32_16x16x32_bf16 v[224:227], a[36:39], a[8:11], v[224:227]
    buffer_load_dwordx4 v31, s[12:15], s39 offen offset:2048 lds
    v_mfma_f32_16x16x32_bf16 v[228:231], a[36:39], a[12:15], v[228:231]
    ds_read_b64_tr_b16 a[86:87], v50 offset:13824
    v_mfma_f32_16x16x32_bf16 v[232:235], a[36:39], a[16:19], v[232:235]
    s_waitcnt lgkmcnt(15)
    v_mfma_f32_16x16x32_bf16 v[236:239], a[40:43], a[0:3], v[236:239]
    v_mfma_f32_16x16x32_bf16 v[240:243], a[40:43], a[4:7], v[240:243]
    v_mfma_f32_16x16x32_bf16 v[244:247], a[40:43], a[8:11], v[244:247]
    v_mfma_f32_16x16x32_bf16 v[248:251], a[40:43], a[12:15], v[248:251]
    v_mfma_f32_16x16x32_bf16 v[252:255], a[40:43], a[16:19], v[252:255]
    s_waitcnt lgkmcnt(0)
    s_waitcnt vmcnt(9)
    s_barrier
    v_mfma_f32_16x16x32_bf16 v[136:139], a[64:67], a[44:47], v[136:139]
    v_add_u32 v37, 90112, v35
    v_add_u32 v38, 90112, v36
    v_mfma_f32_16x16x32_bf16 v[140:143], a[64:67], a[48:51], v[140:143]
    v_add_u32 v45, 90112, v39
    v_mfma_f32_16x16x32_bf16 v[144:147], a[64:67], a[52:55], v[144:147]
    buffer_load_dwordx4 v32, s[12:15], s39 offen offset:3072 lds
    v_mfma_f32_16x16x32_bf16 v[148:151], a[64:67], a[56:59], v[148:151]
    v_add_u32 v46, 90112, v40
    v_mfma_f32_16x16x32_bf16 v[152:155], a[64:67], a[60:63], v[152:155]
    v_add_u32 v47, 90112, v41
    v_mfma_f32_16x16x32_bf16 v[156:159], a[68:71], a[44:47], v[156:159]
    v_add_u32 v48, 90112, v42
    v_mfma_f32_16x16x32_bf16 v[160:163], a[68:71], a[48:51], v[160:163]
    v_add_u32 v49, 90112, v43
    v_add_u32 v50, 90112, v44
    v_mfma_f32_16x16x32_bf16 v[164:167], a[68:71], a[52:55], v[164:167]
    s_add_u32 m0, s35, 4096
    s_nop 0
    buffer_load_dwordx4 v33, s[12:15], s39 offen lds
    v_mfma_f32_16x16x32_bf16 v[168:171], a[68:71], a[56:59], v[168:171]
    ds_read_b64_tr_b16 a[20:21], v45
    v_mfma_f32_16x16x32_bf16 v[172:175], a[68:71], a[60:63], v[172:175]
    ds_read_b64_tr_b16 a[22:23], v45 offset:1536
    v_mfma_f32_16x16x32_bf16 v[176:179], a[72:75], a[44:47], v[176:179]
    ds_read_b128 a[0:3], v37
    v_mfma_f32_16x16x32_bf16 v[180:183], a[72:75], a[48:51], v[180:183]
    ds_read_b64_tr_b16 a[24:25], v46
    v_mfma_f32_16x16x32_bf16 v[184:187], a[72:75], a[52:55], v[184:187]
    ds_read_b64_tr_b16 a[26:27], v46 offset:1536
    v_mfma_f32_16x16x32_bf16 v[188:191], a[72:75], a[56:59], v[188:191]
    buffer_load_dwordx4 v34, s[12:15], s39 offen offset:1024 lds
    ds_read_b128 a[4:7], v37 offset:2048
    v_mfma_f32_16x16x32_bf16 v[192:195], a[72:75], a[60:63], v[192:195]
    ds_read_b64_tr_b16 a[28:29], v47
    v_mfma_f32_16x16x32_bf16 v[196:199], a[76:79], a[44:47], v[196:199]
    ds_read_b64_tr_b16 a[30:31], v47 offset:1536
    v_mfma_f32_16x16x32_bf16 v[200:203], a[76:79], a[48:51], v[200:203]
    ds_read_b128 a[8:11], v37 offset:4096
    v_mfma_f32_16x16x32_bf16 v[204:207], a[76:79], a[52:55], v[204:207]
    ds_read_b64_tr_b16 a[32:33], v48
    v_mfma_f32_16x16x32_bf16 v[208:211], a[76:79], a[56:59], v[208:211]
    s_mov_b32 s38, 640
    s_add_u32 m0, s34, 45056
    s_nop 0
    buffer_load_dwordx4 v24, s[8:11], s38 offen lds
    v_mfma_f32_16x16x32_bf16 v[212:215], a[76:79], a[60:63], v[212:215]
    ds_read_b64_tr_b16 a[34:35], v48 offset:1536
    ds_read_b128 a[12:15], v37 offset:6144
    v_mfma_f32_16x16x32_bf16 v[216:219], a[80:83], a[44:47], v[216:219]
    ds_read_b64_tr_b16 a[36:37], v49
    v_mfma_f32_16x16x32_bf16 v[220:223], a[80:83], a[48:51], v[220:223]
    ds_read_b64_tr_b16 a[38:39], v49 offset:1536
    v_mfma_f32_16x16x32_bf16 v[224:227], a[80:83], a[52:55], v[224:227]
    ds_read_b128 a[16:19], v37 offset:8192
    v_mfma_f32_16x16x32_bf16 v[228:231], a[80:83], a[56:59], v[228:231]
    buffer_load_dwordx4 v25, s[8:11], s38 offen offset:1024 lds
    v_mfma_f32_16x16x32_bf16 v[232:235], a[80:83], a[60:63], v[232:235]
    ds_read_b64_tr_b16 a[40:41], v50
    v_mfma_f32_16x16x32_bf16 v[236:239], a[84:87], a[44:47], v[236:239]
    ds_read_b64_tr_b16 a[42:43], v50 offset:1536
    v_mfma_f32_16x16x32_bf16 v[240:243], a[84:87], a[48:51], v[240:243]
    v_mfma_f32_16x16x32_bf16 v[244:247], a[84:87], a[52:55], v[244:247]
    v_mfma_f32_16x16x32_bf16 v[248:251], a[84:87], a[56:59], v[248:251]
    v_mfma_f32_16x16x32_bf16 v[252:255], a[84:87], a[60:63], v[252:255]
    s_waitcnt lgkmcnt(14)
    v_mfma_f32_16x16x32_bf16 v[136:139], a[20:23], a[0:3], v[136:139]
    ds_read_b64_tr_b16 a[64:65], v45 offset:12288
    s_waitcnt lgkmcnt(12)
    v_mfma_f32_16x16x32_bf16 v[140:143], a[20:23], a[4:7], v[140:143]
    buffer_load_dwordx4 v26, s[8:11], s38 offen offset:2048 lds
    s_waitcnt lgkmcnt(9)
    v_mfma_f32_16x16x32_bf16 v[144:147], a[20:23], a[8:11], v[144:147]
    ds_read_b64_tr_b16 a[66:67], v45 offset:13824
    s_waitcnt lgkmcnt(7)
    v_mfma_f32_16x16x32_bf16 v[148:151], a[20:23], a[12:15], v[148:151]
    ds_read_b128 a[44:47], v38
    s_waitcnt lgkmcnt(5)
    v_mfma_f32_16x16x32_bf16 v[152:155], a[20:23], a[16:19], v[152:155]
    ds_read_b64_tr_b16 a[68:69], v46 offset:12288
    v_mfma_f32_16x16x32_bf16 v[156:159], a[24:27], a[0:3], v[156:159]
    buffer_load_dwordx4 v27, s[8:11], s38 offen offset:3072 lds
    v_mfma_f32_16x16x32_bf16 v[160:163], a[24:27], a[4:7], v[160:163]
    ds_read_b64_tr_b16 a[70:71], v46 offset:13824
    v_mfma_f32_16x16x32_bf16 v[164:167], a[24:27], a[8:11], v[164:167]
    ds_read_b128 a[48:51], v38 offset:2048
    v_mfma_f32_16x16x32_bf16 v[168:171], a[24:27], a[12:15], v[168:171]
    s_add_u32 m0, s34, 49152
    s_nop 0
    buffer_load_dwordx4 v28, s[8:11], s38 offen lds
    v_mfma_f32_16x16x32_bf16 v[172:175], a[24:27], a[16:19], v[172:175]
    ds_read_b64_tr_b16 a[72:73], v47 offset:12288
    v_mfma_f32_16x16x32_bf16 v[176:179], a[28:31], a[0:3], v[176:179]
    ds_read_b64_tr_b16 a[74:75], v47 offset:13824
    v_mfma_f32_16x16x32_bf16 v[180:183], a[28:31], a[4:7], v[180:183]
    ds_read_b128 a[52:55], v38 offset:4096
    v_mfma_f32_16x16x32_bf16 v[184:187], a[28:31], a[8:11], v[184:187]
    s_mov_b32 s39, 3932160
    s_add_u32 m0, s35, 45056
    s_nop 0
    buffer_load_dwordx4 v29, s[12:15], s39 offen lds
    v_mfma_f32_16x16x32_bf16 v[188:191], a[28:31], a[12:15], v[188:191]
    ds_read_b64_tr_b16 a[76:77], v48 offset:12288
    v_mfma_f32_16x16x32_bf16 v[192:195], a[28:31], a[16:19], v[192:195]
    ds_read_b64_tr_b16 a[78:79], v48 offset:13824
    v_mfma_f32_16x16x32_bf16 v[196:199], a[32:35], a[0:3], v[196:199]
    buffer_load_dwordx4 v30, s[12:15], s39 offen offset:1024 lds
    v_mfma_f32_16x16x32_bf16 v[200:203], a[32:35], a[4:7], v[200:203]
    ds_read_b128 a[56:59], v38 offset:6144
    v_mfma_f32_16x16x32_bf16 v[204:207], a[32:35], a[8:11], v[204:207]
    ds_read_b64_tr_b16 a[80:81], v49 offset:12288
    v_mfma_f32_16x16x32_bf16 v[208:211], a[32:35], a[12:15], v[208:211]
    buffer_load_dwordx4 v31, s[12:15], s39 offen offset:2048 lds
    v_mfma_f32_16x16x32_bf16 v[212:215], a[32:35], a[16:19], v[212:215]
    ds_read_b64_tr_b16 a[82:83], v49 offset:13824
    v_mfma_f32_16x16x32_bf16 v[216:219], a[36:39], a[0:3], v[216:219]
    ds_read_b128 a[60:63], v38 offset:8192
    v_mfma_f32_16x16x32_bf16 v[220:223], a[36:39], a[4:7], v[220:223]
    ds_read_b64_tr_b16 a[84:85], v50 offset:12288
    v_mfma_f32_16x16x32_bf16 v[224:227], a[36:39], a[8:11], v[224:227]
    buffer_load_dwordx4 v32, s[12:15], s39 offen offset:3072 lds
    v_mfma_f32_16x16x32_bf16 v[228:231], a[36:39], a[12:15], v[228:231]
    ds_read_b64_tr_b16 a[86:87], v50 offset:13824
    v_mfma_f32_16x16x32_bf16 v[232:235], a[36:39], a[16:19], v[232:235]
    s_waitcnt lgkmcnt(15)
    v_mfma_f32_16x16x32_bf16 v[236:239], a[40:43], a[0:3], v[236:239]
    v_mfma_f32_16x16x32_bf16 v[240:243], a[40:43], a[4:7], v[240:243]
    v_mfma_f32_16x16x32_bf16 v[244:247], a[40:43], a[8:11], v[244:247]
    v_mfma_f32_16x16x32_bf16 v[248:251], a[40:43], a[12:15], v[248:251]
    v_mfma_f32_16x16x32_bf16 v[252:255], a[40:43], a[16:19], v[252:255]
    s_waitcnt lgkmcnt(0)
    s_waitcnt vmcnt(9)
    s_barrier
    v_mfma_f32_16x16x32_bf16 v[136:139], a[64:67], a[44:47], v[136:139]
    v_add_u32 v37, 0, v35
    v_add_u32 v38, 0, v36
    v_mfma_f32_16x16x32_bf16 v[140:143], a[64:67], a[48:51], v[140:143]
    v_add_u32 v45, 0, v39
    v_mfma_f32_16x16x32_bf16 v[144:147], a[64:67], a[52:55], v[144:147]
    s_add_u32 m0, s35, 49152
    s_nop 0
    buffer_load_dwordx4 v33, s[12:15], s39 offen lds
    v_mfma_f32_16x16x32_bf16 v[148:151], a[64:67], a[56:59], v[148:151]
    v_add_u32 v46, 0, v40
    v_mfma_f32_16x16x32_bf16 v[152:155], a[64:67], a[60:63], v[152:155]
    v_add_u32 v47, 0, v41
    v_mfma_f32_16x16x32_bf16 v[156:159], a[68:71], a[44:47], v[156:159]
    v_add_u32 v48, 0, v42
    v_mfma_f32_16x16x32_bf16 v[160:163], a[68:71], a[48:51], v[160:163]
    v_add_u32 v49, 0, v43
    v_add_u32 v50, 0, v44
    v_mfma_f32_16x16x32_bf16 v[164:167], a[68:71], a[52:55], v[164:167]
    buffer_load_dwordx4 v34, s[12:15], s39 offen offset:1024 lds
    v_mfma_f32_16x16x32_bf16 v[168:171], a[68:71], a[56:59], v[168:171]
    ds_read_b64_tr_b16 a[20:21], v45
    v_mfma_f32_16x16x32_bf16 v[172:175], a[68:71], a[60:63], v[172:175]
    ds_read_b64_tr_b16 a[22:23], v45 offset:1536
    v_mfma_f32_16x16x32_bf16 v[176:179], a[72:75], a[44:47], v[176:179]
    ds_read_b128 a[0:3], v37
    v_mfma_f32_16x16x32_bf16 v[180:183], a[72:75], a[48:51], v[180:183]
    ds_read_b64_tr_b16 a[24:25], v46
    v_mfma_f32_16x16x32_bf16 v[184:187], a[72:75], a[52:55], v[184:187]
    ds_read_b64_tr_b16 a[26:27], v46 offset:1536
    v_mfma_f32_16x16x32_bf16 v[188:191], a[72:75], a[56:59], v[188:191]
    v_add_co_u32 v100, vcc, v100, v102
    s_nop 1
    v_addc_co_u32 v101, vcc, 0, v101, vcc
    s_cmp_lt_u32 s28, 2
    s_cbranch_scc0 TOUCH_SKIP
    global_load_dword v106, v[100:101], off
TOUCH_SKIP:
    ds_read_b128 a[4:7], v37 offset:2048
    v_mfma_f32_16x16x32_bf16 v[192:195], a[72:75], a[60:63], v[192:195]
    ds_read_b64_tr_b16 a[28:29], v47
    v_mfma_f32_16x16x32_bf16 v[196:199], a[76:79], a[44:47], v[196:199]
    ds_read_b64_tr_b16 a[30:31], v47 offset:1536
    v_mfma_f32_16x16x32_bf16 v[200:203], a[76:79], a[48:51], v[200:203]
    ds_read_b128 a[8:11], v37 offset:4096
    v_mfma_f32_16x16x32_bf16 v[204:207], a[76:79], a[52:55], v[204:207]
    ds_read_b64_tr_b16 a[32:33], v48
    v_mfma_f32_16x16x32_bf16 v[208:211], a[76:79], a[56:59], v[208:211]
    s_mov_b32 s38, 768
    s_add_u32 m0, s34, 90112
    s_nop 0
    buffer_load_dwordx4 v24, s[8:11], s38 offen lds
    v_mfma_f32_16x16x32_bf16 v[212:215], a[76:79], a[60:63], v[212:215]
    ds_read_b64_tr_b16 a[34:35], v48 offset:1536
    ds_read_b128 a[12:15], v37 offset:6144
    v_mfma_f32_16x16x32_bf16 v[216:219], a[80:83], a[44:47], v[216:219]
    ds_read_b64_tr_b16 a[36:37], v49
    v_mfma_f32_16x16x32_bf16 v[220:223], a[80:83], a[48:51], v[220:223]
    ds_read_b64_tr_b16 a[38:39], v49 offset:1536
    v_mfma_f32_16x16x32_bf16 v[224:227], a[80:83], a[52:55], v[224:227]
    ds_read_b128 a[16:19], v37 offset:8192
    v_mfma_f32_16x16x32_bf16 v[228:231], a[80:83], a[56:59], v[228:231]
    buffer_load_dwordx4 v25, s[8:11], s38 offen offset:1024 lds
    v_mfma_f32_16x16x32_bf16 v[232:235], a[80:83], a[60:63], v[232:235]
    ds_read_b64_tr_b16 a[40:41], v50
    v_mfma_f32_16x16x32_bf16 v[236:239], a[84:87], a[44:47], v[236:239]
    ds_read_b64_tr_b16 a[42:43], v50 offset:1536
    v_mfma_f32_16x16x32_bf16 v[240:243], a[84:87], a[48:51], v[240:243]
    v_mfma_f32_16x16x32_bf16 v[244:247], a[84:87], a[52:55], v[244:247]
    v_mfma_f32_16x16x32_bf16 v[248:251], a[84:87], a[56:59], v[248:251]
    v_mfma_f32_16x16x32_bf16 v[252:255], a[84:87], a[60:63], v[252:255]
    s_waitcnt lgkmcnt(14)
    v_mfma_f32_16x16x32_bf16 v[136:139], a[20:23], a[0:3], v[136:139]
    ds_read_b64_tr_b16 a[64:65], v45 offset:12288
    s_waitcnt lgkmcnt(12)
    v_mfma_f32_16x16x32_bf16 v[140:143], a[20:23], a[4:7], v[140:143]
    buffer_load_dwordx4 v26, s[8:11], s38 offen offset:2048 lds
    s_waitcnt lgkmcnt(9)
    v_mfma_f32_16x16x32_bf16 v[144:147], a[20:23], a[8:11], v[144:147]
    ds_read_b64_tr_b16 a[66:67], v45 offset:13824
    s_waitcnt lgkmcnt(7)
    v_mfma_f32_16x16x32_bf16 v[148:151], a[20:23], a[12:15], v[148:151]
    ds_read_b128 a[44:47], v38
    s_waitcnt lgkmcnt(5)
    v_mfma_f32_16x16x32_bf16 v[152:155], a[20:23], a[16:19], v[152:155]
    ds_read_b64_tr_b16 a[68:69], v46 offset:12288
    v_mfma_f32_16x16x32_bf16 v[156:159], a[24:27], a[0:3], v[156:159]
    buffer_load_dwordx4 v27, s[8:11], s38 offen offset:3072 lds
    v_mfma_f32_16x16x32_bf16 v[160:163], a[24:27], a[4:7], v[160:163]
    ds_read_b64_tr_b16 a[70:71], v46 offset:13824
    v_mfma_f32_16x16x32_bf16 v[164:167], a[24:27], a[8:11], v[164:167]
    ds_read_b128 a[48:51], v38 offset:2048
    v_mfma_f32_16x16x32_bf16 v[168:171], a[24:27], a[12:15], v[168:171]
    s_add_u32 m0, s34, 94208
    s_nop 0
    buffer_load_dwordx4 v28, s[8:11], s38 offen lds
    v_mfma_f32_16x16x32_bf16 v[172:175], a[24:27], a[16:19], v[172:175]
    ds_read_b64_tr_b16 a[72:73], v47 offset:12288
    v_mfma_f32_16x16x32_bf16 v[176:179], a[28:31], a[0:3], v[176:179]
    ds_read_b64_tr_b16 a[74:75], v47 offset:13824
    v_mfma_f32_16x16x32_bf16 v[180:183], a[28:31], a[4:7], v[180:183]
    ds_read_b128 a[52:55], v38 offset:4096
    v_mfma_f32_16x16x32_bf16 v[184:187], a[28:31], a[8:11], v[184:187]
    s_mov_b32 s39, 4718592
    s_add_u32 m0, s35, 90112
    s_nop 0
    buffer_load_dwordx4 v29, s[12:15], s39 offen lds
    v_mfma_f32_16x16x32_bf16 v[188:191], a[28:31], a[12:15], v[188:191]
    ds_read_b64_tr_b16 a[76:77], v48 offset:12288
    v_mfma_f32_16x16x32_bf16 v[192:195], a[28:31], a[16:19], v[192:195]
    ds_read_b64_tr_b16 a[78:79], v48 offset:13824
    v_mfma_f32_16x16x32_bf16 v[196:199], a[32:35], a[0:3], v[196:199]
    buffer_load_dwordx4 v30, s[12:15], s39 offen offset:1024 lds
    v_mfma_f32_16x16x32_bf16 v[200:203], a[32:35], a[4:7], v[200:203]
    ds_read_b128 a[56:59], v38 offset:6144
    v_mfma_f32_16x16x32_bf16 v[204:207], a[32:35], a[8:11], v[204:207]
    ds_read_b64_tr_b16 a[80:81], v49 offset:12288
    v_mfma_f32_16x16x32_bf16 v[208:211], a[32:35], a[12:15], v[208:211]
    buffer_load_dwordx4 v31, s[12:15], s39 offen offset:2048 lds
    v_mfma_f32_16x16x32_bf16 v[212:215], a[32:35], a[16:19], v[212:215]
    ds_read_b64_tr_b16 a[82:83], v49 offset:13824
    v_mfma_f32_16x16x32_bf16 v[216:219], a[36:39], a[0:3], v[216:219]
    ds_read_b128 a[60:63], v38 offset:8192
    v_mfma_f32_16x16x32_bf16 v[220:223], a[36:39], a[4:7], v[220:223]
    ds_read_b64_tr_b16 a[84:85], v50 offset:12288
    v_mfma_f32_16x16x32_bf16 v[224:227], a[36:39], a[8:11], v[224:227]
    buffer_load_dwordx4 v32, s[12:15], s39 offen offset:3072 lds
    v_mfma_f32_16x16x32_bf16 v[228:231], a[36:39], a[12:15], v[228:231]
    ds_read_b64_tr_b16 a[86:87], v50 offset:13824
    v_mfma_f32_16x16x32_bf16 v[232:235], a[36:39], a[16:19], v[232:235]
    s_waitcnt lgkmcnt(15)
    v_mfma_f32_16x16x32_bf16 v[236:239], a[40:43], a[0:3], v[236:239]
    v_mfma_f32_16x16x32_bf16 v[240:243], a[40:43], a[4:7], v[240:243]
    v_mfma_f32_16x16x32_bf16 v[244:247], a[40:43], a[8:11], v[244:247]
    v_mfma_f32_16x16x32_bf16 v[248:251], a[40:43], a[12:15], v[248:251]
    v_mfma_f32_16x16x32_bf16 v[252:255], a[40:43], a[16:19], v[252:255]
    s_waitcnt lgkmcnt(0)
    s_waitcnt vmcnt(9)
    s_barrier
    v_mfma_f32_16x16x32_bf16 v[136:139], a[64:67], a[44:47], v[136:139]
    v_add_u32 v37, 45056, v35
    v_add_u32 v38, 45056, v36
    v_mfma_f32_16x16x32_bf16 v[140:143], a[64:67], a[48:51], v[140:143]
    v_add_u32 v45, 45056, v39
    v_mfma_f32_16x16x32_bf16 v[144:147], a[64:67], a[52:55], v[144:147]
    s_add_u32 m0, s35, 94208
    s_nop 0
    buffer_load_dwordx4 v33, s[12:15], s39 offen lds
    v_mfma_f32_16x16x32_bf16 v[148:151], a[64:67], a[56:59], v[148:151]
    v_add_u32 v46, 45056, v40
    v_mfma_f32_16x16x32_bf16 v[152:155], a[64:67], a[60:63], v[152:155]
    v_add_u32 v47, 45056, v41
    v_mfma_f32_16x16x32_bf16 v[156:159], a[68:71], a[44:47], v[156:159]
    v_add_u32 v48, 45056, v42
    v_mfma_f32_16x16x32_bf16 v[160:163], a[68:71], a[48:51], v[160:163]
    v_add_u32 v49, 45056, v43
    v_add_u32 v50, 45056, v44
    v_mfma_f32_16x16x32_bf16 v[164:167], a[68:71], a[52:55], v[164:167]
    buffer_load_dwordx4 v34, s[12:15], s39 offen offset:1024 lds
    v_mfma_f32_16x16x32_bf16 v[168:171], a[68:71], a[56:59], v[168:171]
    ds_read_b64_tr_b16 a[20:21], v45
    v_mfma_f32_16x16x32_bf16 v[172:175], a[68:71], a[60:63], v[172:175]
    ds_read_b64_tr_b16 a[22:23], v45 offset:1536
    v_mfma_f32_16x16x32_bf16 v[176:179], a[72:75], a[44:47], v[176:179]
    ds_read_b128 a[0:3], v37
    v_mfma_f32_16x16x32_bf16 v[180:183], a[72:75], a[48:51], v[180:183]
    ds_read_b64_tr_b16 a[24:25], v46
    v_mfma_f32_16x16x32_bf16 v[184:187], a[72:75], a[52:55], v[184:187]
    ds_read_b64_tr_b16 a[26:27], v46 offset:1536
    v_mfma_f32_16x16x32_bf16 v[188:191], a[72:75], a[56:59], v[188:191]
    s_mov_b32 s38, 896
    s_add_u32 m0, s34, 0
    s_nop 0
    buffer_load_dwordx4 v24, s[8:11], s38 offen lds
    ds_read_b128 a[4:7], v37 offset:2048
    v_mfma_f32_16x16x32_bf16 v[192:195], a[72:75], a[60:63], v[192:195]
    ds_read_b64_tr_b16 a[28:29], v47
    v_mfma_f32_16x16x32_bf16 v[196:199], a[76:79], a[44:47], v[196:199]
    ds_read_b64_tr_b16 a[30:31], v47 offset:1536
    v_mfma_f32_16x16x32_bf16 v[200:203], a[76:79], a[48:51], v[200:203]
    ds_read_b128 a[8:11], v37 offset:4096
    v_mfma_f32_16x16x32_bf16 v[204:207], a[76:79], a[52:55], v[204:207]
    ds_read_b64_tr_b16 a[32:33], v48
    v_mfma_f32_16x16x32_bf16 v[208:211], a[76:79], a[56:59], v[208:211]
    buffer_load_dwordx4 v25, s[8:11], s38 offen offset:1024 lds
    v_mfma_f32_16x16x32_bf16 v[212:215], a[76:79], a[60:63], v[212:215]
    ds_read_b64_tr_b16 a[34:35], v48 offset:1536
    ds_read_b128 a[12:15], v37 offset:6144
    v_mfma_f32_16x16x32_bf16 v[216:219], a[80:83], a[44:47], v[216:219]
    ds_read_b64_tr_b16 a[36:37], v49
    v_mfma_f32_16x16x32_bf16 v[220:223], a[80:83], a[48:51], v[220:223]
    ds_read_b64_tr_b16 a[38:39], v49 offset:1536
    v_mfma_f32_16x16x32_bf16 v[224:227], a[80:83], a[52:55], v[224:227]
    ds_read_b128 a[16:19], v37 offset:8192
    v_mfma_f32_16x16x32_bf16 v[228:231], a[80:83], a[56:59], v[228:231]
    buffer_load_dwordx4 v26, s[8:11], s38 offen offset:2048 lds
    v_mfma_f32_16x16x32_bf16 v[232:235], a[80:83], a[60:63], v[232:235]
    ds_read_b64_tr_b16 a[40:41], v50
    v_mfma_f32_16x16x32_bf16 v[236:239], a[84:87], a[44:47], v[236:239]
    ds_read_b64_tr_b16 a[42:43], v50 offset:1536
    v_mfma_f32_16x16x32_bf16 v[240:243], a[84:87], a[48:51], v[240:243]
    v_mfma_f32_16x16x32_bf16 v[244:247], a[84:87], a[52:55], v[244:247]
    v_mfma_f32_16x16x32_bf16 v[248:251], a[84:87], a[56:59], v[248:251]
    v_mfma_f32_16x16x32_bf16 v[252:255], a[84:87], a[60:63], v[252:255]
    s_waitcnt lgkmcnt(14)
    v_mfma_f32_16x16x32_bf16 v[136:139], a[20:23], a[0:3], v[136:139]
    ds_read_b64_tr_b16 a[64:65], v45 offset:12288
    s_waitcnt lgkmcnt(12)
    v_mfma_f32_16x16x32_bf16 v[140:143], a[20:23], a[4:7], v[140:143]
    buffer_load_dwordx4 v27, s[8:11], s38 offen offset:3072 lds
    s_waitcnt lgkmcnt(9)
    v_mfma_f32_16x16x32_bf16 v[144:147], a[20:23], a[8:11], v[144:147]
    ds_read_b64_tr_b16 a[66:67], v45 offset:13824
    s_waitcnt lgkmcnt(7)
    v_mfma_f32_16x16x32_bf16 v[148:151], a[20:23], a[12:15], v[148:151]
    ds_read_b128 a[44:47], v38
    s_waitcnt lgkmcnt(5)
    v_mfma_f32_16x16x32_bf16 v[152:155], a[20:23], a[16:19], v[152:155]
    ds_read_b64_tr_b16 a[68:69], v46 offset:12288
    v_mfma_f32_16x16x32_bf16 v[156:159], a[24:27], a[0:3], v[156:159]
    s_add_u32 m0, s34, 4096
    s_nop 0
    buffer_load_dwordx4 v28, s[8:11], s38 offen lds
    v_mfma_f32_16x16x32_bf16 v[160:163], a[24:27], a[4:7], v[160:163]
    ds_read_b64_tr_b16 a[70:71], v46 offset:13824
    v_mfma_f32_16x16x32_bf16 v[164:167], a[24:27], a[8:11], v[164:167]
    ds_read_b128 a[48:51], v38 offset:2048
    v_mfma_f32_16x16x32_bf16 v[168:171], a[24:27], a[12:15], v[168:171]
    s_mov_b32 s39, 5505024
    s_add_u32 m0, s35, 0
    s_nop 0
    buffer_load_dwordx4 v29, s[12:15], s39 offen lds
    v_mfma_f32_16x16x32_bf16 v[172:175], a[24:27], a[16:19], v[172:175]
    ds_read_b64_tr_b16 a[72:73], v47 offset:12288
    v_mfma_f32_16x16x32_bf16 v[176:179], a[28:31], a[0:3], v[176:179]
    ds_read_b64_tr_b16 a[74:75], v47 offset:13824
    v_mfma_f32_16x16x32_bf16 v[180:183], a[28:31], a[4:7], v[180:183]
    ds_read_b128 a[52:55], v38 offset:4096
    v_mfma_f32_16x16x32_bf16 v[184:187], a[28:31], a[8:11], v[184:187]
    buffer_load_dwordx4 v30, s[12:15], s39 offen offset:1024 lds
    v_mfma_f32_16x16x32_bf16 v[188:191], a[28:31], a[12:15], v[188:191]
    ds_read_b64_tr_b16 a[76:77], v48 offset:12288
    v_mfma_f32_16x16x32_bf16 v[192:195], a[28:31], a[16:19], v[192:195]
    ds_read_b64_tr_b16 a[78:79], v48 offset:13824
    v_mfma_f32_16x16x32_bf16 v[196:199], a[32:35], a[0:3], v[196:199]
    buffer_load_dwordx4 v31, s[12:15], s39 offen offset:2048 lds
    v_mfma_f32_16x16x32_bf16 v[200:203], a[32:35], a[4:7], v[200:203]
    ds_read_b128 a[56:59], v38 offset:6144
    v_mfma_f32_16x16x32_bf16 v[204:207], a[32:35], a[8:11], v[204:207]
    ds_read_b64_tr_b16 a[80:81], v49 offset:12288
    v_mfma_f32_16x16x32_bf16 v[208:211], a[32:35], a[12:15], v[208:211]
    buffer_load_dwordx4 v32, s[12:15], s39 offen offset:3072 lds
    v_mfma_f32_16x16x32_bf16 v[212:215], a[32:35], a[16:19], v[212:215]
    ds_read_b64_tr_b16 a[82:83], v49 offset:13824
    v_mfma_f32_16x16x32_bf16 v[216:219], a[36:39], a[0:3], v[216:219]
    ds_read_b128 a[60:63], v38 offset:8192
    v_mfma_f32_16x16x32_bf16 v[220:223], a[36:39], a[4:7], v[220:223]
    ds_read_b64_tr_b16 a[84:85], v50 offset:12288
    v_mfma_f32_16x16x32_bf16 v[224:227], a[36:39], a[8:11], v[224:227]
    s_add_u32 m0, s35, 4096
    s_nop 0
    buffer_load_dwordx4 v33, s[12:15], s39 offen lds
    v_mfma_f32_16x16x32_bf16 v[228:231], a[36:39], a[12:15], v[228:231]
    ds_read_b64_tr_b16 a[86:87], v50 offset:13824
    v_mfma_f32_16x16x32_bf16 v[232:235], a[36:39], a[16:19], v[232:235]
    s_waitcnt lgkmcnt(15)
    v_mfma_f32_16x16x32_bf16 v[236:239], a[40:43], a[0:3], v[236:239]
    v_mfma_f32_16x16x32_bf16 v[240:243], a[40:43], a[4:7], v[240:243]
    v_mfma_f32_16x16x32_bf16 v[244:247], a[40:43], a[8:11], v[244:247]
    v_mfma_f32_16x16x32_bf16 v[248:251], a[40:43], a[12:15], v[248:251]
    v_mfma_f32_16x16x32_bf16 v[252:255], a[40:43], a[16:19], v[252:255]
    s_waitcnt lgkmcnt(0)
    s_waitcnt vmcnt(10)
    s_barrier
    v_mfma_f32_16x16x32_bf16 v[136:139], a[64:67], a[44:47], v[136:139]
    v_add_u32 v37, 90112, v35
    v_add_u32 v38, 90112, v36
    v_mfma_f32_16x16x32_bf16 v[140:143], a[64:67], a[48:51], v[140:143]
    v_add_u32 v45, 90112, v39
    v_mfma_f32_16x16x32_bf16 v[144:147], a[64:67], a[52:55], v[144:147]
    buffer_load_dwordx4 v34, s[12:15], s39 offen offset:1024 lds
    v_mfma_f32_16x16x32_bf16 v[148:151], a[64:67], a[56:59], v[148:151]
    v_add_u32 v46, 90112, v40
    v_mfma_f32_16x16x32_bf16 v[152:155], a[64:67], a[60:63], v[152:155]
    v_add_u32 v47, 90112, v41
    v_mfma_f32_16x16x32_bf16 v[156:159], a[68:71], a[44:47], v[156:159]
    v_add_u32 v48, 90112, v42
    v_mfma_f32_16x16x32_bf16 v[160:163], a[68:71], a[48:51], v[160:163]
    v_add_u32 v49, 90112, v43
    v_add_u32 v50, 90112, v44
    v_mfma_f32_16x16x32_bf16 v[164:167], a[68:71], a[52:55], v[164:167]
    s_mov_b32 s38, 1024
    s_add_u32 m0, s34, 45056
    s_nop 0
    buffer_load_dwordx4 v24, s[8:11], s38 offen lds
    v_mfma_f32_16x16x32_bf16 v[168:171], a[68:71], a[56:59], v[168:171]
    ds_read_b64_tr_b16 a[20:21], v45
    v_mfma_f32_16x16x32_bf16 v[172:175], a[68:71], a[60:63], v[172:175]
    ds_read_b64_tr_b16 a[22:23], v45 offset:1536
    v_mfma_f32_16x16x32_bf16 v[176:179], a[72:75], a[44:47], v[176:179]
    ds_read_b128 a[0:3], v37
    v_mfma_f32_16x16x32_bf16 v[180:183], a[72:75], a[48:51], v[180:183]
    ds_read_b64_tr_b16 a[24:25], v46
    v_mfma_f32_16x16x32_bf16 v[184:187], a[72:75], a[52:55], v[184:187]
    ds_read_b64_tr_b16 a[26:27], v46 offset:1536
    v_mfma_f32_16x16x32_bf16 v[188:191], a[72:75], a[56:59], v[188:191]
    buffer_load_dwordx4 v25, s[8:11], s38 offen offset:1024 lds
    ds_read_b128 a[4:7], v37 offset:2048
    v_mfma_f32_16x16x32_bf16 v[192:195], a[72:75], a[60:63], v[192:195]
    ds_read_b64_tr_b16 a[28:29], v47
    v_mfma_f32_16x16x32_bf16 v[196:199], a[76:79], a[44:47], v[196:199]
    ds_read_b64_tr_b16 a[30:31], v47 offset:1536
    v_mfma_f32_16x16x32_bf16 v[200:203], a[76:79], a[48:51], v[200:203]
    ds_read_b128 a[8:11], v37 offset:4096
    v_mfma_f32_16x16x32_bf16 v[204:207], a[76:79], a[52:55], v[204:207]
    ds_read_b64_tr_b16 a[32:33], v48
    v_mfma_f32_16x16x32_bf16 v[208:211], a[76:79], a[56:59], v[208:211]
    buffer_load_dwordx4 v26, s[8:11], s38 offen offset:2048 lds
    v_mfma_f32_16x16x32_bf16 v[212:215], a[76:79], a[60:63], v[212:215]
    ds_read_b64_tr_b16 a[34:35], v48 offset:1536
    ds_read_b128 a[12:15], v37 offset:6144
    v_mfma_f32_16x16x32_bf16 v[216:219], a[80:83], a[44:47], v[216:219]
    ds_read_b64_tr_b16 a[36:37], v49
    v_mfma_f32_16x16x32_bf16 v[220:223], a[80:83], a[48:51], v[220:223]
    ds_read_b64_tr_b16 a[38:39], v49 offset:1536
    v_mfma_f32_16x16x32_bf16 v[224:227], a[80:83], a[52:55], v[224:227]
    ds_read_b128 a[16:19], v37 offset:8192
    v_mfma_f32_16x16x32_bf16 v[228:231], a[80:83], a[56:59], v[228:231]
    buffer_load_dwordx4 v27, s[8:11], s38 offen offset:3072 lds
    v_mfma_f32_16x16x32_bf16 v[232:235], a[80:83], a[60:63], v[232:235]
    ds_read_b64_tr_b16 a[40:41], v50
    v_mfma_f32_16x16x32_bf16 v[236:239], a[84:87], a[44:47], v[236:239]
    ds_read_b64_tr_b16 a[42:43], v50 offset:1536
    v_mfma_f32_16x16x32_bf16 v[240:243], a[84:87], a[48:51], v[240:243]
    v_mfma_f32_16x16x32_bf16 v[244:247], a[84:87], a[52:55], v[244:247]
    v_mfma_f32_16x16x32_bf16 v[248:251], a[84:87], a[56:59], v[248:251]
    v_mfma_f32_16x16x32_bf16 v[252:255], a[84:87], a[60:63], v[252:255]
    s_waitcnt lgkmcnt(14)
    v_mfma_f32_16x16x32_bf16 v[136:139], a[20:23], a[0:3], v[136:139]
    ds_read_b64_tr_b16 a[64:65], v45 offset:12288
    s_waitcnt lgkmcnt(12)
    v_mfma_f32_16x16x32_bf16 v[140:143], a[20:23], a[4:7], v[140:143]
    s_add_u32 m0, s34, 49152
    s_nop 0
    buffer_load_dwordx4 v28, s[8:11], s38 offen lds
    s_waitcnt lgkmcnt(9)
    v_mfma_f32_16x16x32_bf16 v[144:147], a[20:23], a[8:11], v[144:147]
    ds_read_b64_tr_b16 a[66:67], v45 offset:13824
    s_waitcnt lgkmcnt(7)
    v_mfma_f32_16x16x32_bf16 v[148:151], a[20:23], a[12:15], v[148:151]
    ds_read_b128 a[44:47], v38
    s_waitcnt lgkmcnt(5)
    v_mfma_f32_16x16x32_bf16 v[152:155], a[20:23], a[16:19], v[152:155]
    ds_read_b64_tr_b16 a[68:69], v46 offset:12288
    v_mfma_f32_16x16x32_bf16 v[156:159], a[24:27], a[0:3], v[156:159]
    s_mov_b32 s39, 6291456
    s_add_u32 m0, s35, 45056
    s_nop 0
    buffer_load_dwordx4 v29, s[12:15], s39 offen lds
    v_mfma_f32_16x16x32_bf16 v[160:163], a[24:27], a[4:7], v[160:163]
    ds_read_b64_tr_b16 a[70:71], v46 offset:13824
    v_mfma_f32_16x16x32_bf16 v[164:167], a[24:27], a[8:11], v[164:167]
    ds_read_b128 a[48:51], v38 offset:2048
    v_mfma_f32_16x16x32_bf16 v[168:171], a[24:27], a[12:15], v[168:171]
    buffer_load_dwordx4 v30, s[12:15], s39 offen offset:1024 lds
    v_mfma_f32_16x16x32_bf16 v[172:175], a[24:27], a[16:19], v[172:175]
    ds_read_b64_tr_b16 a[72:73], v47 offset:12288
    v_mfma_f32_16x16x32_bf16 v[176:179], a[28:31], a[0:3], v[176:179]
    ds_read_b64_tr_b16 a[74:75], v47 offset:13824
    v_mfma_f32_16x16x32_bf16 v[180:183], a[28:31], a[4:7], v[180:183]
    ds_read_b128 a[52:55], v38 offset:4096
    v_mfma_f32_16x16x32_bf16 v[184:187], a[28:31], a[8:11], v[184:187]
    buffer_load_dwordx4 v31, s[12:15], s39 offen offset:2048 lds
    v_mfma_f32_16x16x32_bf16 v[188:191], a[28:31], a[12:15], v[188:191]
    ds_read_b64_tr_b16 a[76:77], v48 offset:12288
    v_mfma_f32_16x16x32_bf16 v[192:195], a[28:31], a[16:19], v[192:195]
    ds_read_b64_tr_b16 a[78:79], v48 offset:13824
    v_mfma_f32_16x16x32_bf16 v[196:199], a[32:35], a[0:3], v[196:199]
    buffer_load_dwordx4 v32, s[12:15], s39 offen offset:3072 lds
    v_mfma_f32_16x16x32_bf16 v[200:203], a[32:35], a[4:7], v[200:203]
    ds_read_b128 a[56:59], v38 offset:6144
    v_mfma_f32_16x16x32_bf16 v[204:207], a[32:35], a[8:11], v[204:207]
    ds_read_b64_tr_b16 a[80:81], v49 offset:12288
    v_mfma_f32_16x16x32_bf16 v[208:211], a[32:35], a[12:15], v[208:211]
    s_add_u32 m0, s35, 49152
    s_nop 0
    buffer_load_dwordx4 v33, s[12:15], s39 offen lds
    v_mfma_f32_16x16x32_bf16 v[212:215], a[32:35], a[16:19], v[212:215]
    ds_read_b64_tr_b16 a[82:83], v49 offset:13824
    v_mfma_f32_16x16x32_bf16 v[216:219], a[36:39], a[0:3], v[216:219]
    ds_read_b128 a[60:63], v38 offset:8192
    v_mfma_f32_16x16x32_bf16 v[220:223], a[36:39], a[4:7], v[220:223]
    ds_read_b64_tr_b16 a[84:85], v50 offset:12288
    v_mfma_f32_16x16x32_bf16 v[224:227], a[36:39], a[8:11], v[224:227]
    buffer_load_dwordx4 v34, s[12:15], s39 offen offset:1024 lds
    v_mfma_f32_16x16x32_bf16 v[228:231], a[36:39], a[12:15], v[228:231]
    ds_read_b64_tr_b16 a[86:87], v50 offset:13824
    v_mfma_f32_16x16x32_bf16 v[232:235], a[36:39], a[16:19], v[232:235]
    s_waitcnt lgkmcnt(15)
    v_mfma_f32_16x16x32_bf16 v[236:239], a[40:43], a[0:3], v[236:239]
    v_mfma_f32_16x16x32_bf16 v[240:243], a[40:43], a[4:7], v[240:243]
    v_mfma_f32_16x16x32_bf16 v[244:247], a[40:43], a[8:11], v[244:247]
    v_mfma_f32_16x16x32_bf16 v[248:251], a[40:43], a[12:15], v[248:251]
    v_mfma_f32_16x16x32_bf16 v[252:255], a[40:43], a[16:19], v[252:255]
    s_waitcnt lgkmcnt(0)
    s_waitcnt vmcnt(11)
    s_barrier
    v_mfma_f32_16x16x32_bf16 v[136:139], a[64:67], a[44:47], v[136:139]
    v_add_u32 v37, 0, v35
    v_add_u32 v38, 0, v36
    v_mfma_f32_16x16x32_bf16 v[140:143], a[64:67], a[48:51], v[140:143]
    v_add_u32 v45, 0, v39
    v_mfma_f32_16x16x32_bf16 v[144:147], a[64:67], a[52:55], v[144:147]
    s_mov_b32 s40, 0
    s_add_u32 m0, s36, 135168
    s_nop 0
    buffer_load_dwordx4 v2, s[16:19], s40 offen nt lds
    v_mfma_f32_16x16x32_bf16 v[148:151], a[64:67], a[56:59], v[148:151]
    v_add_u32 v46, 0, v40
    v_mfma_f32_16x16x32_bf16 v[152:155], a[64:67], a[60:63], v[152:155]
    v_add_u32 v47, 0, v41
    v_mfma_f32_16x16x32_bf16 v[156:159], a[68:71], a[44:47], v[156:159]
    v_add_u32 v48, 0, v42
    v_mfma_f32_16x16x32_bf16 v[160:163], a[68:71], a[48:51], v[160:163]
    v_add_u32 v49, 0, v43
    v_add_u32 v50, 0, v44
    v_mfma_f32_16x16x32_bf16 v[164:167], a[68:71], a[52:55], v[164:167]
    buffer_load_dwordx4 v3, s[16:19], s40 offen offset:1024 nt lds
    v_mfma_f32_16x16x32_bf16 v[168:171], a[68:71], a[56:59], v[168:171]
    ds_read_b64_tr_b16 a[20:21], v45
    v_mfma_f32_16x16x32_bf16 v[172:175], a[68:71], a[60:63], v[172:175]
    ds_read_b64_tr_b16 a[22:23], v45 offset:1536
    v_mfma_f32_16x16x32_bf16 v[176:179], a[72:75], a[44:47], v[176:179]
    ds_read_b128 a[0:3], v37
    v_mfma_f32_16x16x32_bf16 v[180:183], a[72:75], a[48:51], v[180:183]
    ds_read_b64_tr_b16 a[24:25], v46
    v_mfma_f32_16x16x32_bf16 v[184:187], a[72:75], a[52:55], v[184:187]
    ds_read_b64_tr_b16 a[26:27], v46 offset:1536
    v_mfma_f32_16x16x32_bf16 v[188:191], a[72:75], a[56:59], v[188:191]
    buffer_load_dwordx4 v4, s[16:19], s40 offen offset:2048 nt lds
    ds_read_b128 a[4:7], v37 offset:2048
    v_mfma_f32_16x16x32_bf16 v[192:195], a[72:75], a[60:63], v[192:195]
    ds_read_b64_tr_b16 a[28:29], v47
    v_mfma_f32_16x16x32_bf16 v[196:199], a[76:79], a[44:47], v[196:199]
    ds_read_b64_tr_b16 a[30:31], v47 offset:1536
    v_mfma_f32_16x16x32_bf16 v[200:203], a[76:79], a[48:51], v[200:203]
    ds_read_b128 a[8:11], v37 offset:4096
    v_mfma_f32_16x16x32_bf16 v[204:207], a[76:79], a[52:55], v[204:207]
    ds_read_b64_tr_b16 a[32:33], v48
    v_mfma_f32_16x16x32_bf16 v[208:211], a[76:79], a[56:59], v[208:211]
    s_mov_b32 s40, 12288
    s_add_u32 m0, s36, 147456
    s_nop 0
    buffer_load_dwordx4 v2, s[16:19], s40 offen nt lds
    v_mfma_f32_16x16x32_bf16 v[212:215], a[76:79], a[60:63], v[212:215]
    ds_read_b64_tr_b16 a[34:35], v48 offset:1536
    ds_read_b128 a[12:15], v37 offset:6144
    v_mfma_f32_16x16x32_bf16 v[216:219], a[80:83], a[44:47], v[216:219]
    ds_read_b64_tr_b16 a[36:37], v49
    v_mfma_f32_16x16x32_bf16 v[220:223], a[80:83], a[48:51], v[220:223]
    ds_read_b64_tr_b16 a[38:39], v49 offset:1536
    v_mfma_f32_16x16x32_bf16 v[224:227], a[80:83], a[52:55], v[224:227]
    ds_read_b128 a[16:19], v37 offset:8192
    v_mfma_f32_16x16x32_bf16 v[228:231], a[80:83], a[56:59], v[228:231]
    buffer_load_dwordx4 v3, s[16:19], s40 offen offset:1024 nt lds
    v_mfma_f32_16x16x32_bf16 v[232:235], a[80:83], a[60:63], v[232:235]
    ds_read_b64_tr_b16 a[40:41], v50
    v_mfma_f32_16x16x32_bf16 v[236:239], a[84:87], a[44:47], v[236:239]
    ds_read_b64_tr_b16 a[42:43], v50 offset:1536
    v_mfma_f32_16x16x32_bf16 v[240:243], a[84:87], a[48:51], v[240:243]
    v_mfma_f32_16x16x32_bf16 v[244:247], a[84:87], a[52:55], v[244:247]
    v_mfma_f32_16x16x32_bf16 v[248:251], a[84:87], a[56:59], v[248:251]
    v_mfma_f32_16x16x32_bf16 v[252:255], a[84:87], a[60:63], v[252:255]
    s_waitcnt lgkmcnt(14)
    v_mfma_f32_16x16x32_bf16 v[136:139], a[20:23], a[0:3], v[136:139]
    ds_read_b64_tr_b16 a[64:65], v45 offset:12288
    s_waitcnt lgkmcnt(12)
    v_mfma_f32_16x16x32_bf16 v[140:143], a[20:23], a[4:7], v[140:143]
    buffer_load_dwordx4 v4, s[16:19], s40 offen offset:2048 nt lds
    s_waitcnt lgkmcnt(9)
    v_mfma_f32_16x16x32_bf16 v[144:147], a[20:23], a[8:11], v[144:147]
    ds_read_b64_tr_b16 a[66:67], v45 offset:13824
    s_waitcnt lgkmcnt(7)
    v_mfma_f32_16x16x32_bf16 v[148:151], a[20:23], a[12:15], v[148:151]
    ds_read_b128 a[44:47], v38
    s_waitcnt lgkmcnt(5)
    v_mfma_f32_16x16x32_bf16 v[152:155], a[20:23], a[16:19], v[152:155]
    ds_read_b64_tr_b16 a[68:69], v46 offset:12288
    v_mfma_f32_16x16x32_bf16 v[156:159], a[24:27], a[0:3], v[156:159]
    s_mov_b32 s38, 1152
    s_add_u32 m0, s34, 90112
    s_nop 0
    buffer_load_dwordx4 v24, s[8:11], s38 offen lds
    v_mfma_f32_16x16x32_bf16 v[160:163], a[24:27], a[4:7], v[160:163]
    ds_read_b64_tr_b16 a[70:71], v46 offset:13824
    v_mfma_f32_16x16x32_bf16 v[164:167], a[24:27], a[8:11], v[164:167]
    ds_read_b128 a[48:51], v38 offset:2048
    v_mfma_f32_16x16x32_bf16 v[168:171], a[24:27], a[12:15], v[168:171]
    buffer_load_dwordx4 v25, s[8:11], s38 offen offset:1024 lds
    v_mfma_f32_16x16x32_bf16 v[172:175], a[24:27], a[16:19], v[172:175]
    ds_read_b64_tr_b16 a[72:73], v47 offset:12288
    v_mfma_f32_16x16x32_bf16 v[176:179], a[28:31], a[0:3], v[176:179]
    ds_read_b64_tr_b16 a[74:75], v47 offset:13824
    v_mfma_f32_16x16x32_bf16 v[180:183], a[28:31], a[4:7], v[180:183]
    ds_read_b128 a[52:55], v38 offset:4096
    v_mfma_f32_16x16x32_bf16 v[184:187], a[28:31], a[8:11], v[184:187]
    buffer_load_dwordx4 v26, s[8:11], s38 offen offset:2048 lds
    v_mfma_f32_16x16x32_bf16 v[188:191], a[28:31], a[12:15], v[188:191]
    ds_read_b64_tr_b16 a[76:77], v48 offset:12288
    v_mfma_f32_16x16x32_bf16 v[192:195], a[28:31], a[16:19], v[192:195]
    ds_read_b64_tr_b16 a[78:79], v48 offset:13824
    v_mfma_f32_16x16x32_bf16 v[196:199], a[32:35], a[0:3], v[196:199]
    buffer_load_dwordx4 v27, s[8:11], s38 offen offset:3072 lds
    v_mfma_f32_16x16x32_bf16 v[200:203], a[32:35], a[4:7], v[200:203]
    ds_read_b128 a[56:59], v38 offset:6144
    v_mfma_f32_16x16x32_bf16 v[204:207], a[32:35], a[8:11], v[204:207]
    ds_read_b64_tr_b16 a[80:81], v49 offset:12288
    v_mfma_f32_16x16x32_bf16 v[208:211], a[32:35], a[12:15], v[208:211]
    s_add_u32 m0, s34, 94208
    s_nop 0
    buffer_load_dwordx4 v28, s[8:11], s38 offen lds
    v_mfma_f32_16x16x32_bf16 v[212:215], a[32:35], a[16:19], v[212:215]
    ds_read_b64_tr_b16 a[82:83], v49 offset:13824
    v_mfma_f32_16x16x32_bf16 v[216:219], a[36:39], a[0:3], v[216:219]
    ds_read_b128 a[60:63], v38 offset:8192
    v_mfma_f32_16x16x32_bf16 v[220:223], a[36:39], a[4:7], v[220:223]
    ds_read_b64_tr_b16 a[84:85], v50 offset:12288
    v_mfma_f32_16x16x32_bf16 v[224:227], a[36:39], a[8:11], v[224:227]
    s_mov_b32 s39, 7077888
    s_add_u32 m0, s35, 90112
    s_nop 0
    buffer_load_dwordx4 v29, s[12:15], s39 offen lds
    v_mfma_f32_16x16x32_bf16 v[228:231], a[36:39], a[12:15], v[228:231]
    ds_read_b64_tr_b16 a[86:87], v50 offset:13824
    v_mfma_f32_16x16x32_bf16 v[232:235], a[36:39], a[16:19], v[232:235]
    s_waitcnt lgkmcnt(15)
    v_mfma_f32_16x16x32_bf16 v[236:239], a[40:43], a[0:3], v[236:239]
    v_mfma_f32_16x16x32_bf16 v[240:243], a[40:43], a[4:7], v[240:243]
    v_mfma_f32_16x16x32_bf16 v[244:247], a[40:43], a[8:11], v[244:247]
    v_mfma_f32_16x16x32_bf16 v[248:251], a[40:43], a[12:15], v[248:251]
    v_mfma_f32_16x16x32_bf16 v[252:255], a[40:43], a[16:19], v[252:255]
    s_waitcnt lgkmcnt(0)
    s_waitcnt vmcnt(12)
    s_barrier
    v_mfma_f32_16x16x32_bf16 v[136:139], a[64:67], a[44:47], v[136:139]
    v_add_u32 v37, 45056, v35
    v_add_u32 v38, 45056, v36
    v_mfma_f32_16x16x32_bf16 v[140:143], a[64:67], a[48:51], v[140:143]
    v_add_u32 v45, 45056, v39
    v_mfma_f32_16x16x32_bf16 v[144:147], a[64:67], a[52:55], v[144:147]
    buffer_load_dwordx4 v30, s[12:15], s39 offen offset:1024 lds
    v_mfma_f32_16x16x32_bf16 v[148:151], a[64:67], a[56:59], v[148:151]
    v_add_u32 v46, 45056, v40
    v_mfma_f32_16x16x32_bf16 v[152:155], a[64:67], a[60:63], v[152:155]
    v_add_u32 v47, 45056, v41
    v_mfma_f32_16x16x32_bf16 v[156:159], a[68:71], a[44:47], v[156:159]
    v_add_u32 v48, 45056, v42
    v_mfma_f32_16x16x32_bf16 v[160:163], a[68:71], a[48:51], v[160:163]
    v_add_u32 v49, 45056, v43
    v_add_u32 v50, 45056, v44
    v_mfma_f32_16x16x32_bf16 v[164:167], a[68:71], a[52:55], v[164:167]
    buffer_load_dwordx4 v31, s[12:15], s39 offen offset:2048 lds
    v_mfma_f32_16x16x32_bf16 v[168:171], a[68:71], a[56:59], v[168:171]
    ds_read_b64_tr_b16 a[20:21], v45
    v_mfma_f32_16x16x32_bf16 v[172:175], a[68:71], a[60:63], v[172:175]
    ds_read_b64_tr_b16 a[22:23], v45 offset:1536
    v_mfma_f32_16x16x32_bf16 v[176:179], a[72:75], a[44:47], v[176:179]
    ds_read_b128 a[0:3], v37
    v_mfma_f32_16x16x32_bf16 v[180:183], a[72:75], a[48:51], v[180:183]
    ds_read_b64_tr_b16 a[24:25], v46
    v_mfma_f32_16x16x32_bf16 v[184:187], a[72:75], a[52:55], v[184:187]
    ds_read_b64_tr_b16 a[26:27], v46 offset:1536
    v_mfma_f32_16x16x32_bf16 v[188:191], a[72:75], a[56:59], v[188:191]
    buffer_load_dwordx4 v32, s[12:15], s39 offen offset:3072 lds
    ds_read_b128 a[4:7], v37 offset:2048
    v_mfma_f32_16x16x32_bf16 v[192:195], a[72:75], a[60:63], v[192:195]
    ds_read_b64_tr_b16 a[28:29], v47
    v_mfma_f32_16x16x32_bf16 v[196:199], a[76:79], a[44:47], v[196:199]
    ds_read_b64_tr_b16 a[30:31], v47 offset:1536
    v_mfma_f32_16x16x32_bf16 v[200:203], a[76:79], a[48:51], v[200:203]
    ds_read_b128 a[8:11], v37 offset:4096
    v_mfma_f32_16x16x32_bf16 v[204:207], a[76:79], a[52:55], v[204:207]
    ds_read_b64_tr_b16 a[32:33], v48
    v_mfma_f32_16x16x32_bf16 v[208:211], a[76:79], a[56:59], v[208:211]
    s_add_u32 m0, s35, 94208
    s_nop 0
    buffer_load_dwordx4 v33, s[12:15], s39 offen lds
    v_mfma_f32_16x16x32_bf16 v[212:215], a[76:79], a[60:63], v[212:215]
    ds_read_b64_tr_b16 a[34:35], v48 offset:1536
    ds_read_b128 a[12:15], v37 offset:6144
    v_mfma_f32_16x16x32_bf16 v[216:219], a[80:83], a[44:47], v[216:219]
    ds_read_b64_tr_b16 a[36:37], v49
    v_mfma_f32_16x16x32_bf16 v[220:223], a[80:83], a[48:51], v[220:223]
    ds_read_b64_tr_b16 a[38:39], v49 offset:1536
    v_mfma_f32_16x16x32_bf16 v[224:227], a[80:83], a[52:55], v[224:227]
    ds_read_b128 a[16:19], v37 offset:8192
    v_mfma_f32_16x16x32_bf16 v[228:231], a[80:83], a[56:59], v[228:231]
    buffer_load_dwordx4 v34, s[12:15], s39 offen offset:1024 lds
    v_mfma_f32_16x16x32_bf16 v[232:235], a[80:83], a[60:63], v[232:235]
    ds_read_b64_tr_b16 a[40:41], v50
    v_mfma_f32_16x16x32_bf16 v[236:239], a[84:87], a[44:47], v[236:239]
    ds_read_b64_tr_b16 a[42:43], v50 offset:1536
    v_mfma_f32_16x16x32_bf16 v[240:243], a[84:87], a[48:51], v[240:243]
    v_mfma_f32_16x16x32_bf16 v[244:247], a[84:87], a[52:55], v[244:247]
    v_mfma_f32_16x16x32_bf16 v[248:251], a[84:87], a[56:59], v[248:251]
    v_mfma_f32_16x16x32_bf16 v[252:255], a[84:87], a[60:63], v[252:255]
    s_waitcnt lgkmcnt(14)
    v_mfma_f32_16x16x32_bf16 v[136:139], a[20:23], a[0:3], v[136:139]
    ds_read_b64_tr_b16 a[64:65], v45 offset:12288
    s_waitcnt lgkmcnt(12)
    v_mfma_f32_16x16x32_bf16 v[140:143], a[20:23], a[4:7], v[140:143]
    buffer_atomic_add v115, v114, s[60:63], 0 offen
    s_waitcnt lgkmcnt(9)
    v_mfma_f32_16x16x32_bf16 v[144:147], a[20:23], a[8:11], v[144:147]
    ds_read_b64_tr_b16 a[66:67], v45 offset:13824
    s_waitcnt lgkmcnt(7)
    v_mfma_f32_16x16x32_bf16 v[148:151], a[20:23], a[12:15], v[148:151]
    ds_read_b128 a[44:47], v38
    s_waitcnt lgkmcnt(5)
    v_mfma_f32_16x16x32_bf16 v[152:155], a[20:23], a[16:19], v[152:155]
    ds_read_b64_tr_b16 a[68:69], v46 offset:12288
    v_mfma_f32_16x16x32_bf16 v[156:159], a[24:27], a[0:3], v[156:159]
    s_mov_b32 s40, 24576
    s_add_u32 m0, s36, 0
    s_nop 0
    buffer_load_dwordx4 v2, s[16:19], s40 offen nt lds
    v_mfma_f32_16x16x32_bf16 v[160:163], a[24:27], a[4:7], v[160:163]
    ds_read_b64_tr_b16 a[70:71], v46 offset:13824
    v_mfma_f32_16x16x32_bf16 v[164:167], a[24:27], a[8:11], v[164:167]
    ds_read_b128 a[48:51], v38 offset:2048
    v_mfma_f32_16x16x32_bf16 v[168:171], a[24:27], a[12:15], v[168:171]
    v_mfma_f32_16x16x32_bf16 v[172:175], a[24:27], a[16:19], v[172:175]
    ds_read_b64_tr_b16 a[72:73], v47 offset:12288
    v_mfma_f32_16x16x32_bf16 v[176:179], a[28:31], a[0:3], v[176:179]
    ds_read_b64_tr_b16 a[74:75], v47 offset:13824
    v_mfma_f32_16x16x32_bf16 v[180:183], a[28:31], a[4:7], v[180:183]
    ds_read_b128 a[52:55], v38 offset:4096
    v_mfma_f32_16x16x32_bf16 v[184:187], a[28:31], a[8:11], v[184:187]
    buffer_load_dwordx4 v3, s[16:19], s40 offen offset:1024 nt lds
    v_mfma_f32_16x16x32_bf16 v[188:191], a[28:31], a[12:15], v[188:191]
    ds_read_b64_tr_b16 a[76:77], v48 offset:12288
    v_mfma_f32_16x16x32_bf16 v[192:195], a[28:31], a[16:19], v[192:195]
    ds_read_b64_tr_b16 a[78:79], v48 offset:13824
    v_mfma_f32_16x16x32_bf16 v[196:199], a[32:35], a[0:3], v[196:199]
    buffer_load_dwordx4 v4, s[16:19], s40 offen offset:2048 nt lds
    v_mfma_f32_16x16x32_bf16 v[200:203], a[32:35], a[4:7], v[200:203]
    ds_read_b128 a[56:59], v38 offset:6144
    v_mfma_f32_16x16x32_bf16 v[204:207], a[32:35], a[8:11], v[204:207]
    ds_read_b64_tr_b16 a[80:81], v49 offset:12288
    v_mfma_f32_16x16x32_bf16 v[208:211], a[32:35], a[12:15], v[208:211]
    s_mov_b32 s40, 36864
    s_add_u32 m0, s36, 12288
    s_nop 0
    buffer_load_dwordx4 v2, s[16:19], s40 offen nt lds
    v_mfma_f32_16x16x32_bf16 v[212:215], a[32:35], a[16:19], v[212:215]
    ds_read_b64_tr_b16 a[82:83], v49 offset:13824
    v_mfma_f32_16x16x32_bf16 v[216:219], a[36:39], a[0:3], v[216:219]
    ds_read_b128 a[60:63], v38 offset:8192
    v_mfma_f32_16x16x32_bf16 v[220:223], a[36:39], a[4:7], v[220:223]
    ds_read_b64_tr_b16 a[84:85], v50 offset:12288
    v_mfma_f32_16x16x32_bf16 v[224:227], a[36:39], a[8:11], v[224:227]
    buffer_load_dwordx4 v3, s[16:19], s40 offen offset:1024 nt lds
    v_mfma_f32_16x16x32_bf16 v[228:231], a[36:39], a[12:15], v[228:231]
    ds_read_b64_tr_b16 a[86:87], v50 offset:13824
    v_mfma_f32_16x16x32_bf16 v[232:235], a[36:39], a[16:19], v[232:235]
    s_waitcnt lgkmcnt(15)
    v_mfma_f32_16x16x32_bf16 v[236:239], a[40:43], a[0:3], v[236:239]
    v_mfma_f32_16x16x32_bf16 v[240:243], a[40:43], a[4:7], v[240:243]
    v_mfma_f32_16x16x32_bf16 v[244:247], a[40:43], a[8:11], v[244:247]
    v_mfma_f32_16x16x32_bf16 v[248:251], a[40:43], a[12:15], v[248:251]
    v_mfma_f32_16x16x32_bf16 v[252:255], a[40:43], a[16:19], v[252:255]
    s_waitcnt lgkmcnt(0)
    s_waitcnt vmcnt(6)
    s_barrier
    v_mfma_f32_16x16x32_bf16 v[136:139], a[64:67], a[44:47], v[136:139]
    v_add_u32 v37, 90112, v35
    v_add_u32 v38, 90112, v36
    v_mfma_f32_16x16x32_bf16 v[140:143], a[64:67], a[48:51], v[140:143]
    v_add_u32 v45, 90112, v39
    v_mfma_f32_16x16x32_bf16 v[144:147], a[64:67], a[52:55], v[144:147]
    buffer_load_dwordx4 v4, s[16:19], s40 offen offset:2048 nt lds
    v_mfma_f32_16x16x32_bf16 v[148:151], a[64:67], a[56:59], v[148:151]
    v_add_u32 v46, 90112, v40
    v_mfma_f32_16x16x32_bf16 v[152:155], a[64:67], a[60:63], v[152:155]
    v_add_u32 v47, 90112, v41
    v_mfma_f32_16x16x32_bf16 v[156:159], a[68:71], a[44:47], v[156:159]
    v_add_u32 v48, 90112, v42
    v_mfma_f32_16x16x32_bf16 v[160:163], a[68:71], a[48:51], v[160:163]
    v_add_u32 v49, 90112, v43
    v_add_u32 v50, 90112, v44
    v_mfma_f32_16x16x32_bf16 v[164:167], a[68:71], a[52:55], v[164:167]
    s_mov_b32 s40, 49152
    s_add_u32 m0, s36, 24576
    s_nop 0
    buffer_load_dwordx4 v2, s[16:19], s40 offen nt lds
    v_mfma_f32_16x16x32_bf16 v[168:171], a[68:71], a[56:59], v[168:171]
    ds_read_b64_tr_b16 a[20:21], v45
    v_mfma_f32_16x16x32_bf16 v[172:175], a[68:71], a[60:63], v[172:175]
    ds_read_b64_tr_b16 a[22:23], v45 offset:1536
    v_mfma_f32_16x16x32_bf16 v[176:179], a[72:75], a[44:47], v[176:179]
    ds_read_b128 a[0:3], v37
    v_mfma_f32_16x16x32_bf16 v[180:183], a[72:75], a[48:51], v[180:183]
    ds_read_b64_tr_b16 a[24:25], v46
    v_mfma_f32_16x16x32_bf16 v[184:187], a[72:75], a[52:55], v[184:187]
    ds_read_b64_tr_b16 a[26:27], v46 offset:1536
    v_mfma_f32_16x16x32_bf16 v[188:191], a[72:75], a[56:59], v[188:191]
    buffer_load_dwordx4 v3, s[16:19], s40 offen offset:1024 nt lds
    ds_read_b128 a[4:7], v37 offset:2048
    v_mfma_f32_16x16x32_bf16 v[192:195], a[72:75], a[60:63], v[192:195]
    ds_read_b64_tr_b16 a[28:29], v47
    v_mfma_f32_16x16x32_bf16 v[196:199], a[76:79], a[44:47], v[196:199]
    ds_read_b64_tr_b16 a[30:31], v47 offset:1536
    v_mfma_f32_16x16x32_bf16 v[200:203], a[76:79], a[48:51], v[200:203]
    ds_read_b128 a[8:11], v37 offset:4096
    v_mfma_f32_16x16x32_bf16 v[204:207], a[76:79], a[52:55], v[204:207]
    ds_read_b64_tr_b16 a[32:33], v48
    v_mfma_f32_16x16x32_bf16 v[208:211], a[76:79], a[56:59], v[208:211]
    buffer_load_dwordx4 v4, s[16:19], s40 offen offset:2048 nt lds
    v_mfma_f32_16x16x32_bf16 v[212:215], a[76:79], a[60:63], v[212:215]
    ds_read_b64_tr_b16 a[34:35], v48 offset:1536
    ds_read_b128 a[12:15], v37 offset:6144
    v_mfma_f32_16x16x32_bf16 v[216:219], a[80:83], a[44:47], v[216:219]
    ds_read_b64_tr_b16 a[36:37], v49
    v_mfma_f32_16x16x32_bf16 v[220:223], a[80:83], a[48:51], v[220:223]
    ds_read_b64_tr_b16 a[38:39], v49 offset:1536
    v_mfma_f32_16x16x32_bf16 v[224:227], a[80:83], a[52:55], v[224:227]
    ds_read_b128 a[16:19], v37 offset:8192
    v_mfma_f32_16x16x32_bf16 v[228:231], a[80:83], a[56:59], v[228:231]
    s_mov_b32 s40, 61440
    s_add_u32 m0, s36, 36864
    s_nop 0
    buffer_load_dwordx4 v2, s[16:19], s40 offen nt lds
    v_mfma_f32_16x16x32_bf16 v[232:235], a[80:83], a[60:63], v[232:235]
    ds_read_b64_tr_b16 a[40:41], v50
    v_mfma_f32_16x16x32_bf16 v[236:239], a[84:87], a[44:47], v[236:239]
    ds_read_b64_tr_b16 a[42:43], v50 offset:1536
    v_mfma_f32_16x16x32_bf16 v[240:243], a[84:87], a[48:51], v[240:243]
    v_mfma_f32_16x16x32_bf16 v[244:247], a[84:87], a[52:55], v[244:247]
    v_mfma_f32_16x16x32_bf16 v[248:251], a[84:87], a[56:59], v[248:251]
    v_mfma_f32_16x16x32_bf16 v[252:255], a[84:87], a[60:63], v[252:255]
    s_waitcnt lgkmcnt(14)
    v_mfma_f32_16x16x32_bf16 v[136:139], a[20:23], a[0:3], v[136:139]
    ds_read_b64_tr_b16 a[64:65], v45 offset:12288
    s_waitcnt lgkmcnt(12)
    v_mfma_f32_16x16x32_bf16 v[140:143], a[20:23], a[4:7], v[140:143]
    buffer_load_dwordx4 v3, s[16:19], s40 offen offset:1024 nt lds
    s_waitcnt lgkmcnt(9)
    v_mfma_f32_16x16x32_bf16 v[144:147], a[20:23], a[8:11], v[144:147]
    ds_read_b64_tr_b16 a[66:67], v45 offset:13824
    s_waitcnt lgkmcnt(7)
    v_mfma_f32_16x16x32_bf16 v[148:151], a[20:23], a[12:15], v[148:151]
    ds_read_b128 a[44:47], v38
    s_waitcnt lgkmcnt(5)
    v_mfma_f32_16x16x32_bf16 v[152:155], a[20:23], a[16:19], v[152:155]
    ds_read_b64_tr_b16 a[68:69], v46 offset:12288
    v_mfma_f32_16x16x32_bf16 v[156:159], a[24:27], a[0:3], v[156:159]
    v_mfma_f32_16x16x32_bf16 v[160:163], a[24:27], a[4:7], v[160:163]
    ds_read_b64_tr_b16 a[70:71], v46 offset:13824
    v_mfma_f32_16x16x32_bf16 v[164:167], a[24:27], a[8:11], v[164:167]
    ds_read_b128 a[48:51], v38 offset:2048
    v_mfma_f32_16x16x32_bf16 v[168:171], a[24:27], a[12:15], v[168:171]
    v_mfma_f32_16x16x32_bf16 v[172:175], a[24:27], a[16:19], v[172:175]
    ds_read_b64_tr_b16 a[72:73], v47 offset:12288
    v_mfma_f32_16x16x32_bf16 v[176:179], a[28:31], a[0:3], v[176:179]
    ds_read_b64_tr_b16 a[74:75], v47 offset:13824
    v_mfma_f32_16x16x32_bf16 v[180:183], a[28:31], a[4:7], v[180:183]
    ds_read_b128 a[52:55], v38 offset:4096
    v_mfma_f32_16x16x32_bf16 v[184:187], a[28:31], a[8:11], v[184:187]
    v_mfma_f32_16x16x32_bf16 v[188:191], a[28:31], a[12:15], v[188:191]
    ds_read_b64_tr_b16 a[76:77], v48 offset:12288
    v_mfma_f32_16x16x32_bf16 v[192:195], a[28:31], a[16:19], v[192:195]
    ds_read_b64_tr_b16 a[78:79], v48 offset:13824
    v_mfma_f32_16x16x32_bf16 v[196:199], a[32:35], a[0:3], v[196:199]
    v_mfma_f32_16x16x32_bf16 v[200:203], a[32:35], a[4:7], v[200:203]
    ds_read_b128 a[56:59], v38 offset:6144
    v_mfma_f32_16x16x32_bf16 v[204:207], a[32:35], a[8:11], v[204:207]
    ds_read_b64_tr_b16 a[80:81], v49 offset:12288
    v_mfma_f32_16x16x32_bf16 v[208:211], a[32:35], a[12:15], v[208:211]
    v_mfma_f32_16x16x32_bf16 v[212:215], a[32:35], a[16:19], v[212:215]
    ds_read_b64_tr_b16 a[82:83], v49 offset:13824
    v_mfma_f32_16x16x32_bf16 v[216:219], a[36:39], a[0:3], v[216:219]
    ds_read_b128 a[60:63], v38 offset:8192
    v_mfma_f32_16x16x32_bf16 v[220:223], a[36:39], a[4:7], v[220:223]
    ds_read_b64_tr_b16 a[84:85], v50 offset:12288
    v_mfma_f32_16x16x32_bf16 v[224:227], a[36:39], a[8:11], v[224:227]
    v_mfma_f32_16x16x32_bf16 v[228:231], a[36:39], a[12:15], v[228:231]
    ds_read_b64_tr_b16 a[86:87], v50 offset:13824
    v_mfma_f32_16x16x32_bf16 v[232:235], a[36:39], a[16:19], v[232:235]
    s_waitcnt lgkmcnt(15)
    v_mfma_f32_16x16x32_bf16 v[236:239], a[40:43], a[0:3], v[236:239]
    v_mfma_f32_16x16x32_bf16 v[240:243], a[40:43], a[4:7], v[240:243]
    v_mfma_f32_16x16x32_bf16 v[244:247], a[40:43], a[8:11], v[244:247]
    v_mfma_f32_16x16x32_bf16 v[248:251], a[40:43], a[12:15], v[248:251]
    v_mfma_f32_16x16x32_bf16 v[252:255], a[40:43], a[16:19], v[252:255]
    s_waitcnt lgkmcnt(0)
    s_barrier
    v_mfma_f32_16x16x32_bf16 v[136:139], a[64:67], a[44:47], v[136:139]
    v_mfma_f32_16x16x32_bf16 v[140:143], a[64:67], a[48:51], v[140:143]
    v_mfma_f32_16x16x32_bf16 v[144:147], a[64:67], a[52:55], v[144:147]
    v_mfma_f32_16x16x32_bf16 v[148:151], a[64:67], a[56:59], v[148:151]
    v_mfma_f32_16x16x32_bf16 v[152:155], a[64:67], a[60:63], v[152:155]
    v_mfma_f32_16x16x32_bf16 v[156:159], a[68:71], a[44:47], v[156:159]
    v_mfma_f32_16x16x32_bf16 v[160:163], a[68:71], a[48:51], v[160:163]
    v_mfma_f32_16x16x32_bf16 v[164:167], a[68:71], a[52:55], v[164:167]
    v_mfma_f32_16x16x32_bf16 v[168:171], a[68:71], a[56:59], v[168:171]
    v_mfma_f32_16x16x32_bf16 v[172:175], a[68:71], a[60:63], v[172:175]
    v_cvt_pk_bf16_f32 v72, v136, v137
    v_cvt_pk_bf16_f32 v73, v138, v139
    ds_write_b64 v51, v[72:73]
    v_mfma_f32_16x16x32_bf16 v[176:179], a[72:75], a[44:47], v[176:179]
    v_cvt_pk_bf16_f32 v74, v140, v141
    v_cvt_pk_bf16_f32 v75, v142, v143
    ds_write_b64 v51, v[74:75] offset:6144
    v_mfma_f32_16x16x32_bf16 v[180:183], a[72:75], a[48:51], v[180:183]
    v_cvt_pk_bf16_f32 v76, v144, v145
    v_cvt_pk_bf16_f32 v77, v146, v147
    ds_write_b64 v51, v[76:77] offset:12288
    v_mfma_f32_16x16x32_bf16 v[184:187], a[72:75], a[52:55], v[184:187]
    v_cvt_pk_bf16_f32 v78, v148, v149
    v_cvt_pk_bf16_f32 v79, v150, v151
    ds_write_b64 v51, v[78:79] offset:18432
    v_mfma_f32_16x16x32_bf16 v[188:191], a[72:75], a[56:59], v[188:191]
    v_cvt_pk_bf16_f32 v80, v152, v153
    v_cvt_pk_bf16_f32 v81, v154, v155
    ds_write_b64 v51, v[80:81] offset:24576
    v_mfma_f32_16x16x32_bf16 v[192:195], a[72:75], a[60:63], v[192:195]
    v_cvt_pk_bf16_f32 v82, v156, v157
    v_cvt_pk_bf16_f32 v83, v158, v159
    ds_write_b64 v52, v[82:83]
    v_mfma_f32_16x16x32_bf16 v[196:199], a[76:79], a[44:47], v[196:199]
    v_cvt_pk_bf16_f32 v84, v160, v161
    v_cvt_pk_bf16_f32 v85, v162, v163
    ds_write_b64 v52, v[84:85] offset:6144
    v_mfma_f32_16x16x32_bf16 v[200:203], a[76:79], a[48:51], v[200:203]
    v_cvt_pk_bf16_f32 v86, v164, v165
    v_cvt_pk_bf16_f32 v87, v166, v167
    ds_write_b64 v52, v[86:87] offset:12288
    v_mfma_f32_16x16x32_bf16 v[204:207], a[76:79], a[52:55], v[204:207]
    v_cvt_pk_bf16_f32 v72, v168, v169
    v_cvt_pk_bf16_f32 v73, v170, v171
    ds_write_b64 v52, v[72:73] offset:18432
    v_mfma_f32_16x16x32_bf16 v[208:211], a[76:79], a[56:59], v[208:211]
    v_cvt_pk_bf16_f32 v74, v172, v173
    v_cvt_pk_bf16_f32 v75, v174, v175
    ds_write_b64 v52, v[74:75] offset:24576
    v_mfma_f32_16x16x32_bf16 v[212:215], a[76:79], a[60:63], v[212:215]
    v_cvt_pk_bf16_f32 v76, v176, v177
    v_cvt_pk_bf16_f32 v77, v178, v179
    ds_write_b64 v53, v[76:77]
    v_mfma_f32_16x16x32_bf16 v[216:219], a[80:83], a[44:47], v[216:219]
    v_cvt_pk_bf16_f32 v78, v180, v181
    v_cvt_pk_bf16_f32 v79, v182, v183
    ds_write_b64 v53, v[78:79] offset:6144
    v_mfma_f32_16x16x32_bf16 v[220:223], a[80:83], a[48:51], v[220:223]
    v_cvt_pk_bf16_f32 v80, v184, v185
    v_cvt_pk_bf16_f32 v81, v186, v187
    ds_write_b64 v53, v[80:81] offset:12288
    v_mfma_f32_16x16x32_bf16 v[224:227], a[80:83], a[52:55], v[224:227]
    v_cvt_pk_bf16_f32 v82, v188, v189
    v_cvt_pk_bf16_f32 v83, v190, v191
    ds_write_b64 v53, v[82:83] offset:18432
    v_mfma_f32_16x16x32_bf16 v[228:231], a[80:83], a[56:59], v[228:231]
    v_cvt_pk_bf16_f32 v84, v192, v193
    v_cvt_pk_bf16_f32 v85, v194, v195
    ds_write_b64 v53, v[84:85] offset:24576
    v_mfma_f32_16x16x32_bf16 v[232:235], a[80:83], a[60:63], v[232:235]
    v_cvt_pk_bf16_f32 v86, v196, v197
    v_cvt_pk_bf16_f32 v87, v198, v199
    ds_write_b64 v54, v[86:87]
    v_mfma_f32_16x16x32_bf16 v[236:239], a[84:87], a[44:47], v[236:239]
    v_cvt_pk_bf16_f32 v72, v200, v201
    v_cvt_pk_bf16_f32 v73, v202, v203
    ds_write_b64 v54, v[72:73] offset:6144
    v_mfma_f32_16x16x32_bf16 v[240:243], a[84:87], a[48:51], v[240:243]
    v_cvt_pk_bf16_f32 v74, v204, v205
    v_cvt_pk_bf16_f32 v75, v206, v207
    ds_write_b64 v54, v[74:75] offset:12288
    v_mfma_f32_16x16x32_bf16 v[244:247], a[84:87], a[52:55], v[244:247]
    v_cvt_pk_bf16_f32 v76, v208, v209
    v_cvt_pk_bf16_f32 v77, v210, v211
    ds_write_b64 v54, v[76:77] offset:18432
    v_mfma_f32_16x16x32_bf16 v[248:251], a[84:87], a[56:59], v[248:251]
    v_cvt_pk_bf16_f32 v78, v212, v213
    v_cvt_pk_bf16_f32 v79, v214, v215
    ds_write_b64 v54, v[78:79] offset:24576
    v_mfma_f32_16x16x32_bf16 v[252:255], a[84:87], a[60:63], v[252:255]
    v_cvt_pk_bf16_f32 v80, v216, v217
    v_cvt_pk_bf16_f32 v81, v218, v219
    ds_write_b64 v55, v[80:81]
    v_cvt_pk_bf16_f32 v82, v220, v221
    v_cvt_pk_bf16_f32 v83, v222, v223
    ds_write_b64 v55, v[82:83] offset:6144
    v_cvt_pk_bf16_f32 v84, v224, v225
    v_cvt_pk_bf16_f32 v85, v226, v227
    ds_write_b64 v55, v[84:85] offset:12288
    v_cvt_pk_bf16_f32 v86, v228, v229
    v_cvt_pk_bf16_f32 v87, v230, v231
    ds_write_b64 v55, v[86:87] offset:18432
    v_cvt_pk_bf16_f32 v72, v232, v233
    v_cvt_pk_bf16_f32 v73, v234, v235
    ds_write_b64 v55, v[72:73] offset:24576
    v_cvt_pk_bf16_f32 v74, v236, v237
    v_cvt_pk_bf16_f32 v75, v238, v239
    ds_write_b64 v56, v[74:75]
    v_cvt_pk_bf16_f32 v76, v240, v241
    v_cvt_pk_bf16_f32 v77, v242, v243
    ds_write_b64 v56, v[76:77] offset:6144
    v_cvt_pk_bf16_f32 v78, v244, v245
    v_cvt_pk_bf16_f32 v79, v246, v247
    ds_write_b64 v56, v[78:79] offset:12288
    v_cvt_pk_bf16_f32 v80, v248, v249
    v_cvt_pk_bf16_f32 v81, v250, v251
    ds_write_b64 v56, v[80:81] offset:18432
    v_cvt_pk_bf16_f32 v82, v252, v253
    v_cvt_pk_bf16_f32 v83, v254, v255
    ds_write_b64 v56, v[82:83] offset:24576
    s_mul_i32 s33, s73, 320
    s_sub_u32 s8, s44, s33
    s_subb_u32 s9, s45, 0
    s_mov_b32 s10, 983040
    s_mov_b32 s11, 0x00020000
    s_waitcnt lgkmcnt(0)
    s_barrier
    ds_read_b128 a[120:123], v9
    ds_read_b128 a[0:3], v57
    ds_read_b128 a[4:7], v57 offset:6144
    ds_read_b128 a[8:11], v57 offset:12288
    ds_read_b128 a[12:15], v57 offset:18432
    ds_read_b128 a[16:19], v57 offset:24576
    ds_read_b128 a[124:127], v10
    ds_read_b128 a[20:23], v58
    ds_read_b128 a[24:27], v58 offset:6144
    ds_read_b128 a[28:31], v58 offset:12288
    ds_read_b128 a[32:35], v58 offset:18432
    ds_read_b128 a[36:39], v58 offset:24576
    ds_read_b128 a[128:131], v9 offset:128
    ds_read_b128 a[40:43], v57 offset:128
    ds_read_b128 a[44:47], v57 offset:6272
    ds_read_b128 a[48:51], v57 offset:12416
    ds_read_b128 a[52:55], v57 offset:18560
    ds_read_b128 a[56:59], v57 offset:24704
    ds_read_b128 a[132:135], v10 offset:128
    ds_read_b128 a[60:63], v58 offset:128
    ds_read_b128 a[64:67], v58 offset:6272
    ds_read_b128 a[68:71], v58 offset:12416
    ds_read_b128 a[72:75], v58 offset:18560
    ds_read_b128 a[76:79], v58 offset:24704
    ds_read_b128 a[136:139], v9 offset:256
    ds_read_b128 a[80:83], v57 offset:256
    ds_read_b128 a[84:87], v57 offset:6400
    ds_read_b128 a[88:91], v57 offset:12544
    ds_read_b128 a[92:95], v57 offset:18688
    ds_read_b128 a[96:99], v57 offset:24832
    ds_read_b128 a[140:143], v10 offset:256
    ds_read_b128 a[100:103], v58 offset:256
    ds_read_b128 a[104:107], v58 offset:6400
    ds_read_b128 a[108:111], v58 offset:12544
    ds_read_b128 a[112:115], v58 offset:18688
    ds_read_b128 a[116:119], v58 offset:24832
QK_ENTRY:
    s_waitcnt lgkmcnt(15)
    v_mfma_f32_16x16x32_bf16 v[24:27], a[120:123], a[0:3], 0
    v_mfma_f32_16x16x32_bf16 v[28:31], a[120:123], a[4:7], 0
    v_mfma_f32_16x16x32_bf16 v[32:35], a[120:123], a[8:11], 0
    v_mfma_f32_16x16x32_bf16 v[36:39], a[120:123], a[12:15], 0
    s_add_u32 m0, s36, 36864
    s_nop 0
    buffer_load_dwordx4 v4, s[16:19], s40 offen offset:2048 nt lds
    v_mfma_f32_16x16x32_bf16 v[40:43], a[120:123], a[16:19], 0
    v_mfma_f32_16x16x32_bf16 v[24:27], a[124:127], a[20:23], v[24:27]
    v_mfma_f32_16x16x32_bf16 v[28:31], a[124:127], a[24:27], v[28:31]
    v_mfma_f32_16x16x32_bf16 v[32:35], a[124:127], a[28:31], v[32:35]
    v_mfma_f32_16x16x32_bf16 v[36:39], a[124:127], a[32:35], v[36:39]
    v_add_u32 v9, 0x3000, v9
    v_mfma_f32_16x16x32_bf16 v[40:43], a[124:127], a[36:39], v[40:43]
    v_add_u32 v10, 0x3000, v10
    v_mfma_f32_16x16x32_bf16 v[24:27], a[128:131], a[40:43], v[24:27]
    ds_read_b128 a[144:147], v9
    v_mfma_f32_16x16x32_bf16 v[28:31], a[128:131], a[44:47], v[28:31]
    ds_read_b128 a[148:151], v10
    s_mov_b32 s40, 73728
    s_add_u32 m0, s36, 49152
    s_nop 0
    buffer_load_dwordx4 v2, s[16:19], s40 offen nt lds
    v_mfma_f32_16x16x32_bf16 v[32:35], a[128:131], a[48:51], v[32:35]
    v_mfma_f32_16x16x32_bf16 v[36:39], a[128:131], a[52:55], v[36:39]
    ds_read_b128 a[152:155], v9 offset:128
    v_mfma_f32_16x16x32_bf16 v[40:43], a[128:131], a[56:59], v[40:43]
    ds_read_b128 a[156:159], v10 offset:128
    v_mfma_f32_16x16x32_bf16 v[24:27], a[132:135], a[60:63], v[24:27]
    ds_read_b128 a[160:163], v9 offset:256
    v_mfma_f32_16x16x32_bf16 v[28:31], a[132:135], a[64:67], v[28:31]
    ds_read_b128 a[164:167], v10 offset:256
    s_waitcnt lgkmcnt(15)
    v_mfma_f32_16x16x32_bf16 v[32:35], a[132:135], a[68:71], v[32:35]
    v_mfma_f32_16x16x32_bf16 v[36:39], a[132:135], a[72:75], v[36:39]
    v_mfma_f32_16x16x32_bf16 v[40:43], a[132:135], a[76:79], v[40:43]
    buffer_load_dwordx4 v3, s[16:19], s40 offen offset:1024 nt lds
    v_mfma_f32_16x16x32_bf16 v[24:27], a[136:139], a[80:83], v[24:27]
    v_mfma_f32_16x16x32_bf16 v[28:31], a[136:139], a[84:87], v[28:31]
    s_waitcnt lgkmcnt(14)
    v_mfma_f32_16x16x32_bf16 v[32:35], a[136:139], a[88:91], v[32:35]
    s_waitcnt lgkmcnt(13)
    v_mfma_f32_16x16x32_bf16 v[36:39], a[136:139], a[92:95], v[36:39]
    s_waitcnt lgkmcnt(12)
    v_mfma_f32_16x16x32_bf16 v[40:43], a[136:139], a[96:99], v[40:43]
    s_waitcnt lgkmcnt(10)
    v_mfma_f32_16x16x32_bf16 v[24:27], a[140:143], a[100:103], v[24:27]
    s_waitcnt lgkmcnt(9)
    v_mfma_f32_16x16x32_bf16 v[28:31], a[140:143], a[104:107], v[28:31]
    s_waitcnt lgkmcnt(8)
    v_mfma_f32_16x16x32_bf16 v[32:35], a[140:143], a[108:111], v[32:35]
    s_waitcnt lgkmcnt(7)
    v_mfma_f32_16x16x32_bf16 v[36:39], a[140:143], a[112:115], v[36:39]
    s_waitcnt lgkmcnt(6)
    v_mfma_f32_16x16x32_bf16 v[40:43], a[140:143], a[116:119], v[40:43]
    s_waitcnt lgkmcnt(0)
    s_waitcnt vmcnt(8)
    s_barrier
    v_mfma_f32_16x16x32_bf16 v[44:47], a[144:147], a[0:3], 0
    v_mfma_f32_16x16x32_bf16 v[48:51], a[144:147], a[4:7], 0
    v_add_u32 v9, 0xfffdc000, v9
    v_mfma_f32_16x16x32_bf16 v[52:55], a[144:147], a[8:11], 0
    v_add_u32 v10, 0xfffdc000, v10
    s_cmp_eq_u32 s0, 0
    s_cbranch_scc0 REF_SKIP
    v_max3_f32 v11, v24, v25, v26
    v_max_f32 v11, v11, v27
    v_max3_f32 v12, v28, v29, v30
    v_max_f32 v12, v12, v31
    v_max3_f32 v13, v32, v33, v34
    v_max_f32 v13, v13, v35
    v_max3_f32 v14, v36, v37, v38
    v_max_f32 v14, v14, v39
    v_max3_f32 v15, v40, v41, v42
    v_max_f32 v15, v15, v43
    v_mov_b32 v16, v11
    s_nop 1
    v_permlane16_swap_b32 v11, v16
    v_max_f32 v11, v11, v16
    v_mov_b32 v17, v12
    s_nop 1
    v_permlane16_swap_b32 v12, v17
    v_max_f32 v12, v12, v17
    v_mov_b32 v16, v13
    s_nop 1
    v_permlane16_swap_b32 v13, v16
    v_max_f32 v13, v13, v16
    v_mov_b32 v17, v14
    s_nop 1
    v_permlane16_swap_b32 v14, v17
    v_max_f32 v14, v14, v17
    v_mov_b32 v16, v15
    s_nop 1
    v_permlane16_swap_b32 v15, v16
    v_max_f32 v15, v15, v16
    v_mov_b32 v16, v11
    s_nop 1
    v_permlane32_swap_b32 v11, v16
    v_max_f32 v11, v11, v16
    v_mov_b32 v17, v12
    s_nop 1
    v_permlane32_swap_b32 v12, v17
    v_max_f32 v12, v12, v17
    v_mov_b32 v16, v13
    s_nop 1
    v_permlane32_swap_b32 v13, v16
    v_max_f32 v13, v13, v16
    v_mov_b32 v17, v14
    s_nop 1
    v_permlane32_swap_b32 v14, v17
    v_max_f32 v14, v14, v17
    v_mov_b32 v16, v15
    s_nop 1
    v_permlane32_swap_b32 v15, v16
    v_max_f32 v15, v15, v16
    v_mul_f32 v11, s42, v11
    v_mul_f32 v12, s42, v12
    v_mul_f32 v13, s42, v13
    v_mul_f32 v14, s42, v14
    v_mul_f32 v15, s42, v15
REF_SKIP:
    s_nop 7
    v_max3_f32 v64, v24, v25, v26
    v_max_f32 v64, v64, v27
    v_mfma_f32_16x16x32_bf16 v[56:59], a[144:147], a[12:15], 0
    ds_read_b128 a[120:123], v9
    v_fma_f32 v24, v24, s42, -v11
    v_fma_f32 v25, v25, s42, -v11
    buffer_load_dwordx4 v4, s[16:19], s40 offen offset:2048 nt lds
    v_mfma_f32_16x16x32_bf16 v[60:63], a[144:147], a[16:19], 0
    ds_read_b128 a[124:127], v10
    v_fma_f32 v26, v26, s42, -v11
    v_fma_f32 v27, v27, s42, -v11
    v_mfma_f32_16x16x32_bf16 v[44:47], a[148:151], a[20:23], v[44:47]
    v_exp_f32 v24, v24
    v_exp_f32 v25, v25
    v_exp_f32 v26, v26
    v_mfma_f32_16x16x32_bf16 v[48:51], a[148:151], a[24:27], v[48:51]
    ds_read_b128 a[128:131], v9 offset:128
    v_exp_f32 v27, v27
    v_cvt_pk_bf16_f32 v72, v24, v25
    v_mfma_f32_16x16x32_bf16 v[52:55], a[148:151], a[28:31], v[52:55]
    ds_read_b128 a[132:135], v10 offset:128
    v_cvt_pk_bf16_f32 v73, v26, v27
    v_max3_f32 v65, v28, v29, v30
    v_mfma_f32_16x16x32_bf16 v[56:59], a[148:151], a[32:35], v[56:59]
    ds_read_b128 a[136:139], v9 offset:256
    v_max_f32 v65, v65, v31
    v_fma_f32 v28, v28, s42, -v12
    v_mfma_f32_16x16x32_bf16 v[60:63], a[148:151], a[36:39], v[60:63]
    ds_read_b128 a[140:143], v10 offset:256
    v_fma_f32 v29, v29, s42, -v12
    v_fma_f32 v30, v30, s42, -v12
    v_fma_f32 v31, v31, s42, -v12
    v_mfma_f32_16x16x32_bf16 v[44:47], a[152:155], a[40:43], v[44:47]
    v_exp_f32 v28, v28
    v_exp_f32 v29, v29
    v_mfma_f32_16x16x32_bf16 v[48:51], a[152:155], a[44:47], v[48:51]
    v_exp_f32 v30, v30
    v_exp_f32 v31, v31
    s_mov_b32 s40, 86016
    s_add_u32 m0, s36, 61440
    s_nop 0
    buffer_load_dwordx4 v2, s[16:19], s40 offen nt lds
    v_mfma_f32_16x16x32_bf16 v[52:55], a[152:155], a[48:51], v[52:55]
    v_cvt_pk_bf16_f32 v76, v28, v29
    v_cvt_pk_bf16_f32 v77, v30, v31
    v_mfma_f32_16x16x32_bf16 v[56:59], a[152:155], a[52:55], v[56:59]
    v_max3_f32 v66, v32, v33, v34
    v_max_f32 v66, v66, v35
    v_fma_f32 v32, v32, s42, -v13
    v_mfma_f32_16x16x32_bf16 v[60:63], a[152:155], a[56:59], v[60:63]
    v_fma_f32 v33, v33, s42, -v13
    v_fma_f32 v34, v34, s42, -v13
    v_mfma_f32_16x16x32_bf16 v[44:47], a[156:159], a[60:63], v[44:47]
    v_fma_f32 v35, v35, s42, -v13
    v_exp_f32 v32, v32
    v_mfma_f32_16x16x32_bf16 v[48:51], a[156:159], a[64:67], v[48:51]
    v_exp_f32 v33, v33
    v_exp_f32 v34, v34
    v_mfma_f32_16x16x32_bf16 v[52:55], a[156:159], a[68:71], v[52:55]
    v_exp_f32 v35, v35
    v_cvt_pk_bf16_f32 v80, v32, v33
    v_cvt_pk_bf16_f32 v81, v34, v35
    v_mfma_f32_16x16x32_bf16 v[56:59], a[156:159], a[72:75], v[56:59]
    v_max3_f32 v67, v36, v37, v38
    v_max_f32 v67, v67, v39
    v_mfma_f32_16x16x32_bf16 v[60:63], a[156:159], a[76:79], v[60:63]
    v_fma_f32 v36, v36, s42, -v14
    v_fma_f32 v37, v37, s42, -v14
    buffer_load_dwordx4 v3, s[16:19], s40 offen offset:1024 nt lds
    v_mfma_f32_16x16x32_bf16 v[44:47], a[160:163], a[80:83], v[44:47]
    v_fma_f32 v38, v38, s42, -v14
    v_fma_f32 v39, v39, s42, -v14
    v_mfma_f32_16x16x32_bf16 v[48:51], a[160:163], a[84:87], v[48:51]
    v_exp_f32 v36, v36
    v_exp_f32 v37, v37
    v_exp_f32 v38, v38
    v_mfma_f32_16x16x32_bf16 v[52:55], a[160:163], a[88:91], v[52:55]
    v_exp_f32 v39, v39
    v_cvt_pk_bf16_f32 v84, v36, v37
    v_mfma_f32_16x16x32_bf16 v[56:59], a[160:163], a[92:95], v[56:59]
    v_cvt_pk_bf16_f32 v85, v38, v39
    v_max3_f32 v68, v40, v41, v42
    v_mfma_f32_16x16x32_bf16 v[60:63], a[160:163], a[96:99], v[60:63]
    v_max_f32 v68, v68, v43
    v_fma_f32 v40, v40, s42, -v15
    v_mfma_f32_16x16x32_bf16 v[44:47], a[164:167], a[100:103], v[44:47]
    v_fma_f32 v41, v41, s42, -v15
    v_fma_f32 v42, v42, s42, -v15
    v_fma_f32 v43, v43, s42, -v15
    v_mfma_f32_16x16x32_bf16 v[48:51], a[164:167], a[104:107], v[48:51]
    v_exp_f32 v40, v40
    v_exp_f32 v41, v41
    v_mfma_f32_16x16x32_bf16 v[52:55], a[164:167], a[108:111], v[52:55]
    v_exp_f32 v42, v42
    v_exp_f32 v43, v43
    v_mfma_f32_16x16x32_bf16 v[56:59], a[164:167], a[112:115], v[56:59]
    v_cvt_pk_bf16_f32 v88, v40, v41
    v_cvt_pk_bf16_f32 v89, v42, v43
    v_mfma_f32_16x16x32_bf16 v[60:63], a[164:167], a[116:119], v[60:63]
    s_waitcnt lgkmcnt(5)
    v_mfma_f32_16x16x32_bf16 v[24:27], a[120:123], a[0:3], 0
    v_mfma_f32_16x16x32_bf16 v[28:31], a[120:123], a[4:7], 0
    v_add_u32 v9, 0x3000, v9
    v_mfma_f32_16x16x32_bf16 v[32:35], a[120:123], a[8:11], 0
    v_add_u32 v10, 0x3000, v10
    v_max3_f32 v64, v64, v44, v45
    v_max3_f32 v64, v64, v46, v47
    v_fma_f32 v44, v44, s42, -v11
    v_mfma_f32_16x16x32_bf16 v[36:39], a[120:123], a[12:15], 0
    ds_read_b128 a[144:147], v9
    v_fma_f32 v45, v45, s42, -v11
    v_fma_f32 v46, v46, s42, -v11
    buffer_load_dwordx4 v4, s[16:19], s40 offen offset:2048 nt lds
    v_mfma_f32_16x16x32_bf16 v[40:43], a[120:123], a[16:19], 0
    ds_read_b128 a[148:151], v10
    v_fma_f32 v47, v47, s42, -v11
    v_exp_f32 v44, v44
    s_waitcnt lgkmcnt(6)
    v_mfma_f32_16x16x32_bf16 v[24:27], a[124:127], a[20:23], v[24:27]
    v_exp_f32 v45, v45
    v_exp_f32 v46, v46
    v_mfma_f32_16x16x32_bf16 v[28:31], a[124:127], a[24:27], v[28:31]
    ds_read_b128 a[152:155], v9 offset:128
    v_exp_f32 v47, v47
    v_cvt_pk_bf16_f32 v74, v44, v45
    v_cvt_pk_bf16_f32 v75, v46, v47
    v_mfma_f32_16x16x32_bf16 v[32:35], a[124:127], a[28:31], v[32:35]
    ds_read_b128 a[156:159], v10 offset:128
    v_max3_f32 v65, v65, v48, v49
    v_max3_f32 v65, v65, v50, v51
    v_mfma_f32_16x16x32_bf16 v[36:39], a[124:127], a[32:35], v[36:39]
    ds_read_b128 a[160:163], v9 offset:256
    v_fma_f32 v48, v48, s42, -v12
    v_fma_f32 v49, v49, s42, -v12
    v_mfma_f32_16x16x32_bf16 v[40:43], a[124:127], a[36:39], v[40:43]
    ds_read_b128 a[164:167], v10 offset:256
    v_fma_f32 v50, v50, s42, -v12
    v_fma_f32 v51, v51, s42, -v12
    s_waitcnt lgkmcnt(9)
    v_mfma_f32_16x16x32_bf16 v[24:27], a[128:131], a[40:43], v[24:27]
    v_exp_f32 v48, v48
    v_exp_f32 v49, v49
    v_mfma_f32_16x16x32_bf16 v[28:31], a[128:131], a[44:47], v[28:31]
    v_exp_f32 v50, v50
    v_exp_f32 v51, v51
    v_cvt_pk_bf16_f32 v78, v48, v49
    s_mov_b32 s40, 98304
    s_add_u32 m0, s36, 73728
    s_nop 0
    buffer_load_dwordx4 v2, s[16:19], s40 offen nt lds
    v_mfma_f32_16x16x32_bf16 v[32:35], a[128:131], a[48:51], v[32:35]
    v_cvt_pk_bf16_f32 v79, v50, v51
    v_max3_f32 v66, v66, v52, v53
    v_mfma_f32_16x16x32_bf16 v[36:39], a[128:131], a[52:55], v[36:39]
    v_max3_f32 v66, v66, v54, v55
    v_fma_f32 v52, v52, s42, -v13
    v_mfma_f32_16x16x32_bf16 v[40:43], a[128:131], a[56:59], v[40:43]
    v_fma_f32 v53, v53, s42, -v13
    v_fma_f32 v54, v54, s42, -v13
    s_waitcnt lgkmcnt(8)
    v_mfma_f32_16x16x32_bf16 v[24:27], a[132:135], a[60:63], v[24:27]
    v_fma_f32 v55, v55, s42, -v13
    v_exp_f32 v52, v52
    v_exp_f32 v53, v53
    v_mfma_f32_16x16x32_bf16 v[28:31], a[132:135], a[64:67], v[28:31]
    v_exp_f32 v54, v54
    v_exp_f32 v55, v55
    v_mfma_f32_16x16x32_bf16 v[32:35], a[132:135], a[68:71], v[32:35]
    v_cvt_pk_bf16_f32 v82, v52, v53
    v_cvt_pk_bf16_f32 v83, v54, v55
    v_mfma_f32_16x16x32_bf16 v[36:39], a[132:135], a[72:75], v[36:39]
    v_max3_f32 v67, v67, v56, v57
    v_max3_f32 v67, v67, v58, v59
    v_mfma_f32_16x16x32_bf16 v[40:43], a[132:135], a[76:79], v[40:43]
    v_fma_f32 v56, v56, s42, -v14
    v_fma_f32 v57, v57, s42, -v14
    buffer_load_dwordx4 v3, s[16:19], s40 offen offset:1024 nt lds
    s_waitcnt lgkmcnt(7)
    v_mfma_f32_16x16x32_bf16 v[24:27], a[136:139], a[80:83], v[24:27]
    v_fma_f32 v58, v58, s42, -v14
    v_fma_f32 v59, v59, s42, -v14
    v_exp_f32 v56, v56
    v_mfma_f32_16x16x32_bf16 v[28:31], a[136:139], a[84:87], v[28:31]
    v_exp_f32 v57, v57
    v_exp_f32 v58, v58
    v_mfma_f32_16x16x32_bf16 v[32:35], a[136:139], a[88:91], v[32:35]
    v_exp_f32 v59, v59
    v_cvt_pk_bf16_f32 v86, v56, v57
    v_mfma_f32_16x16x32_bf16 v[36:39], a[136:139], a[92:95], v[36:39]
    v_cvt_pk_bf16_f32 v87, v58, v59
    v_max3_f32 v68, v68, v60, v61
    v_mfma_f32_16x16x32_bf16 v[40:43], a[136:139], a[96:99], v[40:43]
    v_max3_f32 v68, v68, v62, v63
    v_fma_f32 v60, v60, s42, -v15
    v_fma_f32 v61, v61, s42, -v15
    s_waitcnt lgkmcnt(6)
    v_mfma_f32_16x16x32_bf16 v[24:27], a[140:143], a[100:103], v[24:27]
    v_fma_f32 v62, v62, s42, -v15
    v_fma_f32 v63, v63, s42, -v15
    v_mfma_f32_16x16x32_bf16 v[28:31], a[140:143], a[104:107], v[28:31]
    v_exp_f32 v60, v60
    v_exp_f32 v61, v61
    v_mfma_f32_16x16x32_bf16 v[32:35], a[140:143], a[108:111], v[32:35]
    v_exp_f32 v62, v62
    v_exp_f32 v63, v63
    v_mfma_f32_16x16x32_bf16 v[36:39], a[140:143], a[112:115], v[36:39]
    v_cvt_pk_bf16_f32 v90, v60, v61
    v_cvt_pk_bf16_f32 v91, v62, v63
    v_mfma_f32_16x16x32_bf16 v[40:43], a[140:143], a[116:119], v[40:43]
    s_waitcnt lgkmcnt(0)
    s_waitcnt vmcnt(8)
    s_barrier
    v_mfma_f32_16x16x32_bf16 v[44:47], a[144:147], a[0:3], 0
    v_mfma_f32_16x16x32_bf16 v[48:51], a[144:147], a[4:7], 0
    v_add_u32 v9, 0x3000, v9
    v_mfma_f32_16x16x32_bf16 v[52:55], a[144:147], a[8:11], 0
    v_add_u32 v10, 0x3000, v10
    v_max3_f32 v64, v64, v24, v25
    v_max3_f32 v64, v64, v26, v27
    v_fma_f32 v24, v24, s42, -v11
    v_mfma_f32_16x16x32_bf16 v[56:59], a[144:147], a[12:15], 0
    ds_read_b128 a[120:123], v9
    v_fma_f32 v25, v25, s42, -v11
    v_fma_f32 v26, v26, s42, -v11
    buffer_load_dwordx4 v4, s[16:19], s40 offen offset:2048 nt lds
    v_mfma_f32_16x16x32_bf16 v[60:63], a[144:147], a[16:19], 0
    ds_read_b128 a[124:127], v10
    v_fma_f32 v27, v27, s42, -v11
    v_exp_f32 v24, v24
    v_mfma_f32_16x16x32_bf16 v[44:47], a[148:151], a[20:23], v[44:47]
    v_exp_f32 v25, v25
    v_exp_f32 v26, v26
    v_mfma_f32_16x16x32_bf16 v[48:51], a[148:151], a[24:27], v[48:51]
    ds_read_b128 a[128:131], v9 offset:128
    v_exp_f32 v27, v27
    v_cvt_pk_bf16_f32 v92, v24, v25
    v_cvt_pk_bf16_f32 v93, v26, v27
    v_mfma_f32_16x16x32_bf16 v[52:55], a[148:151], a[28:31], v[52:55]
    ds_read_b128 a[132:135], v10 offset:128
    v_max3_f32 v65, v65, v28, v29
    v_max3_f32 v65, v65, v30, v31
    v_mfma_f32_16x16x32_bf16 v[56:59], a[148:151], a[32:35], v[56:59]
    ds_read_b128 a[136:139], v9 offset:256
    v_fma_f32 v28, v28, s42, -v12
    v_fma_f32 v29, v29, s42, -v12
    v_mfma_f32_16x16x32_bf16 v[60:63], a[148:151], a[36:39], v[60:63]
    ds_read_b128 a[140:143], v10 offset:256
    v_fma_f32 v30, v30, s42, -v12
    v_fma_f32 v31, v31, s42, -v12
    v_mfma_f32_16x16x32_bf16 v[44:47], a[152:155], a[40:43], v[44:47]
    v_exp_f32 v28, v28
    v_exp_f32 v29, v29
    v_mfma_f32_16x16x32_bf16 v[48:51], a[152:155], a[44:47], v[48:51]
    v_exp_f32 v30, v30
    v_exp_f32 v31, v31
    v_cvt_pk_bf16_f32 v96, v28, v29
    s_mov_b32 s40, 110592
    s_add_u32 m0, s36, 86016
    s_nop 0
    buffer_load_dwordx4 v2, s[16:19], s40 offen nt lds
    v_mfma_f32_16x16x32_bf16 v[52:55], a[152:155], a[48:51], v[52:55]
    v_cvt_pk_bf16_f32 v97, v30, v31
    v_max3_f32 v66, v66, v32, v33
    v_mfma_f32_16x16x32_bf16 v[56:59], a[152:155], a[52:55], v[56:59]
    v_max3_f32 v66, v66, v34, v35
    v_fma_f32 v32, v32, s42, -v13
    v_mfma_f32_16x16x32_bf16 v[60:63], a[152:155], a[56:59], v[60:63]
    v_fma_f32 v33, v33, s42, -v13
    v_fma_f32 v34, v34, s42, -v13
    v_mfma_f32_16x16x32_bf16 v[44:47], a[156:159], a[60:63], v[44:47]
    v_fma_f32 v35, v35, s42, -v13
    v_exp_f32 v32, v32
    v_exp_f32 v33, v33
    v_mfma_f32_16x16x32_bf16 v[48:51], a[156:159], a[64:67], v[48:51]
    v_exp_f32 v34, v34
    v_exp_f32 v35, v35
    v_mfma_f32_16x16x32_bf16 v[52:55], a[156:159], a[68:71], v[52:55]
    v_cvt_pk_bf16_f32 v100, v32, v33
    v_cvt_pk_bf16_f32 v101, v34, v35
    v_mfma_f32_16x16x32_bf16 v[56:59], a[156:159], a[72:75], v[56:59]
    v_max3_f32 v67, v67, v36, v37
    v_max3_f32 v67, v67, v38, v39
    v_mfma_f32_16x16x32_bf16 v[60:63], a[156:159], a[76:79], v[60:63]
    v_fma_f32 v36, v36, s42, -v14
    v_fma_f32 v37, v37, s42, -v14
    buffer_load_dwordx4 v3, s[16:19], s40 offen offset:1024 nt lds
    v_mfma_f32_16x16x32_bf16 v[44:47], a[160:163], a[80:83], v[44:47]
    v_fma_f32 v38, v38, s42, -v14
    v_fma_f32 v39, v39, s42, -v14
    v_exp_f32 v36, v36
    v_mfma_f32_16x16x32_bf16 v[48:51], a[160:163], a[84:87], v[48:51]
    v_exp_f32 v37, v37
    v_exp_f32 v38, v38
    v_mfma_f32_16x16x32_bf16 v[52:55], a[160:163], a[88:91], v[52:55]
    v_exp_f32 v39, v39
    v_cvt_pk_bf16_f32 v104, v36, v37
    v_mfma_f32_16x16x32_bf16 v[56:59], a[160:163], a[92:95], v[56:59]
    v_cvt_pk_bf16_f32 v105, v38, v39
    v_max3_f32 v68, v68, v40, v41
    v_mfma_f32_16x16x32_bf16 v[60:63], a[160:163], a[96:99], v[60:63]
    v_max3_f32 v68, v68, v42, v43
    v_fma_f32 v40, v40, s42, -v15
    v_fma_f32 v41, v41, s42, -v15
    v_mfma_f32_16x16x32_bf16 v[44:47], a[164:167], a[100:103], v[44:47]
    v_fma_f32 v42, v42, s42, -v15
    v_fma_f32 v43, v43, s42, -v15
    v_mfma_f32_16x16x32_bf16 v[48:51], a[164:167], a[104:107], v[48:51]
    v_exp_f32 v40, v40
    v_exp_f32 v41, v41
    v_mfma_f32_16x16x32_bf16 v[52:55], a[164:167], a[108:111], v[52:55]
    v_exp_f32 v42, v42
    v_exp_f32 v43, v43
    v_mfma_f32_16x16x32_bf16 v[56:59], a[164:167], a[112:115], v[56:59]
    v_cvt_pk_bf16_f32 v108, v40, v41
    v_cvt_pk_bf16_f32 v109, v42, v43
    v_mfma_f32_16x16x32_bf16 v[60:63], a[164:167], a[116:119], v[60:63]
    s_waitcnt lgkmcnt(5)
    v_mfma_f32_16x16x32_bf16 v[24:27], a[120:123], a[0:3], 0
    v_mfma_f32_16x16x32_bf16 v[28:31], a[120:123], a[4:7], 0
    v_add_u32 v9, 0x3000, v9
    v_mfma_f32_16x16x32_bf16 v[32:35], a[120:123], a[8:11], 0
    v_add_u32 v10, 0x3000, v10
    v_max3_f32 v64, v64, v44, v45
    v_max3_f32 v64, v64, v46, v47
    v_fma_f32 v44, v44, s42, -v11
    v_mfma_f32_16x16x32_bf16 v[36:39], a[120:123], a[12:15], 0
    ds_read_b128 a[144:147], v9
    v_fma_f32 v45, v45, s42, -v11
    v_fma_f32 v46, v46, s42, -v11
    buffer_load_dwordx4 v4, s[16:19], s40 offen offset:2048 nt lds
    v_mfma_f32_16x16x32_bf16 v[40:43], a[120:123], a[16:19], 0
    ds_read_b128 a[148:151], v10
    v_fma_f32 v47, v47, s42, -v11
    v_exp_f32 v44, v44
    s_waitcnt lgkmcnt(6)
    v_mfma_f32_16x16x32_bf16 v[24:27], a[124:127], a[20:23], v[24:27]
    v_exp_f32 v45, v45
    v_exp_f32 v46, v46
    v_mfma_f32_16x16x32_bf16 v[28:31], a[124:127], a[24:27], v[28:31]
    ds_read_b128 a[152:155], v9 offset:128
    v_exp_f32 v47, v47
    v_cvt_pk_bf16_f32 v94, v44, v45
    v_cvt_pk_bf16_f32 v95, v46, v47
    v_mfma_f32_16x16x32_bf16 v[32:35], a[124:127], a[28:31], v[32:35]
    ds_read_b128 a[156:159], v10 offset:128
    v_max3_f32 v65, v65, v48, v49
    v_max3_f32 v65, v65, v50, v51
    v_mfma_f32_16x16x32_bf16 v[36:39], a[124:127], a[32:35], v[36:39]
    ds_read_b128 a[160:163], v9 offset:256
    v_fma_f32 v48, v48, s42, -v12
    v_fma_f32 v49, v49, s42, -v12
    v_mfma_f32_16x16x32_bf16 v[40:43], a[124:127], a[36:39], v[40:43]
    ds_read_b128 a[164:167], v10 offset:256
    v_fma_f32 v50, v50, s42, -v12
    v_fma_f32 v51, v51, s42, -v12
    s_waitcnt lgkmcnt(9)
    v_mfma_f32_16x16x32_bf16 v[24:27], a[128:131], a[40:43], v[24:27]
    v_exp_f32 v48, v48
    v_exp_f32 v49, v49
    v_mfma_f32_16x16x32_bf16 v[28:31], a[128:131], a[44:47], v[28:31]
    v_exp_f32 v50, v50
    v_exp_f32 v51, v51
    v_cvt_pk_bf16_f32 v98, v48, v49
    s_mov_b32 s40, 122880
    s_add_u32 m0, s36, 98304
    s_nop 0
    buffer_load_dwordx4 v2, s[16:19], s40 offen nt lds
    v_mfma_f32_16x16x32_bf16 v[32:35], a[128:131], a[48:51], v[32:35]
    v_cvt_pk_bf16_f32 v99, v50, v51
    v_max3_f32 v66, v66, v52, v53
    v_mfma_f32_16x16x32_bf16 v[36:39], a[128:131], a[52:55], v[36:39]
    v_max3_f32 v66, v66, v54, v55
    v_fma_f32 v52, v52, s42, -v13
    v_mfma_f32_16x16x32_bf16 v[40:43], a[128:131], a[56:59], v[40:43]
    v_fma_f32 v53, v53, s42, -v13
    v_fma_f32 v54, v54, s42, -v13
    s_waitcnt lgkmcnt(8)
    v_mfma_f32_16x16x32_bf16 v[24:27], a[132:135], a[60:63], v[24:27]
    v_fma_f32 v55, v55, s42, -v13
    v_exp_f32 v52, v52
    v_exp_f32 v53, v53
    v_mfma_f32_16x16x32_bf16 v[28:31], a[132:135], a[64:67], v[28:31]
    v_exp_f32 v54, v54
    v_exp_f32 v55, v55
    v_mfma_f32_16x16x32_bf16 v[32:35], a[132:135], a[68:71], v[32:35]
    v_cvt_pk_bf16_f32 v102, v52, v53
    v_cvt_pk_bf16_f32 v103, v54, v55
    v_mfma_f32_16x16x32_bf16 v[36:39], a[132:135], a[72:75], v[36:39]
    v_max3_f32 v67, v67, v56, v57
    v_max3_f32 v67, v67, v58, v59
    v_mfma_f32_16x16x32_bf16 v[40:43], a[132:135], a[76:79], v[40:43]
    v_fma_f32 v56, v56, s42, -v14
    v_fma_f32 v57, v57, s42, -v14
    buffer_load_dwordx4 v3, s[16:19], s40 offen offset:1024 nt lds
    s_waitcnt lgkmcnt(7)
    v_mfma_f32_16x16x32_bf16 v[24:27], a[136:139], a[80:83], v[24:27]
    v_fma_f32 v58, v58, s42, -v14
    v_fma_f32 v59, v59, s42, -v14
    v_exp_f32 v56, v56
    v_mfma_f32_16x16x32_bf16 v[28:31], a[136:139], a[84:87], v[28:31]
    v_exp_f32 v57, v57
    v_exp_f32 v58, v58
    v_mfma_f32_16x16x32_bf16 v[32:35], a[136:139], a[88:91], v[32:35]
    v_exp_f32 v59, v59
    v_cvt_pk_bf16_f32 v106, v56, v57
    v_mfma_f32_16x16x32_bf16 v[36:39], a[136:139], a[92:95], v[36:39]
    v_cvt_pk_bf16_f32 v107, v58, v59
    v_max3_f32 v68, v68, v60, v61
    v_mfma_f32_16x16x32_bf16 v[40:43], a[136:139], a[96:99], v[40:43]
    v_max3_f32 v68, v68, v62, v63
    v_fma_f32 v60, v60, s42, -v15
    v_fma_f32 v61, v61, s42, -v15
    s_waitcnt lgkmcnt(6)
    v_mfma_f32_16x16x32_bf16 v[24:27], a[140:143], a[100:103], v[24:27]
    v_fma_f32 v62, v62, s42, -v15
    v_fma_f32 v63, v63, s42, -v15
    v_mfma_f32_16x16x32_bf16 v[28:31], a[140:143], a[104:107], v[28:31]
    v_exp_f32 v60, v60
    v_exp_f32 v61, v61
    v_mfma_f32_16x16x32_bf16 v[32:35], a[140:143], a[108:111], v[32:35]
    v_exp_f32 v62, v62
    v_exp_f32 v63, v63
    v_mfma_f32_16x16x32_bf16 v[36:39], a[140:143], a[112:115], v[36:39]
    v_cvt_pk_bf16_f32 v110, v60, v61
    v_cvt_pk_bf16_f32 v111, v62, v63
    v_mfma_f32_16x16x32_bf16 v[40:43], a[140:143], a[116:119], v[40:43]
    s_waitcnt lgkmcnt(0)
    s_waitcnt vmcnt(8)
    s_barrier
    v_mfma_f32_16x16x32_bf16 v[44:47], a[144:147], a[0:3], 0
    v_mfma_f32_16x16x32_bf16 v[48:51], a[144:147], a[4:7], 0
    v_add_u32 v9, 0x3000, v9
    v_mfma_f32_16x16x32_bf16 v[52:55], a[144:147], a[8:11], 0
    v_add_u32 v10, 0x3000, v10
    v_max3_f32 v64, v64, v24, v25
    v_max3_f32 v64, v64, v26, v27
    v_fma_f32 v24, v24, s42, -v11
    v_mfma_f32_16x16x32_bf16 v[56:59], a[144:147], a[12:15], 0
    ds_read_b128 a[120:123], v9
    v_fma_f32 v25, v25, s42, -v11
    v_fma_f32 v26, v26, s42, -v11
    buffer_load_dwordx4 v4, s[16:19], s40 offen offset:2048 nt lds
    v_mfma_f32_16x16x32_bf16 v[60:63], a[144:147], a[16:19], 0
    ds_read_b128 a[124:127], v10
    v_fma_f32 v27, v27, s42, -v11
    v_exp_f32 v24, v24
    v_mfma_f32_16x16x32_bf16 v[44:47], a[148:151], a[20:23], v[44:47]
    v_exp_f32 v25, v25
    v_exp_f32 v26, v26
    v_mfma_f32_16x16x32_bf16 v[48:51], a[148:151], a[24:27], v[48:51]
    ds_read_b128 a[128:131], v9 offset:128
    v_exp_f32 v27, v27
    v_cvt_pk_bf16_f32 v112, v24, v25
    v_cvt_pk_bf16_f32 v113, v26, v27
    v_mfma_f32_16x16x32_bf16 v[52:55], a[148:151], a[28:31], v[52:55]
    ds_read_b128 a[132:135], v10 offset:128
    v_max3_f32 v65, v65, v28, v29
    v_max3_f32 v65, v65, v30, v31
    v_mfma_f32_16x16x32_bf16 v[56:59], a[148:151], a[32:35], v[56:59]
    ds_read_b128 a[136:139], v9 offset:256
    v_fma_f32 v28, v28, s42, -v12
    v_fma_f32 v29, v29, s42, -v12
    v_mfma_f32_16x16x32_bf16 v[60:63], a[148:151], a[36:39], v[60:63]
    ds_read_b128 a[140:143], v10 offset:256
    v_fma_f32 v30, v30, s42, -v12
    v_fma_f32 v31, v31, s42, -v12
    v_mfma_f32_16x16x32_bf16 v[44:47], a[152:155], a[40:43], v[44:47]
    v_exp_f32 v28, v28
    v_exp_f32 v29, v29
    v_mfma_f32_16x16x32_bf16 v[48:51], a[152:155], a[44:47], v[48:51]
    v_exp_f32 v30, v30
    v_exp_f32 v31, v31
    v_cvt_pk_bf16_f32 v116, v28, v29
    s_mov_b32 s40, 135168
    s_add_u32 m0, s36, 110592
    s_nop 0
    buffer_load_dwordx4 v2, s[16:19], s40 offen nt lds
    v_mfma_f32_16x16x32_bf16 v[52:55], a[152:155], a[48:51], v[52:55]
    v_cvt_pk_bf16_f32 v117, v30, v31
    v_max3_f32 v66, v66, v32, v33
    v_mfma_f32_16x16x32_bf16 v[56:59], a[152:155], a[52:55], v[56:59]
    v_max3_f32 v66, v66, v34, v35
    v_fma_f32 v32, v32, s42, -v13
    v_mfma_f32_16x16x32_bf16 v[60:63], a[152:155], a[56:59], v[60:63]
    v_fma_f32 v33, v33, s42, -v13
    v_fma_f32 v34, v34, s42, -v13
    v_mfma_f32_16x16x32_bf16 v[44:47], a[156:159], a[60:63], v[44:47]
    v_fma_f32 v35, v35, s42, -v13
    v_exp_f32 v32, v32
    v_exp_f32 v33, v33
    v_mfma_f32_16x16x32_bf16 v[48:51], a[156:159], a[64:67], v[48:51]
    v_exp_f32 v34, v34
    v_exp_f32 v35, v35
    v_mfma_f32_16x16x32_bf16 v[52:55], a[156:159], a[68:71], v[52:55]
    v_cvt_pk_bf16_f32 v120, v32, v33
    v_cvt_pk_bf16_f32 v121, v34, v35
    v_mfma_f32_16x16x32_bf16 v[56:59], a[156:159], a[72:75], v[56:59]
    v_max3_f32 v67, v67, v36, v37
    v_max3_f32 v67, v67, v38, v39
    v_mfma_f32_16x16x32_bf16 v[60:63], a[156:159], a[76:79], v[60:63]
    v_fma_f32 v36, v36, s42, -v14
    v_fma_f32 v37, v37, s42, -v14
    buffer_load_dwordx4 v3, s[16:19], s40 offen offset:1024 nt lds
    v_mfma_f32_16x16x32_bf16 v[44:47], a[160:163], a[80:83], v[44:47]
    v_fma_f32 v38, v38, s42, -v14
    v_fma_f32 v39, v39, s42, -v14
    v_exp_f32 v36, v36
    v_mfma_f32_16x16x32_bf16 v[48:51], a[160:163], a[84:87], v[48:51]
    v_exp_f32 v37, v37
    v_exp_f32 v38, v38
    v_mfma_f32_16x16x32_bf16 v[52:55], a[160:163], a[88:91], v[52:55]
    v_exp_f32 v39, v39
    v_cvt_pk_bf16_f32 v124, v36, v37
    v_mfma_f32_16x16x32_bf16 v[56:59], a[160:163], a[92:95], v[56:59]
    v_cvt_pk_bf16_f32 v125, v38, v39
    v_max3_f32 v68, v68, v40, v41
    v_mfma_f32_16x16x32_bf16 v[60:63], a[160:163], a[96:99], v[60:63]
    v_max3_f32 v68, v68, v42, v43
    v_fma_f32 v40, v40, s42, -v15
    v_fma_f32 v41, v41, s42, -v15
    v_mfma_f32_16x16x32_bf16 v[44:47], a[164:167], a[100:103], v[44:47]
    v_fma_f32 v42, v42, s42, -v15
    v_fma_f32 v43, v43, s42, -v15
    v_mfma_f32_16x16x32_bf16 v[48:51], a[164:167], a[104:107], v[48:51]
    v_exp_f32 v40, v40
    v_exp_f32 v41, v41
    v_mfma_f32_16x16x32_bf16 v[52:55], a[164:167], a[108:111], v[52:55]
    v_exp_f32 v42, v42
    v_exp_f32 v43, v43
    v_mfma_f32_16x16x32_bf16 v[56:59], a[164:167], a[112:115], v[56:59]
    v_cvt_pk_bf16_f32 v128, v40, v41
    v_cvt_pk_bf16_f32 v129, v42, v43
    v_mfma_f32_16x16x32_bf16 v[60:63], a[164:167], a[116:119], v[60:63]
    s_waitcnt lgkmcnt(5)
    v_mfma_f32_16x16x32_bf16 v[24:27], a[120:123], a[0:3], 0
    v_mfma_f32_16x16x32_bf16 v[28:31], a[120:123], a[4:7], 0
    v_add_u32 v9, 0x3000, v9
    v_mfma_f32_16x16x32_bf16 v[32:35], a[120:123], a[8:11], 0
    v_add_u32 v10, 0x3000, v10
    v_max3_f32 v64, v64, v44, v45
    v_max3_f32 v64, v64, v46, v47
    v_fma_f32 v44, v44, s42, -v11
    v_mfma_f32_16x16x32_bf16 v[36:39], a[120:123], a[12:15], 0
    ds_read_b128 a[144:147], v9
    v_fma_f32 v45, v45, s42, -v11
    v_fma_f32 v46, v46, s42, -v11
    buffer_load_dwordx4 v4, s[16:19], s40 offen offset:2048 nt lds
    v_mfma_f32_16x16x32_bf16 v[40:43], a[120:123], a[16:19], 0
    ds_read_b128 a[148:151], v10
    v_fma_f32 v47, v47, s42, -v11
    v_exp_f32 v44, v44
    s_waitcnt lgkmcnt(6)
    v_mfma_f32_16x16x32_bf16 v[24:27], a[124:127], a[20:23], v[24:27]
    v_exp_f32 v45, v45
    v_exp_f32 v46, v46
    v_mfma_f32_16x16x32_bf16 v[28:31], a[124:127], a[24:27], v[28:31]
    ds_read_b128 a[152:155], v9 offset:128
    v_exp_f32 v47, v47
    v_cvt_pk_bf16_f32 v114, v44, v45
    v_cvt_pk_bf16_f32 v115, v46, v47
    v_mfma_f32_16x16x32_bf16 v[32:35], a[124:127], a[28:31], v[32:35]
    ds_read_b128 a[156:159], v10 offset:128
    v_max3_f32 v65, v65, v48, v49
    v_max3_f32 v65, v65, v50, v51
    v_mfma_f32_16x16x32_bf16 v[36:39], a[124:127], a[32:35], v[36:39]
    ds_read_b128 a[160:163], v9 offset:256
    v_fma_f32 v48, v48, s42, -v12
    v_fma_f32 v49, v49, s42, -v12
    v_mfma_f32_16x16x32_bf16 v[40:43], a[124:127], a[36:39], v[40:43]
    ds_read_b128 a[164:167], v10 offset:256
    v_fma_f32 v50, v50, s42, -v12
    v_fma_f32 v51, v51, s42, -v12
    s_waitcnt lgkmcnt(9)
    v_mfma_f32_16x16x32_bf16 v[24:27], a[128:131], a[40:43], v[24:27]
    v_exp_f32 v48, v48
    v_exp_f32 v49, v49
    v_mfma_f32_16x16x32_bf16 v[28:31], a[128:131], a[44:47], v[28:31]
    v_exp_f32 v50, v50
    v_exp_f32 v51, v51
    v_cvt_pk_bf16_f32 v118, v48, v49
    s_mov_b32 s40, 147456
    s_add_u32 m0, s36, 122880
    s_nop 0
    buffer_load_dwordx4 v2, s[16:19], s40 offen nt lds
    v_mfma_f32_16x16x32_bf16 v[32:35], a[128:131], a[48:51], v[32:35]
    v_cvt_pk_bf16_f32 v119, v50, v51
    v_max3_f32 v66, v66, v52, v53
    v_mfma_f32_16x16x32_bf16 v[36:39], a[128:131], a[52:55], v[36:39]
    v_max3_f32 v66, v66, v54, v55
    v_fma_f32 v52, v52, s42, -v13
    v_mfma_f32_16x16x32_bf16 v[40:43], a[128:131], a[56:59], v[40:43]
    v_fma_f32 v53, v53, s42, -v13
    v_fma_f32 v54, v54, s42, -v13
    s_waitcnt lgkmcnt(8)
    v_mfma_f32_16x16x32_bf16 v[24:27], a[132:135], a[60:63], v[24:27]
    v_fma_f32 v55, v55, s42, -v13
    v_exp_f32 v52, v52
    v_exp_f32 v53, v53
    v_mfma_f32_16x16x32_bf16 v[28:31], a[132:135], a[64:67], v[28:31]
    v_exp_f32 v54, v54
    v_exp_f32 v55, v55
    v_mfma_f32_16x16x32_bf16 v[32:35], a[132:135], a[68:71], v[32:35]
    v_cvt_pk_bf16_f32 v122, v52, v53
    v_cvt_pk_bf16_f32 v123, v54, v55
    v_mfma_f32_16x16x32_bf16 v[36:39], a[132:135], a[72:75], v[36:39]
    v_max3_f32 v67, v67, v56, v57
    v_max3_f32 v67, v67, v58, v59
    v_mfma_f32_16x16x32_bf16 v[40:43], a[132:135], a[76:79], v[40:43]
    v_fma_f32 v56, v56, s42, -v14
    v_fma_f32 v57, v57, s42, -v14
    buffer_load_dwordx4 v3, s[16:19], s40 offen offset:1024 nt lds
    s_waitcnt lgkmcnt(7)
    v_mfma_f32_16x16x32_bf16 v[24:27], a[136:139], a[80:83], v[24:27]
    v_fma_f32 v58, v58, s42, -v14
    v_fma_f32 v59, v59, s42, -v14
    v_exp_f32 v56, v56
    v_mfma_f32_16x16x32_bf16 v[28:31], a[136:139], a[84:87], v[28:31]
    v_exp_f32 v57, v57
    v_exp_f32 v58, v58
    v_mfma_f32_16x16x32_bf16 v[32:35], a[136:139], a[88:91], v[32:35]
    v_exp_f32 v59, v59
    v_cvt_pk_bf16_f32 v126, v56, v57
    v_mfma_f32_16x16x32_bf16 v[36:39], a[136:139], a[92:95], v[36:39]
    v_cvt_pk_bf16_f32 v127, v58, v59
    v_max3_f32 v68, v68, v60, v61
    v_mfma_f32_16x16x32_bf16 v[40:43], a[136:139], a[96:99], v[40:43]
    v_max3_f32 v68, v68, v62, v63
    v_fma_f32 v60, v60, s42, -v15
    v_fma_f32 v61, v61, s42, -v15
    s_waitcnt lgkmcnt(6)
    v_mfma_f32_16x16x32_bf16 v[24:27], a[140:143], a[100:103], v[24:27]
    v_fma_f32 v62, v62, s42, -v15
    v_fma_f32 v63, v63, s42, -v15
    v_mfma_f32_16x16x32_bf16 v[28:31], a[140:143], a[104:107], v[28:31]
    v_exp_f32 v60, v60
    v_exp_f32 v61, v61
    v_mfma_f32_16x16x32_bf16 v[32:35], a[140:143], a[108:111], v[32:35]
    v_exp_f32 v62, v62
    v_exp_f32 v63, v63
    v_mfma_f32_16x16x32_bf16 v[36:39], a[140:143], a[112:115], v[36:39]
    v_cvt_pk_bf16_f32 v130, v60, v61
    v_cvt_pk_bf16_f32 v131, v62, v63
    v_mfma_f32_16x16x32_bf16 v[40:43], a[140:143], a[116:119], v[40:43]
    s_waitcnt lgkmcnt(0)
    s_waitcnt vmcnt(8)
    s_barrier
    v_mfma_f32_16x16x32_bf16 v[44:47], a[144:147], a[0:3], 0
    v_mfma_f32_16x16x32_bf16 v[48:51], a[144:147], a[4:7], 0
    v_add_u32 v9, 0x3000, v9
    v_mfma_f32_16x16x32_bf16 v[52:55], a[144:147], a[8:11], 0
    v_add_u32 v10, 0x3000, v10
    v_max3_f32 v64, v64, v24, v25
    v_max3_f32 v64, v64, v26, v27
    v_fma_f32 v24, v24, s42, -v11
    v_mfma_f32_16x16x32_bf16 v[56:59], a[144:147], a[12:15], 0
    ds_read_b128 a[120:123], v9
    v_fma_f32 v25, v25, s42, -v11
    v_fma_f32 v26, v26, s42, -v11
    buffer_load_dwordx4 v4, s[16:19], s40 offen offset:2048 nt lds
    v_mfma_f32_16x16x32_bf16 v[60:63], a[144:147], a[16:19], 0
    ds_read_b128 a[124:127], v10
    v_fma_f32 v27, v27, s42, -v11
    v_exp_f32 v24, v24
    v_mfma_f32_16x16x32_bf16 v[44:47], a[148:151], a[20:23], v[44:47]
    v_exp_f32 v25, v25
    v_exp_f32 v26, v26
    v_mfma_f32_16x16x32_bf16 v[48:51], a[148:151], a[24:27], v[48:51]
    ds_read_b128 a[128:131], v9 offset:128
    v_exp_f32 v27, v27
    v_cvt_pk_bf16_f32 v132, v24, v25
    v_cvt_pk_bf16_f32 v133, v26, v27
    v_mfma_f32_16x16x32_bf16 v[52:55], a[148:151], a[28:31], v[52:55]
    ds_read_b128 a[132:135], v10 offset:128
    v_max3_f32 v65, v65, v28, v29
    v_max3_f32 v65, v65, v30, v31
    v_mfma_f32_16x16x32_bf16 v[56:59], a[148:151], a[32:35], v[56:59]
    ds_read_b128 a[136:139], v9 offset:256
    v_fma_f32 v28, v28, s42, -v12
    v_fma_f32 v29, v29, s42, -v12
    v_mfma_f32_16x16x32_bf16 v[60:63], a[148:151], a[36:39], v[60:63]
    ds_read_b128 a[140:143], v10 offset:256
    v_fma_f32 v30, v30, s42, -v12
    v_fma_f32 v31, v31, s42, -v12
    v_mfma_f32_16x16x32_bf16 v[44:47], a[152:155], a[40:43], v[44:47]
    v_exp_f32 v28, v28
    v_exp_f32 v29, v29
    v_mfma_f32_16x16x32_bf16 v[48:51], a[152:155], a[44:47], v[48:51]
    v_exp_f32 v30, v30
    v_exp_f32 v31, v31
    v_cvt_pk_bf16_f32 v136, v28, v29
    s_mov_b32 s40, 159744
    s_add_u32 m0, s36, 135168
    s_nop 0
    buffer_load_dwordx4 v2, s[16:19], s40 offen nt lds
    v_mfma_f32_16x16x32_bf16 v[52:55], a[152:155], a[48:51], v[52:55]
    v_cvt_pk_bf16_f32 v137, v30, v31
    v_max3_f32 v66, v66, v32, v33
    v_mfma_f32_16x16x32_bf16 v[56:59], a[152:155], a[52:55], v[56:59]
    v_max3_f32 v66, v66, v34, v35
    v_fma_f32 v32, v32, s42, -v13
    v_mfma_f32_16x16x32_bf16 v[60:63], a[152:155], a[56:59], v[60:63]
    v_fma_f32 v33, v33, s42, -v13
    v_fma_f32 v34, v34, s42, -v13
    v_mfma_f32_16x16x32_bf16 v[44:47], a[156:159], a[60:63], v[44:47]
    v_fma_f32 v35, v35, s42, -v13
    v_exp_f32 v32, v32
    v_exp_f32 v33, v33
    v_mfma_f32_16x16x32_bf16 v[48:51], a[156:159], a[64:67], v[48:51]
    v_exp_f32 v34, v34
    v_exp_f32 v35, v35
    v_mfma_f32_16x16x32_bf16 v[52:55], a[156:159], a[68:71], v[52:55]
    v_cvt_pk_bf16_f32 v140, v32, v33
    v_cvt_pk_bf16_f32 v141, v34, v35
    v_mfma_f32_16x16x32_bf16 v[56:59], a[156:159], a[72:75], v[56:59]
    v_max3_f32 v67, v67, v36, v37
    v_max3_f32 v67, v67, v38, v39
    v_mfma_f32_16x16x32_bf16 v[60:63], a[156:159], a[76:79], v[60:63]
    v_fma_f32 v36, v36, s42, -v14
    v_fma_f32 v37, v37, s42, -v14
    buffer_load_dwordx4 v3, s[16:19], s40 offen offset:1024 nt lds
    v_mfma_f32_16x16x32_bf16 v[44:47], a[160:163], a[80:83], v[44:47]
    v_fma_f32 v38, v38, s42, -v14
    v_fma_f32 v39, v39, s42, -v14
    v_exp_f32 v36, v36
    v_mfma_f32_16x16x32_bf16 v[48:51], a[160:163], a[84:87], v[48:51]
    v_exp_f32 v37, v37
    v_exp_f32 v38, v38
    v_mfma_f32_16x16x32_bf16 v[52:55], a[160:163], a[88:91], v[52:55]
    v_exp_f32 v39, v39
    v_cvt_pk_bf16_f32 v144, v36, v37
    v_mfma_f32_16x16x32_bf16 v[56:59], a[160:163], a[92:95], v[56:59]
    v_cvt_pk_bf16_f32 v145, v38, v39
    v_max3_f32 v68, v68, v40, v41
    v_mfma_f32_16x16x32_bf16 v[60:63], a[160:163], a[96:99], v[60:63]
    v_max3_f32 v68, v68, v42, v43
    v_fma_f32 v40, v40, s42, -v15
    v_fma_f32 v41, v41, s42, -v15
    v_mfma_f32_16x16x32_bf16 v[44:47], a[164:167], a[100:103], v[44:47]
    v_fma_f32 v42, v42, s42, -v15
    v_fma_f32 v43, v43, s42, -v15
    v_mfma_f32_16x16x32_bf16 v[48:51], a[164:167], a[104:107], v[48:51]
    v_exp_f32 v40, v40
    v_exp_f32 v41, v41
    v_mfma_f32_16x16x32_bf16 v[52:55], a[164:167], a[108:111], v[52:55]
    v_exp_f32 v42, v42
    v_exp_f32 v43, v43
    v_mfma_f32_16x16x32_bf16 v[56:59], a[164:167], a[112:115], v[56:59]
    v_cvt_pk_bf16_f32 v148, v40, v41
    v_cvt_pk_bf16_f32 v149, v42, v43
    v_mfma_f32_16x16x32_bf16 v[60:63], a[164:167], a[116:119], v[60:63]
    s_waitcnt lgkmcnt(5)
    v_mfma_f32_16x16x32_bf16 v[24:27], a[120:123], a[0:3], 0
    v_mfma_f32_16x16x32_bf16 v[28:31], a[120:123], a[4:7], 0
    v_add_u32 v9, 0x3000, v9
    v_mfma_f32_16x16x32_bf16 v[32:35], a[120:123], a[8:11], 0
    v_add_u32 v10, 0x3000, v10
    v_max3_f32 v64, v64, v44, v45
    v_max3_f32 v64, v64, v46, v47
    v_fma_f32 v44, v44, s42, -v11
    v_mfma_f32_16x16x32_bf16 v[36:39], a[120:123], a[12:15], 0
    ds_read_b128 a[144:147], v9
    v_fma_f32 v45, v45, s42, -v11
    v_fma_f32 v46, v46, s42, -v11
    buffer_load_dwordx4 v4, s[16:19], s40 offen offset:2048 nt lds
    v_mfma_f32_16x16x32_bf16 v[40:43], a[120:123], a[16:19], 0
    ds_read_b128 a[148:151], v10
    v_fma_f32 v47, v47, s42, -v11
    v_exp_f32 v44, v44
    s_waitcnt lgkmcnt(6)
    v_mfma_f32_16x16x32_bf16 v[24:27], a[124:127], a[20:23], v[24:27]
    v_exp_f32 v45, v45
    v_exp_f32 v46, v46
    v_exp_f32 v47, v47
    v_mfma_f32_16x16x32_bf16 v[28:31], a[124:127], a[24:27], v[28:31]
    ds_read_b128 a[152:155], v9 offset:128
    v_cvt_pk_bf16_f32 v134, v44, v45
    v_cvt_pk_bf16_f32 v135, v46, v47
    v_mfma_f32_16x16x32_bf16 v[32:35], a[124:127], a[28:31], v[32:35]
    ds_read_b128 a[156:159], v10 offset:128
    v_max3_f32 v65, v65, v48, v49
    v_max3_f32 v65, v65, v50, v51
    v_mfma_f32_16x16x32_bf16 v[36:39], a[124:127], a[32:35], v[36:39]
    ds_read_b128 a[160:163], v9 offset:256
    v_fma_f32 v48, v48, s42, -v12
    v_fma_f32 v49, v49, s42, -v12
    v_mfma_f32_16x16x32_bf16 v[40:43], a[124:127], a[36:39], v[40:43]
    ds_read_b128 a[164:167], v10 offset:256
    v_fma_f32 v50, v50, s42, -v12
    v_fma_f32 v51, v51, s42, -v12
    v_exp_f32 v48, v48
    s_waitcnt lgkmcnt(9)
    v_mfma_f32_16x16x32_bf16 v[24:27], a[128:131], a[40:43], v[24:27]
    v_exp_f32 v49, v49
    v_exp_f32 v50, v50
    v_mfma_f32_16x16x32_bf16 v[28:31], a[128:131], a[44:47], v[28:31]
    v_exp_f32 v51, v51
    v_cvt_pk_bf16_f32 v138, v48, v49
    s_mov_b32 s40, 172032
    s_add_u32 m0, s36, 147456
    s_nop 0
    buffer_load_dwordx4 v2, s[16:19], s40 offen nt lds
    v_mfma_f32_16x16x32_bf16 v[32:35], a[128:131], a[48:51], v[32:35]
    v_cvt_pk_bf16_f32 v139, v50, v51
    v_max3_f32 v66, v66, v52, v53
    v_mfma_f32_16x16x32_bf16 v[36:39], a[128:131], a[52:55], v[36:39]
    v_max3_f32 v66, v66, v54, v55
    v_fma_f32 v52, v52, s42, -v13
    v_fma_f32 v53, v53, s42, -v13
    v_mfma_f32_16x16x32_bf16 v[40:43], a[128:131], a[56:59], v[40:43]
    v_fma_f32 v54, v54, s42, -v13
    v_fma_f32 v55, v55, s42, -v13
    s_waitcnt lgkmcnt(8)
    v_mfma_f32_16x16x32_bf16 v[24:27], a[132:135], a[60:63], v[24:27]
    v_exp_f32 v52, v52
    v_exp_f32 v53, v53
    v_mfma_f32_16x16x32_bf16 v[28:31], a[132:135], a[64:67], v[28:31]
    v_exp_f32 v54, v54
    v_exp_f32 v55, v55
    v_mfma_f32_16x16x32_bf16 v[32:35], a[132:135], a[68:71], v[32:35]
    v_cvt_pk_bf16_f32 v142, v52, v53
    v_cvt_pk_bf16_f32 v143, v54, v55
    v_max3_f32 v67, v67, v56, v57
    v_mfma_f32_16x16x32_bf16 v[36:39], a[132:135], a[72:75], v[36:39]
    v_max3_f32 v67, v67, v58, v59
    v_fma_f32 v56, v56, s42, -v14
    v_mfma_f32_16x16x32_bf16 v[40:43], a[132:135], a[76:79], v[40:43]
    v_fma_f32 v57, v57, s42, -v14
    v_fma_f32 v58, v58, s42, -v14
    buffer_load_dwordx4 v3, s[16:19], s40 offen offset:1024 nt lds
    s_waitcnt lgkmcnt(7)
    v_mfma_f32_16x16x32_bf16 v[24:27], a[136:139], a[80:83], v[24:27]
    v_fma_f32 v59, v59, s42, -v14
    v_exp_f32 v56, v56
    v_mfma_f32_16x16x32_bf16 v[28:31], a[136:139], a[84:87], v[28:31]
    v_exp_f32 v57, v57
    v_exp_f32 v58, v58
    v_exp_f32 v59, v59
    v_mfma_f32_16x16x32_bf16 v[32:35], a[136:139], a[88:91], v[32:35]
    v_cvt_pk_bf16_f32 v146, v56, v57
    v_cvt_pk_bf16_f32 v147, v58, v59
    v_mfma_f32_16x16x32_bf16 v[36:39], a[136:139], a[92:95], v[36:39]
    v_max3_f32 v68, v68, v60, v61
    v_max3_f32 v68, v68, v62, v63
    v_mfma_f32_16x16x32_bf16 v[40:43], a[136:139], a[96:99], v[40:43]
    v_fma_f32 v60, v60, s42, -v15
    v_fma_f32 v61, v61, s42, -v15
    s_waitcnt lgkmcnt(6)
    v_mfma_f32_16x16x32_bf16 v[24:27], a[140:143], a[100:103], v[24:27]
    v_fma_f32 v62, v62, s42, -v15
    v_fma_f32 v63, v63, s42, -v15
    v_exp_f32 v60, v60
    v_mfma_f32_16x16x32_bf16 v[28:31], a[140:143], a[104:107], v[28:31]
    v_exp_f32 v61, v61
    v_exp_f32 v62, v62
    v_mfma_f32_16x16x32_bf16 v[32:35], a[140:143], a[108:111], v[32:35]
    v_exp_f32 v63, v63
    v_cvt_pk_bf16_f32 v150, v60, v61
    v_mfma_f32_16x16x32_bf16 v[36:39], a[140:143], a[112:115], v[36:39]
    v_cvt_pk_bf16_f32 v151, v62, v63
    s_getpc_b64 s[90:91]
CODE_REF2:
    v_and_b32 v1, 15, v0
    s_lshr_b32 s33, s2, 3
    s_and_b32 s33, s33, 31
    s_lshl_b32 s33, s33, 4
    v_add_u32 v1, s33, v1
    v_lshlrev_b32 v1, 7, v1
    v_min_u32 v1, CODE_END-CODE_REF2-4, v1
    v_and_b32 v1, 0xfffffffc, v1
    v_mov_b32 v7, s91
    v_add_co_u32 v6, vcc, s90, v1
    s_nop 1
    v_addc_co_u32 v7, vcc, 0, v7, vcc
    global_load_dword v8, v[6:7], off
    v_mfma_f32_16x16x32_bf16 v[40:43], a[140:143], a[116:119], v[40:43]
    s_waitcnt lgkmcnt(0)
    s_waitcnt vmcnt(9)
    s_barrier
    v_mfma_f32_16x16x32_bf16 v[44:47], a[144:147], a[0:3], 0
    v_mfma_f32_16x16x32_bf16 v[48:51], a[144:147], a[4:7], 0
    v_add_u32 v9, 0x3000, v9
    v_mfma_f32_16x16x32_bf16 v[52:55], a[144:147], a[8:11], 0
    v_add_u32 v10, 0x3000, v10
    v_max3_f32 v64, v64, v24, v25
    v_max3_f32 v64, v64, v26, v27
    v_fma_f32 v24, v24, s42, -v11
    v_mfma_f32_16x16x32_bf16 v[56:59], a[144:147], a[12:15], 0
    ds_read_b128 a[120:123], v9
    v_fma_f32 v25, v25, s42, -v11
    v_fma_f32 v26, v26, s42, -v11
    buffer_load_dwordx4 v4, s[16:19], s40 offen offset:2048 nt lds
    v_mfma_f32_16x16x32_bf16 v[60:63], a[144:147], a[16:19], 0
    ds_read_b128 a[124:127], v10
    v_fma_f32 v27, v27, s42, -v11
    v_exp_f32 v24, v24
    v_mfma_f32_16x16x32_bf16 v[44:47], a[148:151], a[20:23], v[44:47]
    v_exp_f32 v25, v25
    v_exp_f32 v26, v26
    v_mfma_f32_16x16x32_bf16 v[48:51], a[148:151], a[24:27], v[48:51]
    ds_read_b128 a[128:131], v9 offset:128
    v_exp_f32 v27, v27
    v_cvt_pk_bf16_f32 v152, v24, v25
    v_cvt_pk_bf16_f32 v153, v26, v27
    v_mfma_f32_16x16x32_bf16 v[52:55], a[148:151], a[28:31], v[52:55]
    ds_read_b128 a[132:135], v10 offset:128
    v_max3_f32 v65, v65, v28, v29
    v_max3_f32 v65, v65, v30, v31
    v_mfma_f32_16x16x32_bf16 v[56:59], a[148:151], a[32:35], v[56:59]
    ds_read_b128 a[136:139], v9 offset:256
    v_fma_f32 v28, v28, s42, -v12
    v_fma_f32 v29, v29, s42, -v12
    v_mfma_f32_16x16x32_bf16 v[60:63], a[148:151], a[36:39], v[60:63]
    ds_read_b128 a[140:143], v10 offset:256
    v_fma_f32 v30, v30, s42, -v12
    v_fma_f32 v31, v31, s42, -v12
    v_mfma_f32_16x16x32_bf16 v[44:47], a[152:155], a[40:43], v[44:47]
    v_exp_f32 v28, v28
    v_exp_f32 v29, v29
    v_mfma_f32_16x16x32_bf16 v[48:51], a[152:155], a[44:47], v[48:51]
    v_exp_f32 v30, v30
    v_exp_f32 v31, v31
    v_cvt_pk_bf16_f32 v156, v28, v29
    s_mov_b32 s40, 184320
    s_add_u32 m0, s36, 0
    s_nop 0
    buffer_load_dwordx4 v2, s[16:19], s40 offen nt lds
    v_mfma_f32_16x16x32_bf16 v[52:55], a[152:155], a[48:51], v[52:55]
    v_cvt_pk_bf16_f32 v157, v30, v31
    v_max3_f32 v66, v66, v32, v33
    v_mfma_f32_16x16x32_bf16 v[56:59], a[152:155], a[52:55], v[56:59]
    v_max3_f32 v66, v66, v34, v35
    v_fma_f32 v32, v32, s42, -v13
    v_mfma_f32_16x16x32_bf16 v[60:63], a[152:155], a[56:59], v[60:63]
    v_fma_f32 v33, v33, s42, -v13
    v_fma_f32 v34, v34, s42, -v13
    v_mfma_f32_16x16x32_bf16 v[44:47], a[156:159], a[60:63], v[44:47]
    v_fma_f32 v35, v35, s42, -v13
    v_exp_f32 v32, v32
    v_exp_f32 v33, v33
    v_mfma_f32_16x16x32_bf16 v[48:51], a[156:159], a[64:67], v[48:51]
    v_exp_f32 v34, v34
    v_exp_f32 v35, v35
    v_mfma_f32_16x16x32_bf16 v[52:55], a[156:159], a[68:71], v[52:55]
    v_cvt_pk_bf16_f32 v160, v32, v33
    v_cvt_pk_bf16_f32 v161, v34, v35
    v_mfma_f32_16x16x32_bf16 v[56:59], a[156:159], a[72:75], v[56:59]
    v_max3_f32 v67, v67, v36, v37
    v_max3_f32 v67, v67, v38, v39
    v_mfma_f32_16x16x32_bf16 v[60:63], a[156:159], a[76:79], v[60:63]
    v_fma_f32 v36, v36, s42, -v14
    v_fma_f32 v37, v37, s42, -v14
    buffer_load_dwordx4 v3, s[16:19], s40 offen offset:1024 nt lds
    v_mfma_f32_16x16x32_bf16 v[44:47], a[160:163], a[80:83], v[44:47]
    v_fma_f32 v38, v38, s42, -v14
    v_fma_f32 v39, v39, s42, -v14
    v_exp_f32 v36, v36
    v_mfma_f32_16x16x32_bf16 v[48:51], a[160:163], a[84:87], v[48:51]
    v_exp_f32 v37, v37
    v_exp_f32 v38, v38
    v_mfma_f32_16x16x32_bf16 v[52:55], a[160:163], a[88:91], v[52:55]
    v_exp_f32 v39, v39
    v_cvt_pk_bf16_f32 v164, v36, v37
    v_mfma_f32_16x16x32_bf16 v[56:59], a[160:163], a[92:95], v[56:59]
    v_cvt_pk_bf16_f32 v165, v38, v39
    v_max3_f32 v68, v68, v40, v41
    v_mfma_f32_16x16x32_bf16 v[60:63], a[160:163], a[96:99], v[60:63]
    v_max3_f32 v68, v68, v42, v43
    v_fma_f32 v40, v40, s42, -v15
    v_fma_f32 v41, v41, s42, -v15
    v_mfma_f32_16x16x32_bf16 v[44:47], a[164:167], a[100:103], v[44:47]
    v_fma_f32 v42, v42, s42, -v15
    v_fma_f32 v43, v43, s42, -v15
    v_mfma_f32_16x16x32_bf16 v[48:51], a[164:167], a[104:107], v[48:51]
    v_exp_f32 v40, v40
    v_exp_f32 v41, v41
    v_mfma_f32_16x16x32_bf16 v[52:55], a[164:167], a[108:111], v[52:55]
    v_exp_f32 v42, v42
    v_exp_f32 v43, v43
    v_mfma_f32_16x16x32_bf16 v[56:59], a[164:167], a[112:115], v[56:59]
    v_cvt_pk_bf16_f32 v168, v40, v41
    v_cvt_pk_bf16_f32 v169, v42, v43
    v_mfma_f32_16x16x32_bf16 v[60:63], a[164:167], a[116:119], v[60:63]
    s_waitcnt lgkmcnt(5)
    v_mfma_f32_16x16x32_bf16 v[24:27], a[120:123], a[0:3], 0
    v_mfma_f32_16x16x32_bf16 v[28:31], a[120:123], a[4:7], 0
    v_add_u32 v9, 0x3000, v9
    v_mfma_f32_16x16x32_bf16 v[32:35], a[120:123], a[8:11], 0
    v_add_u32 v10, 0x3000, v10
    v_max3_f32 v64, v64, v44, v45
    v_max3_f32 v64, v64, v46, v47
    v_fma_f32 v44, v44, s42, -v11
    v_mfma_f32_16x16x32_bf16 v[36:39], a[120:123], a[12:15], 0
    ds_read_b128 a[144:147], v9
    v_fma_f32 v45, v45, s42, -v11
    v_fma_f32 v46, v46, s42, -v11
    buffer_load_dwordx4 v4, s[16:19], s40 offen offset:2048 nt lds
    v_mfma_f32_16x16x32_bf16 v[40:43], a[120:123], a[16:19], 0
    ds_read_b128 a[148:151], v10
    v_fma_f32 v47, v47, s42, -v11
    v_exp_f32 v44, v44
    s_waitcnt lgkmcnt(6)
    v_mfma_f32_16x16x32_bf16 v[24:27], a[124:127], a[20:23], v[24:27]
    v_exp_f32 v45, v45
    v_exp_f32 v46, v46
    v_mfma_f32_16x16x32_bf16 v[28:31], a[124:127], a[24:27], v[28:31]
    ds_read_b128 a[152:155], v9 offset:128
    v_exp_f32 v47, v47
    v_cvt_pk_bf16_f32 v154, v44, v45
    v_cvt_pk_bf16_f32 v155, v46, v47
    v_mfma_f32_16x16x32_bf16 v[32:35], a[124:127], a[28:31], v[32:35]
    ds_read_b128 a[156:159], v10 offset:128
    v_max3_f32 v65, v65, v48, v49
    v_max3_f32 v65, v65, v50, v51
    v_mfma_f32_16x16x32_bf16 v[36:39], a[124:127], a[32:35], v[36:39]
    ds_read_b128 a[160:163], v9 offset:256
    v_fma_f32 v48, v48, s42, -v12
    v_fma_f32 v49, v49, s42, -v12
    v_mfma_f32_16x16x32_bf16 v[40:43], a[124:127], a[36:39], v[40:43]
    ds_read_b128 a[164:167], v10 offset:256
    v_fma_f32 v50, v50, s42, -v12
    v_fma_f32 v51, v51, s42, -v12
    s_waitcnt lgkmcnt(9)
    v_mfma_f32_16x16x32_bf16 v[24:27], a[128:131], a[40:43], v[24:27]
    v_exp_f32 v48, v48
    v_exp_f32 v49, v49
    v_mfma_f32_16x16x32_bf16 v[28:31], a[128:131], a[44:47], v[28:31]
    v_exp_f32 v50, v50
    v_exp_f32 v51, v51
    v_cvt_pk_bf16_f32 v158, v48, v49
    s_mov_b32 s41, 0
    s_add_u32 m0, s37, 12288
    s_nop 0
    buffer_load_dwordx4 v5, s[20:23], s41 offen nt lds
    v_mfma_f32_16x16x32_bf16 v[32:35], a[128:131], a[48:51], v[32:35]
    v_cvt_pk_bf16_f32 v159, v50, v51
    v_max3_f32 v66, v66, v52, v53
    v_mfma_f32_16x16x32_bf16 v[36:39], a[128:131], a[52:55], v[36:39]
    v_max3_f32 v66, v66, v54, v55
    v_fma_f32 v52, v52, s42, -v13
    v_mfma_f32_16x16x32_bf16 v[40:43], a[128:131], a[56:59], v[40:43]
    v_fma_f32 v53, v53, s42, -v13
    v_fma_f32 v54, v54, s42, -v13
    s_waitcnt lgkmcnt(8)
    v_mfma_f32_16x16x32_bf16 v[24:27], a[132:135], a[60:63], v[24:27]
    v_fma_f32 v55, v55, s42, -v13
    v_exp_f32 v52, v52
    v_exp_f32 v53, v53
    v_mfma_f32_16x16x32_bf16 v[28:31], a[132:135], a[64:67], v[28:31]
    v_exp_f32 v54, v54
    v_exp_f32 v55, v55
    v_mfma_f32_16x16x32_bf16 v[32:35], a[132:135], a[68:71], v[32:35]
    v_cvt_pk_bf16_f32 v162, v52, v53
    v_cvt_pk_bf16_f32 v163, v54, v55
    v_mfma_f32_16x16x32_bf16 v[36:39], a[132:135], a[72:75], v[36:39]
    v_max3_f32 v67, v67, v56, v57
    v_max3_f32 v67, v67, v58, v59
    v_mfma_f32_16x16x32_bf16 v[40:43], a[132:135], a[76:79], v[40:43]
    v_fma_f32 v56, v56, s42, -v14
    v_fma_f32 v57, v57, s42, -v14
    s_mov_b32 s41, 2048
    buffer_load_dwordx4 v5, s[20:23], s41 offen offset:1024 nt lds
    s_waitcnt lgkmcnt(7)
    v_mfma_f32_16x16x32_bf16 v[24:27], a[136:139], a[80:83], v[24:27]
    v_fma_f32 v58, v58, s42, -v14
    v_fma_f32 v59, v59, s42, -v14
    v_exp_f32 v56, v56
    v_mfma_f32_16x16x32_bf16 v[28:31], a[136:139], a[84:87], v[28:31]
    v_exp_f32 v57, v57
    v_exp_f32 v58, v58
    v_mfma_f32_16x16x32_bf16 v[32:35], a[136:139], a[88:91], v[32:35]
    v_exp_f32 v59, v59
    v_cvt_pk_bf16_f32 v166, v56, v57
    v_mfma_f32_16x16x32_bf16 v[36:39], a[136:139], a[92:95], v[36:39]
    v_cvt_pk_bf16_f32 v167, v58, v59
    v_max3_f32 v68, v68, v60, v61
    v_mfma_f32_16x16x32_bf16 v[40:43], a[136:139], a[96:99], v[40:43]
    v_max3_f32 v68, v68, v62, v63
    v_fma_f32 v60, v60, s42, -v15
    v_fma_f32 v61, v61, s42, -v15
    s_waitcnt lgkmcnt(6)
    v_mfma_f32_16x16x32_bf16 v[24:27], a[140:143], a[100:103], v[24:27]
    v_fma_f32 v62, v62, s42, -v15
    v_fma_f32 v63, v63, s42, -v15
    v_mfma_f32_16x16x32_bf16 v[28:31], a[140:143], a[104:107], v[28:31]
    v_exp_f32 v60, v60
    v_exp_f32 v61, v61
    v_mfma_f32_16x16x32_bf16 v[32:35], a[140:143], a[108:111], v[32:35]
    v_exp_f32 v62, v62
    v_exp_f32 v63, v63
    v_mfma_f32_16x16x32_bf16 v[36:39], a[140:143], a[112:115], v[36:39]
    v_cvt_pk_bf16_f32 v170, v60, v61
    v_cvt_pk_bf16_f32 v171, v62, v63
    v_mfma_f32_16x16x32_bf16 v[40:43], a[140:143], a[116:119], v[40:43]
    s_waitcnt lgkmcnt(0)
    s_waitcnt vmcnt(9)
    s_barrier
    v_mfma_f32_16x16x32_bf16 v[44:47], a[144:147], a[0:3], 0
    v_mfma_f32_16x16x32_bf16 v[48:51], a[144:147], a[4:7], 0
    v_add_u32 v9, 0x3000, v9
    v_mfma_f32_16x16x32_bf16 v[52:55], a[144:147], a[8:11], 0
    v_add_u32 v10, 0x3000, v10
    v_max3_f32 v64, v64, v24, v25
    v_max3_f32 v64, v64, v26, v27
    v_fma_f32 v24, v24, s42, -v11
    v_mfma_f32_16x16x32_bf16 v[56:59], a[144:147], a[12:15], 0
    ds_read_b128 a[120:123], v9
    v_fma_f32 v25, v25, s42, -v11
    v_fma_f32 v26, v26, s42, -v11
    s_mov_b32 s41, 4096
    buffer_load_dwordx4 v5, s[20:23], s41 offen offset:2048 nt lds
    v_mfma_f32_16x16x32_bf16 v[60:63], a[144:147], a[16:19], 0
    ds_read_b128 a[124:127], v10
    v_fma_f32 v27, v27, s42, -v11
    v_exp_f32 v24, v24
    v_mfma_f32_16x16x32_bf16 v[44:47], a[148:151], a[20:23], v[44:47]
    v_exp_f32 v25, v25
    v_exp_f32 v26, v26
    v_mfma_f32_16x16x32_bf16 v[48:51], a[148:151], a[24:27], v[48:51]
    ds_read_b128 a[128:131], v9 offset:128
    v_exp_f32 v27, v27
    v_cvt_pk_bf16_f32 v172, v24, v25
    v_cvt_pk_bf16_f32 v173, v26, v27
    v_mfma_f32_16x16x32_bf16 v[52:55], a[148:151], a[28:31], v[52:55]
    ds_read_b128 a[132:135], v10 offset:128
    v_max3_f32 v65, v65, v28, v29
    v_max3_f32 v65, v65, v30, v31
    v_mfma_f32_16x16x32_bf16 v[56:59], a[148:151], a[32:35], v[56:59]
    ds_read_b128 a[136:139], v9 offset:256
    v_fma_f32 v28, v28, s42, -v12
    v_fma_f32 v29, v29, s42, -v12
    v_mfma_f32_16x16x32_bf16 v[60:63], a[148:151], a[36:39], v[60:63]
    ds_read_b128 a[140:143], v10 offset:256
    v_fma_f32 v30, v30, s42, -v12
    v_fma_f32 v31, v31, s42, -v12
    v_mfma_f32_16x16x32_bf16 v[44:47], a[152:155], a[40:43], v[44:47]
    v_exp_f32 v28, v28
    v_exp_f32 v29, v29
    v_mfma_f32_16x16x32_bf16 v[48:51], a[152:155], a[44:47], v[48:51]
    v_exp_f32 v30, v30
    v_exp_f32 v31, v31
    v_cvt_pk_bf16_f32 v176, v28, v29
    s_mov_b32 s41, 6144
    buffer_load_dwordx4 v5, s[20:23], s41 offen offset:3072 nt lds
    v_mfma_f32_16x16x32_bf16 v[52:55], a[152:155], a[48:51], v[52:55]
    v_cvt_pk_bf16_f32 v177, v30, v31
    v_max3_f32 v66, v66, v32, v33
    v_mfma_f32_16x16x32_bf16 v[56:59], a[152:155], a[52:55], v[56:59]
    v_max3_f32 v66, v66, v34, v35
    v_fma_f32 v32, v32, s42, -v13
    v_mfma_f32_16x16x32_bf16 v[60:63], a[152:155], a[56:59], v[60:63]
    v_fma_f32 v33, v33, s42, -v13
    v_fma_f32 v34, v34, s42, -v13
    v_mfma_f32_16x16x32_bf16 v[44:47], a[156:159], a[60:63], v[44:47]
    v_fma_f32 v35, v35, s42, -v13
    v_exp_f32 v32, v32
    v_exp_f32 v33, v33
    v_mfma_f32_16x16x32_bf16 v[48:51], a[156:159], a[64:67], v[48:51]
    v_exp_f32 v34, v34
    v_exp_f32 v35, v35
    v_mfma_f32_16x16x32_bf16 v[52:55], a[156:159], a[68:71], v[52:55]
    v_cvt_pk_bf16_f32 v180, v32, v33
    v_cvt_pk_bf16_f32 v181, v34, v35
    v_mfma_f32_16x16x32_bf16 v[56:59], a[156:159], a[72:75], v[56:59]
    v_max3_f32 v67, v67, v36, v37
    v_max3_f32 v67, v67, v38, v39
    v_mfma_f32_16x16x32_bf16 v[60:63], a[156:159], a[76:79], v[60:63]
    v_fma_f32 v36, v36, s42, -v14
    v_fma_f32 v37, v37, s42, -v14
    s_mov_b32 s41, 49152
    s_add_u32 m0, s37, 28672
    s_nop 0
    buffer_load_dwordx4 v5, s[20:23], s41 offen nt lds
    v_mfma_f32_16x16x32_bf16 v[44:47], a[160:163], a[80:83], v[44:47]
    v_fma_f32 v38, v38, s42, -v14
    v_fma_f32 v39, v39, s42, -v14
    v_exp_f32 v36, v36
    v_mfma_f32_16x16x32_bf16 v[48:51], a[160:163], a[84:87], v[48:51]
    v_exp_f32 v37, v37
    v_exp_f32 v38, v38
    v_mfma_f32_16x16x32_bf16 v[52:55], a[160:163], a[88:91], v[52:55]
    v_exp_f32 v39, v39
    v_cvt_pk_bf16_f32 v184, v36, v37
    v_mfma_f32_16x16x32_bf16 v[56:59], a[160:163], a[92:95], v[56:59]
    v_cvt_pk_bf16_f32 v185, v38, v39
    v_max3_f32 v68, v68, v40, v41
    v_mfma_f32_16x16x32_bf16 v[60:63], a[160:163], a[96:99], v[60:63]
    v_max3_f32 v68, v68, v42, v43
    v_fma_f32 v40, v40, s42, -v15
    v_fma_f32 v41, v41, s42, -v15
    v_mfma_f32_16x16x32_bf16 v[44:47], a[164:167], a[100:103], v[44:47]
    v_fma_f32 v42, v42, s42, -v15
    v_fma_f32 v43, v43, s42, -v15
    v_mfma_f32_16x16x32_bf16 v[48:51], a[164:167], a[104:107], v[48:51]
    v_exp_f32 v40, v40
    v_exp_f32 v41, v41
    v_mfma_f32_16x16x32_bf16 v[52:55], a[164:167], a[108:111], v[52:55]
    v_exp_f32 v42, v42
    v_exp_f32 v43, v43
    v_mfma_f32_16x16x32_bf16 v[56:59], a[164:167], a[112:115], v[56:59]
    v_cvt_pk_bf16_f32 v188, v40, v41
    v_cvt_pk_bf16_f32 v189, v42, v43
    v_mfma_f32_16x16x32_bf16 v[60:63], a[164:167], a[116:119], v[60:63]
    s_waitcnt lgkmcnt(5)
    v_mfma_f32_16x16x32_bf16 v[24:27], a[120:123], a[0:3], 0
    v_mfma_f32_16x16x32_bf16 v[28:31], a[120:123], a[4:7], 0
    v_add_u32 v9, 0x3000, v9
    v_mfma_f32_16x16x32_bf16 v[32:35], a[120:123], a[8:11], 0
    v_add_u32 v10, 0x3000, v10
    v_max3_f32 v64, v64, v44, v45
    v_max3_f32 v64, v64, v46, v47
    v_fma_f32 v44, v44, s42, -v11
    v_fma_f32 v45, v45, s42, -v11
    v_mfma_f32_16x16x32_bf16 v[36:39], a[120:123], a[12:15], 0
    ds_read_b128 a[144:147], v9
    v_fma_f32 v46, v46, s42, -v11
    v_fma_f32 v47, v47, s42, -v11
    v_exp_f32 v44, v44
    s_mov_b32 s41, 51200
    buffer_load_dwordx4 v5, s[20:23], s41 offen offset:1024 nt lds
    v_mfma_f32_16x16x32_bf16 v[40:43], a[120:123], a[16:19], 0
    ds_read_b128 a[148:151], v10
    v_exp_f32 v45, v45
    v_exp_f32 v46, v46
    v_exp_f32 v47, v47
    s_waitcnt lgkmcnt(6)
    v_mfma_f32_16x16x32_bf16 v[24:27], a[124:127], a[20:23], v[24:27]
    v_cvt_pk_bf16_f32 v174, v44, v45
    v_cvt_pk_bf16_f32 v175, v46, v47
    v_max3_f32 v65, v65, v48, v49
    v_mfma_f32_16x16x32_bf16 v[28:31], a[124:127], a[24:27], v[28:31]
    ds_read_b128 a[152:155], v9 offset:128
    v_max3_f32 v65, v65, v50, v51
    v_fma_f32 v48, v48, s42, -v12
    v_fma_f32 v49, v49, s42, -v12
    v_mfma_f32_16x16x32_bf16 v[32:35], a[124:127], a[28:31], v[32:35]
    ds_read_b128 a[156:159], v10 offset:128
    v_fma_f32 v50, v50, s42, -v12
    v_fma_f32 v51, v51, s42, -v12
    v_exp_f32 v48, v48
    v_mfma_f32_16x16x32_bf16 v[36:39], a[124:127], a[32:35], v[36:39]
    ds_read_b128 a[160:163], v9 offset:256
    v_exp_f32 v49, v49
    v_exp_f32 v50, v50
    v_exp_f32 v51, v51
    v_cvt_pk_bf16_f32 v178, v48, v49
    v_mfma_f32_16x16x32_bf16 v[40:43], a[124:127], a[36:39], v[40:43]
    ds_read_b128 a[164:167], v10 offset:256
    v_cvt_pk_bf16_f32 v179, v50, v51
    v_max3_f32 v66, v66, v52, v53
    v_max3_f32 v66, v66, v54, v55
    s_waitcnt lgkmcnt(9)
    v_mfma_f32_16x16x32_bf16 v[24:27], a[128:131], a[40:43], v[24:27]
    v_fma_f32 v52, v52, s42, -v13
    v_fma_f32 v53, v53, s42, -v13
    v_fma_f32 v54, v54, s42, -v13
    v_mfma_f32_16x16x32_bf16 v[28:31], a[128:131], a[44:47], v[28:31]
    v_fma_f32 v55, v55, s42, -v13
    v_exp_f32 v52, v52
    v_exp_f32 v53, v53
    s_mov_b32 s41, 53248
    buffer_load_dwordx4 v5, s[20:23], s41 offen offset:2048 nt lds
    v_mfma_f32_16x16x32_bf16 v[32:35], a[128:131], a[48:51], v[32:35]
    v_exp_f32 v54, v54
    v_exp_f32 v55, v55
    v_cvt_pk_bf16_f32 v182, v52, v53
    v_mfma_f32_16x16x32_bf16 v[36:39], a[128:131], a[52:55], v[36:39]
    v_cvt_pk_bf16_f32 v183, v54, v55
    v_max3_f32 v67, v67, v56, v57
    v_max3_f32 v67, v67, v58, v59
    v_mfma_f32_16x16x32_bf16 v[40:43], a[128:131], a[56:59], v[40:43]
    v_fma_f32 v56, v56, s42, -v14
    v_fma_f32 v57, v57, s42, -v14
    v_fma_f32 v58, v58, s42, -v14
    s_waitcnt lgkmcnt(8)
    v_mfma_f32_16x16x32_bf16 v[24:27], a[132:135], a[60:63], v[24:27]
    v_fma_f32 v59, v59, s42, -v14
    v_exp_f32 v56, v56
    v_exp_f32 v57, v57
    v_exp_f32 v58, v58
    v_mfma_f32_16x16x32_bf16 v[28:31], a[132:135], a[64:67], v[28:31]
    v_exp_f32 v59, v59
    v_cvt_pk_bf16_f32 v186, v56, v57
    v_cvt_pk_bf16_f32 v187, v58, v59
    v_mfma_f32_16x16x32_bf16 v[32:35], a[132:135], a[68:71], v[32:35]
    v_max3_f32 v68, v68, v60, v61
    v_max3_f32 v68, v68, v62, v63
    v_fma_f32 v60, v60, s42, -v15
    v_mfma_f32_16x16x32_bf16 v[36:39], a[132:135], a[72:75], v[36:39]
    v_fma_f32 v61, v61, s42, -v15
    v_fma_f32 v62, v62, s42, -v15
    v_fma_f32 v63, v63, s42, -v15
    v_mfma_f32_16x16x32_bf16 v[40:43], a[132:135], a[76:79], v[40:43]
    v_exp_f32 v60, v60
    v_exp_f32 v61, v61
    v_exp_f32 v62, v62
    s_mov_b32 s41, 55296
    buffer_load_dwordx4 v5, s[20:23], s41 offen offset:3072 nt lds
    s_waitcnt lgkmcnt(7)
    v_mfma_f32_16x16x32_bf16 v[24:27], a[136:139], a[80:83], v[24:27]
    v_exp_f32 v63, v63
    v_cvt_pk_bf16_f32 v190, v60, v61
    v_cvt_pk_bf16_f32 v191, v62, v63
    v_mfma_f32_16x16x32_bf16 v[28:31], a[136:139], a[84:87], v[28:31]
    s_mul_i32 s79, s28, 20480
    v_mov_b32 v16, v0
    v_mul_u32_u24 v17, 3277, v16
    v_mfma_f32_16x16x32_bf16 v[32:35], a[136:139], a[88:91], v[32:35]
    v_lshrrev_b32 v17, 16, v17
    v_mul_u32_u24 v19, 20, v17
    v_sub_u32 v18, v16, v19
    v_lshrrev_b32 v19, 1, v17
    v_mfma_f32_16x16x32_bf16 v[36:39], a[136:139], a[92:95], v[36:39]
    v_and_b32 v19, 2, v19
    v_xor_b32 v18, v18, v19
    v_mul_u32_u24 v19, 1280, v17
    v_mfma_f32_16x16x32_bf16 v[40:43], a[136:139], a[96:99], v[40:43]
    v_lshl_add_u32 v19, v18, 4, v19
    v_add_u32 v19, s79, v19
    v_mov_b32 v1, v19
    s_waitcnt lgkmcnt(6)
    v_mfma_f32_16x16x32_bf16 v[24:27], a[140:143], a[100:103], v[24:27]
    v_add_u32 v16, 64, v0
    v_mul_u32_u24 v17, 3277, v16
    v_lshrrev_b32 v17, 16, v17
    v_mfma_f32_16x16x32_bf16 v[28:31], a[140:143], a[104:107], v[28:31]
    v_mul_u32_u24 v19, 20, v17
    v_sub_u32 v18, v16, v19
    v_lshrrev_b32 v19, 1, v17
    v_mfma_f32_16x16x32_bf16 v[32:35], a[140:143], a[108:111], v[32:35]
    v_and_b32 v19, 2, v19
    v_xor_b32 v18, v18, v19
    v_mul_u32_u24 v19, 1280, v17
    v_mfma_f32_16x16x32_bf16 v[36:39], a[140:143], a[112:115], v[36:39]
    v_lshl_add_u32 v19, v18, 4, v19
    v_add_u32 v19, s79, v19
    v_subrev_u32 v3, 1024, v19
    v_mfma_f32_16x16x32_bf16 v[40:43], a[140:143], a[116:119], v[40:43]
    s_waitcnt lgkmcnt(0)
    s_waitcnt vmcnt(8)
    s_barrier
    v_mfma_f32_16x16x32_bf16 v[44:47], a[144:147], a[0:3], 0
    v_mfma_f32_16x16x32_bf16 v[48:51], a[144:147], a[4:7], 0
    v_add_u32 v9, 0x3000, v9
    v_mfma_f32_16x16x32_bf16 v[52:55], a[144:147], a[8:11], 0
    v_add_u32 v10, 0x3000, v10
    v_max3_f32 v64, v64, v24, v25
    v_max3_f32 v64, v64, v26, v27
    v_fma_f32 v24, v24, s42, -v11
    v_fma_f32 v25, v25, s42, -v11
    v_mfma_f32_16x16x32_bf16 v[56:59], a[144:147], a[12:15], 0
    ds_read_b128 a[120:123], v9
    v_fma_f32 v26, v26, s42, -v11
    v_fma_f32 v27, v27, s42, -v11
    v_exp_f32 v24, v24
    s_mov_b32 s41, 98304
    s_add_u32 m0, s37, 45056
    s_nop 0
    buffer_load_dwordx4 v5, s[20:23], s41 offen nt lds
    v_mfma_f32_16x16x32_bf16 v[60:63], a[144:147], a[16:19], 0
    ds_read_b128 a[124:127], v10
    v_exp_f32 v25, v25
    v_exp_f32 v26, v26
    v_exp_f32 v27, v27
    v_mfma_f32_16x16x32_bf16 v[44:47], a[148:151], a[20:23], v[44:47]
    v_cvt_pk_bf16_f32 v192, v24, v25
    v_cvt_pk_bf16_f32 v193, v26, v27
    v_max3_f32 v65, v65, v28, v29
    v_mfma_f32_16x16x32_bf16 v[48:51], a[148:151], a[24:27], v[48:51]
    ds_read_b128 a[128:131], v9 offset:128
    v_max3_f32 v65, v65, v30, v31
    v_fma_f32 v28, v28, s42, -v12
    v_fma_f32 v29, v29, s42, -v12
    v_mfma_f32_16x16x32_bf16 v[52:55], a[148:151], a[28:31], v[52:55]
    ds_read_b128 a[132:135], v10 offset:128
    v_fma_f32 v30, v30, s42, -v12
    v_fma_f32 v31, v31, s42, -v12
    v_exp_f32 v28, v28
    v_mfma_f32_16x16x32_bf16 v[56:59], a[148:151], a[32:35], v[56:59]
    ds_read_b128 a[136:139], v9 offset:256
    v_exp_f32 v29, v29
    v_exp_f32 v30, v30
    v_exp_f32 v31, v31
    v_mfma_f32_16x16x32_bf16 v[60:63], a[148:151], a[36:39], v[60:63]
    ds_read_b128 a[140:143], v10 offset:256
    v_cvt_pk_bf16_f32 v196, v28, v29
    v_cvt_pk_bf16_f32 v197, v30, v31
    v_max3_f32 v66, v66, v32, v33
    v_mfma_f32_16x16x32_bf16 v[44:47], a[152:155], a[40:43], v[44:47]
    v_max3_f32 v66, v66, v34, v35
    v_fma_f32 v32, v32, s42, -v13
    v_fma_f32 v33, v33, s42, -v13
    v_mfma_f32_16x16x32_bf16 v[48:51], a[152:155], a[44:47], v[48:51]
    v_fma_f32 v34, v34, s42, -v13
    v_fma_f32 v35, v35, s42, -v13
    v_exp_f32 v32, v32
    v_exp_f32 v33, v33
    s_mov_b32 s41, 100352
    buffer_load_dwordx4 v5, s[20:23], s41 offen offset:1024 nt lds
    v_mfma_f32_16x16x32_bf16 v[52:55], a[152:155], a[48:51], v[52:55]
    v_exp_f32 v34, v34
    v_exp_f32 v35, v35
    v_cvt_pk_bf16_f32 v200, v32, v33
    v_mfma_f32_16x16x32_bf16 v[56:59], a[152:155], a[52:55], v[56:59]
    v_cvt_pk_bf16_f32 v201, v34, v35
    v_max3_f32 v67, v67, v36, v37
    v_max3_f32 v67, v67, v38, v39
    v_mfma_f32_16x16x32_bf16 v[60:63], a[152:155], a[56:59], v[60:63]
    v_fma_f32 v36, v36, s42, -v14
    v_fma_f32 v37, v37, s42, -v14
    v_fma_f32 v38, v38, s42, -v14
    v_mfma_f32_16x16x32_bf16 v[44:47], a[156:159], a[60:63], v[44:47]
    v_fma_f32 v39, v39, s42, -v14
    v_exp_f32 v36, v36
    v_exp_f32 v37, v37
    v_mfma_f32_16x16x32_bf16 v[48:51], a[156:159], a[64:67], v[48:51]
    v_exp_f32 v38, v38
    v_exp_f32 v39, v39
    v_cvt_pk_bf16_f32 v204, v36, v37
    v_mfma_f32_16x16x32_bf16 v[52:55], a[156:159], a[68:71], v[52:55]
    v_cvt_pk_bf16_f32 v205, v38, v39
    v_max3_f32 v68, v68, v40, v41
    v_max3_f32 v68, v68, v42, v43
    v_mfma_f32_16x16x32_bf16 v[56:59], a[156:159], a[72:75], v[56:59]
    v_fma_f32 v40, v40, s42, -v15
    v_fma_f32 v41, v41, s42, -v15
    v_fma_f32 v42, v42, s42, -v15
    v_mfma_f32_16x16x32_bf16 v[60:63], a[156:159], a[76:79], v[60:63]
    v_fma_f32 v43, v43, s42, -v15
    v_exp_f32 v40, v40
    v_exp_f32 v41, v41
    s_mov_b32 s41, 102400
    buffer_load_dwordx4 v5, s[20:23], s41 offen offset:2048 nt lds
    v_mfma_f32_16x16x32_bf16 v[44:47], a[160:163], a[80:83], v[44:47]
    v_exp_f32 v42, v42
    v_exp_f32 v43, v43
    v_cvt_pk_bf16_f32 v208, v40, v41
    v_cvt_pk_bf16_f32 v209, v42, v43
    v_mfma_f32_16x16x32_bf16 v[48:51], a[160:163], a[84:87], v[48:51]
    v_add_u32 v16, 128, v0
    v_mul_u32_u24 v17, 3277, v16
    v_lshrrev_b32 v17, 16, v17
    v_mfma_f32_16x16x32_bf16 v[52:55], a[160:163], a[88:91], v[52:55]
    v_mul_u32_u24 v19, 20, v17
    v_sub_u32 v18, v16, v19
    v_lshrrev_b32 v19, 1, v17
    v_mfma_f32_16x16x32_bf16 v[56:59], a[160:163], a[92:95], v[56:59]
    v_and_b32 v19, 2, v19
    v_xor_b32 v18, v18, v19
    v_mul_u32_u24 v19, 1280, v17
    v_mfma_f32_16x16x32_bf16 v[60:63], a[160:163], a[96:99], v[60:63]
    v_lshl_add_u32 v19, v18, 4, v19
    v_add_u32 v19, s79, v19
    v_subrev_u32 v4, 2048, v19
    v_mfma_f32_16x16x32_bf16 v[44:47], a[164:167], a[100:103], v[44:47]
    v_add_u32 v16, 192, v0
    v_mul_u32_u24 v17, 3277, v16
    v_lshrrev_b32 v17, 16, v17
    v_mfma_f32_16x16x32_bf16 v[48:51], a[164:167], a[104:107], v[48:51]
    v_mul_u32_u24 v19, 20, v17
    v_sub_u32 v18, v16, v19
    v_lshrrev_b32 v19, 1, v17
    v_mfma_f32_16x16x32_bf16 v[52:55], a[164:167], a[108:111], v[52:55]
    v_and_b32 v19, 2, v19
    v_xor_b32 v18, v18, v19
    v_mul_u32_u24 v19, 1280, v17
    v_mfma_f32_16x16x32_bf16 v[56:59], a[164:167], a[112:115], v[56:59]
    v_lshl_add_u32 v19, v18, 4, v19
    v_add_u32 v19, s79, v19
    v_subrev_u32 v6, 3072, v19
    v_mfma_f32_16x16x32_bf16 v[60:63], a[164:167], a[116:119], v[60:63]
    s_waitcnt lgkmcnt(5)
    v_mfma_f32_16x16x32_bf16 v[24:27], a[120:123], a[0:3], 0
    v_mfma_f32_16x16x32_bf16 v[28:31], a[120:123], a[4:7], 0
    v_add_u32 v9, 0xfffdc000, v9
    v_mfma_f32_16x16x32_bf16 v[32:35], a[120:123], a[8:11], 0
    v_add_u32 v10, 0xfffdc000, v10
    v_max3_f32 v64, v64, v44, v45
    v_max3_f32 v64, v64, v46, v47
    v_fma_f32 v44, v44, s42, -v11
    v_mfma_f32_16x16x32_bf16 v[36:39], a[120:123], a[12:15], 0
    ds_read_b128 a[144:147], v9
    v_fma_f32 v45, v45, s42, -v11
    v_fma_f32 v46, v46, s42, -v11
    v_fma_f32 v47, v47, s42, -v11
    s_mov_b32 s41, 104448
    buffer_load_dwordx4 v5, s[20:23], s41 offen offset:3072 nt lds
    v_mfma_f32_16x16x32_bf16 v[40:43], a[120:123], a[16:19], 0
    ds_read_b128 a[148:151], v10
    v_exp_f32 v44, v44
    v_exp_f32 v45, v45
    s_waitcnt lgkmcnt(6)
    v_mfma_f32_16x16x32_bf16 v[24:27], a[124:127], a[20:23], v[24:27]
    v_exp_f32 v46, v46
    v_exp_f32 v47, v47
    v_cvt_pk_bf16_f32 v194, v44, v45
    v_mfma_f32_16x16x32_bf16 v[28:31], a[124:127], a[24:27], v[28:31]
    ds_read_b128 a[152:155], v9 offset:128
    v_cvt_pk_bf16_f32 v195, v46, v47
    v_max3_f32 v65, v65, v48, v49
    v_max3_f32 v65, v65, v50, v51
    v_mfma_f32_16x16x32_bf16 v[32:35], a[124:127], a[28:31], v[32:35]
    ds_read_b128 a[156:159], v10 offset:128
    v_fma_f32 v48, v48, s42, -v12
    v_fma_f32 v49, v49, s42, -v12
    v_mfma_f32_16x16x32_bf16 v[36:39], a[124:127], a[32:35], v[36:39]
    ds_read_b128 a[160:163], v9 offset:256
    v_fma_f32 v50, v50, s42, -v12
    v_fma_f32 v51, v51, s42, -v12
    v_exp_f32 v48, v48
    v_mfma_f32_16x16x32_bf16 v[40:43], a[124:127], a[36:39], v[40:43]
    ds_read_b128 a[164:167], v10 offset:256
    v_exp_f32 v49, v49
    v_exp_f32 v50, v50
    v_exp_f32 v51, v51
    s_waitcnt lgkmcnt(9)
    v_mfma_f32_16x16x32_bf16 v[24:27], a[128:131], a[40:43], v[24:27]
    v_cvt_pk_bf16_f32 v198, v48, v49
    v_cvt_pk_bf16_f32 v199, v50, v51
    v_mfma_f32_16x16x32_bf16 v[28:31], a[128:131], a[44:47], v[28:31]
    v_max3_f32 v66, v66, v52, v53
    v_max3_f32 v66, v66, v54, v55
    v_fma_f32 v52, v52, s42, -v13
    s_mov_b32 s41, 147456
    s_add_u32 m0, s37, 61440
    s_nop 0
    buffer_load_dwordx4 v5, s[20:23], s41 offen nt lds
    v_mfma_f32_16x16x32_bf16 v[32:35], a[128:131], a[48:51], v[32:35]
    v_fma_f32 v53, v53, s42, -v13
    v_fma_f32 v54, v54, s42, -v13
    v_fma_f32 v55, v55, s42, -v13
    v_mfma_f32_16x16x32_bf16 v[36:39], a[128:131], a[52:55], v[36:39]
    v_exp_f32 v52, v52
    v_exp_f32 v53, v53
    v_mfma_f32_16x16x32_bf16 v[40:43], a[128:131], a[56:59], v[40:43]
    v_exp_f32 v54, v54
    v_exp_f32 v55, v55
    v_cvt_pk_bf16_f32 v202, v52, v53
    s_waitcnt lgkmcnt(8)
    v_mfma_f32_16x16x32_bf16 v[24:27], a[132:135], a[60:63], v[24:27]
    v_cvt_pk_bf16_f32 v203, v54, v55
    v_max3_f32 v67, v67, v56, v57
    v_max3_f32 v67, v67, v58, v59
    v_mfma_f32_16x16x32_bf16 v[28:31], a[132:135], a[64:67], v[28:31]
    v_fma_f32 v56, v56, s42, -v14
    v_fma_f32 v57, v57, s42, -v14
    v_mfma_f32_16x16x32_bf16 v[32:35], a[132:135], a[68:71], v[32:35]
    v_fma_f32 v58, v58, s42, -v14
    v_fma_f32 v59, v59, s42, -v14
    v_exp_f32 v56, v56
    v_mfma_f32_16x16x32_bf16 v[36:39], a[132:135], a[72:75], v[36:39]
    v_exp_f32 v57, v57
    v_exp_f32 v58, v58
    v_exp_f32 v59, v59
    v_mfma_f32_16x16x32_bf16 v[40:43], a[132:135], a[76:79], v[40:43]
    v_cvt_pk_bf16_f32 v206, v56, v57
    v_cvt_pk_bf16_f32 v207, v58, v59
    s_mov_b32 s41, 149504
    buffer_load_dwordx4 v5, s[20:23], s41 offen offset:1024 nt lds
    s_waitcnt lgkmcnt(7)
    v_mfma_f32_16x16x32_bf16 v[24:27], a[136:139], a[80:83], v[24:27]
    v_max3_f32 v68, v68, v60, v61
    v_max3_f32 v68, v68, v62, v63
    v_fma_f32 v60, v60, s42, -v15
    v_mfma_f32_16x16x32_bf16 v[28:31], a[136:139], a[84:87], v[28:31]
    v_fma_f32 v61, v61, s42, -v15
    v_fma_f32 v62, v62, s42, -v15
    v_fma_f32 v63, v63, s42, -v15
    v_mfma_f32_16x16x32_bf16 v[32:35], a[136:139], a[88:91], v[32:35]
    v_exp_f32 v60, v60
    v_exp_f32 v61, v61
    v_mfma_f32_16x16x32_bf16 v[36:39], a[136:139], a[92:95], v[36:39]
    v_exp_f32 v62, v62
    v_exp_f32 v63, v63
    v_cvt_pk_bf16_f32 v210, v60, v61
    v_mfma_f32_16x16x32_bf16 v[40:43], a[136:139], a[96:99], v[40:43]
    v_cvt_pk_bf16_f32 v211, v62, v63
    v_add_u32 v16, 256, v0
    v_mul_u32_u24 v17, 3277, v16
    s_waitcnt lgkmcnt(6)
    v_mfma_f32_16x16x32_bf16 v[24:27], a[140:143], a[100:103], v[24:27]
    v_lshrrev_b32 v17, 16, v17
    v_mul_u32_u24 v19, 20, v17
    v_mfma_f32_16x16x32_bf16 v[28:31], a[140:143], a[104:107], v[28:31]
    v_sub_u32 v18, v16, v19
    v_lshrrev_b32 v19, 1, v17
    v_and_b32 v19, 2, v19
    v_mfma_f32_16x16x32_bf16 v[32:35], a[140:143], a[108:111], v[32:35]
    v_xor_b32 v18, v18, v19
    v_mul_u32_u24 v19, 1280, v17
    v_lshl_add_u32 v19, v18, 4, v19
    v_mfma_f32_16x16x32_bf16 v[36:39], a[140:143], a[112:115], v[36:39]
    v_add_u32 v19, s79, v19
    v_mov_b32 v7, v19
    v_mfma_f32_16x16x32_bf16 v[40:43], a[140:143], a[116:119], v[40:43]
    s_waitcnt lgkmcnt(5)
    v_mfma_f32_16x16x32_bf16 v[44:47], a[144:147], a[0:3], 0
    v_mfma_f32_16x16x32_bf16 v[48:51], a[144:147], a[4:7], 0
    v_mfma_f32_16x16x32_bf16 v[52:55], a[144:147], a[8:11], 0
    v_max3_f32 v64, v64, v24, v25
    v_max3_f32 v64, v64, v26, v27
    v_fma_f32 v24, v24, s42, -v11
    v_fma_f32 v25, v25, s42, -v11
    v_mfma_f32_16x16x32_bf16 v[56:59], a[144:147], a[12:15], 0
    v_fma_f32 v26, v26, s42, -v11
    v_fma_f32 v27, v27, s42, -v11
    v_exp_f32 v24, v24
    s_mov_b32 s41, 151552
    buffer_load_dwordx4 v5, s[20:23], s41 offen offset:2048 nt lds
    v_mfma_f32_16x16x32_bf16 v[60:63], a[144:147], a[16:19], 0
    v_exp_f32 v25, v25
    v_exp_f32 v26, v26
    v_exp_f32 v27, v27
    s_waitcnt lgkmcnt(4)
    v_mfma_f32_16x16x32_bf16 v[44:47], a[148:151], a[20:23], v[44:47]
    v_cvt_pk_bf16_f32 v212, v24, v25
    v_cvt_pk_bf16_f32 v213, v26, v27
    v_max3_f32 v65, v65, v28, v29
    v_mfma_f32_16x16x32_bf16 v[48:51], a[148:151], a[24:27], v[48:51]
    v_max3_f32 v65, v65, v30, v31
    v_fma_f32 v28, v28, s42, -v12
    v_fma_f32 v29, v29, s42, -v12
    v_mfma_f32_16x16x32_bf16 v[52:55], a[148:151], a[28:31], v[52:55]
    v_fma_f32 v30, v30, s42, -v12
    v_fma_f32 v31, v31, s42, -v12
    v_exp_f32 v28, v28
    v_mfma_f32_16x16x32_bf16 v[56:59], a[148:151], a[32:35], v[56:59]
    v_exp_f32 v29, v29
    v_exp_f32 v30, v30
    v_exp_f32 v31, v31
    v_cvt_pk_bf16_f32 v216, v28, v29
    v_mfma_f32_16x16x32_bf16 v[60:63], a[148:151], a[36:39], v[60:63]
    v_cvt_pk_bf16_f32 v217, v30, v31
    v_max3_f32 v66, v66, v32, v33
    v_max3_f32 v66, v66, v34, v35
    s_waitcnt lgkmcnt(3)
    v_mfma_f32_16x16x32_bf16 v[44:47], a[152:155], a[40:43], v[44:47]
    v_fma_f32 v32, v32, s42, -v13
    v_fma_f32 v33, v33, s42, -v13
    v_fma_f32 v34, v34, s42, -v13
    v_mfma_f32_16x16x32_bf16 v[48:51], a[152:155], a[44:47], v[48:51]
    v_fma_f32 v35, v35, s42, -v13
    v_exp_f32 v32, v32
    v_exp_f32 v33, v33
    s_mov_b32 s41, 153600
    buffer_load_dwordx4 v5, s[20:23], s41 offen offset:3072 nt lds
    v_mfma_f32_16x16x32_bf16 v[52:55], a[152:155], a[48:51], v[52:55]
    v_exp_f32 v34, v34
    v_exp_f32 v35, v35
    v_cvt_pk_bf16_f32 v220, v32, v33
    v_mfma_f32_16x16x32_bf16 v[56:59], a[152:155], a[52:55], v[56:59]
    v_cvt_pk_bf16_f32 v221, v34, v35
    v_max3_f32 v67, v67, v36, v37
    v_max3_f32 v67, v67, v38, v39
    v_mfma_f32_16x16x32_bf16 v[60:63], a[152:155], a[56:59], v[60:63]
    v_fma_f32 v36, v36, s42, -v14
    v_fma_f32 v37, v37, s42, -v14
    v_fma_f32 v38, v38, s42, -v14
    s_waitcnt lgkmcnt(2)
    v_mfma_f32_16x16x32_bf16 v[44:47], a[156:159], a[60:63], v[44:47]
    v_fma_f32 v39, v39, s42, -v14
    v_exp_f32 v36, v36
    v_exp_f32 v37, v37
    v_exp_f32 v38, v38
    v_mfma_f32_16x16x32_bf16 v[48:51], a[156:159], a[64:67], v[48:51]
    v_exp_f32 v39, v39
    v_cvt_pk_bf16_f32 v224, v36, v37
    v_cvt_pk_bf16_f32 v225, v38, v39
    v_mfma_f32_16x16x32_bf16 v[52:55], a[156:159], a[68:71], v[52:55]
    v_max3_f32 v68, v68, v40, v41
    v_max3_f32 v68, v68, v42, v43
    v_fma_f32 v40, v40, s42, -v15
    v_mfma_f32_16x16x32_bf16 v[56:59], a[156:159], a[72:75], v[56:59]
    v_fma_f32 v41, v41, s42, -v15
    v_fma_f32 v42, v42, s42, -v15
    v_fma_f32 v43, v43, s42, -v15
    v_mfma_f32_16x16x32_bf16 v[60:63], a[156:159], a[76:79], v[60:63]
    v_exp_f32 v40, v40
    v_exp_f32 v41, v41
    v_exp_f32 v42, v42
    s_mov_b32 s41, 128
    s_add_u32 m0, s37, 77824
    s_nop 0
    buffer_load_dwordx4 v5, s[20:23], s41 offen nt lds
    s_waitcnt lgkmcnt(1)
    v_mfma_f32_16x16x32_bf16 v[44:47], a[160:163], a[80:83], v[44:47]
    v_exp_f32 v43, v43
    v_cvt_pk_bf16_f32 v228, v40, v41
    v_cvt_pk_bf16_f32 v229, v42, v43
    v_mfma_f32_16x16x32_bf16 v[48:51], a[160:163], a[84:87], v[48:51]
    v_lshlrev_b32 v19, 4, v0
    v_add_u32 v8, s75, v19
    v_add_u32 v9, 4096, v8
    v_mfma_f32_16x16x32_bf16 v[52:55], a[160:163], a[88:91], v[52:55]
    v_mov_b32 v2, 0x40000000
    s_lshl_b32 s33, s2, 7
    v_mov_b32 v16, s33
    v_cmp_eq_u32 vcc, 0, v0
    v_mfma_f32_16x16x32_bf16 v[56:59], a[160:163], a[92:95], v[56:59]
    s_nop 0
    v_cndmask_b32 v16, v2, v16, vcc
    s_cmp_eq_u32 s28, 0
    s_cselect_b64 vcc, -1, 0
    v_cndmask_b32 v2, v2, v16, vcc
    v_mfma_f32_16x16x32_bf16 v[60:63], a[160:163], a[96:99], v[60:63]
    s_mul_i32 s33, s28, 15
    v_add_u32 v17, s33, v0
    v_mul_u32_u24 v10, 205, v17
    s_waitcnt lgkmcnt(0)
    v_mfma_f32_16x16x32_bf16 v[44:47], a[164:167], a[100:103], v[44:47]
    v_lshrrev_b32 v10, 11, v10
    v_mul_u32_u24 v16, 10, v10
    v_sub_u32 v16, v17, v16
    v_mfma_f32_16x16x32_bf16 v[48:51], a[164:167], a[104:107], v[48:51]
    s_lshl_b32 s33, s31, 2
    s_add_u32 s33, s33, s73
    s_mul_i32 s33, s33, 24
    v_mfma_f32_16x16x32_bf16 v[52:55], a[164:167], a[108:111], v[52:55]
    v_add_u32 v10, s33, v10
    v_mul_u32_u24 v10, 1280, v10
    v_lshl_add_u32 v10, v16, 7, v10
    v_mfma_f32_16x16x32_bf16 v[56:59], a[164:167], a[112:115], v[56:59]
    v_mov_b32 v17, 0x40000000
    v_cmp_gt_u32 vcc, 15, v0
    s_nop 1
    v_cndmask_b32 v10, v17, v10, vcc
    v_mfma_f32_16x16x32_bf16 v[60:63], a[164:167], a[116:119], v[60:63]
    v_max3_f32 v64, v64, v44, v45
    v_max3_f32 v64, v64, v46, v47
    v_fma_f32 v44, v44, s42, -v11
    v_fma_f32 v45, v45, s42, -v11
    v_fma_f32 v46, v46, s42, -v11
    v_fma_f32 v47, v47, s42, -v11
    v_exp_f32 v44, v44
    v_exp_f32 v45, v45
    v_exp_f32 v46, v46
    v_exp_f32 v47, v47
    v_cvt_pk_bf16_f32 v214, v44, v45
    v_cvt_pk_bf16_f32 v215, v46, v47
    v_max3_f32 v65, v65, v48, v49
    v_max3_f32 v65, v65, v50, v51
    v_fma_f32 v48, v48, s42, -v12
    v_fma_f32 v49, v49, s42, -v12
    v_fma_f32 v50, v50, s42, -v12
    v_fma_f32 v51, v51, s42, -v12
    v_exp_f32 v48, v48
    v_exp_f32 v49, v49
    v_exp_f32 v50, v50
    v_exp_f32 v51, v51
    v_cvt_pk_bf16_f32 v218, v48, v49
    v_cvt_pk_bf16_f32 v219, v50, v51
    v_max3_f32 v66, v66, v52, v53
    v_max3_f32 v66, v66, v54, v55
    v_fma_f32 v52, v52, s42, -v13
    v_fma_f32 v53, v53, s42, -v13
    v_fma_f32 v54, v54, s42, -v13
    v_fma_f32 v55, v55, s42, -v13
    v_exp_f32 v52, v52
    v_exp_f32 v53, v53
    v_exp_f32 v54, v54
    v_exp_f32 v55, v55
    v_cvt_pk_bf16_f32 v222, v52, v53
    v_cvt_pk_bf16_f32 v223, v54, v55
    v_max3_f32 v67, v67, v56, v57
    v_max3_f32 v67, v67, v58, v59
    v_fma_f32 v56, v56, s42, -v14
    v_fma_f32 v57, v57, s42, -v14
    v_fma_f32 v58, v58, s42, -v14
    v_fma_f32 v59, v59, s42, -v14
    v_exp_f32 v56, v56
    v_exp_f32 v57, v57
    v_exp_f32 v58, v58
    v_exp_f32 v59, v59
    v_cvt_pk_bf16_f32 v226, v56, v57
    v_cvt_pk_bf16_f32 v227, v58, v59
    v_max3_f32 v68, v68, v60, v61
    v_max3_f32 v68, v68, v62, v63
    v_fma_f32 v60, v60, s42, -v15
    v_fma_f32 v61, v61, s42, -v15
    v_fma_f32 v62, v62, s42, -v15
    v_fma_f32 v63, v63, s42, -v15
    v_exp_f32 v60, v60
    v_exp_f32 v61, v61
    v_exp_f32 v62, v62
    v_exp_f32 v63, v63
    v_cvt_pk_bf16_f32 v230, v60, v61
    v_cvt_pk_bf16_f32 v231, v62, v63
    v_mov_b32 v16, v64
    s_nop 1
    v_permlane16_swap_b32 v64, v16
    v_max_f32 v64, v64, v16
    v_mov_b32 v17, v65
    s_nop 1
    v_permlane16_swap_b32 v65, v17
    v_max_f32 v65, v65, v17
    v_mov_b32 v16, v66
    s_nop 1
    v_permlane16_swap_b32 v66, v16
    v_max_f32 v66, v66, v16
    v_mov_b32 v17, v67
    s_nop 1
    v_permlane16_swap_b32 v67, v17
    v_max_f32 v67, v67, v17
    v_mov_b32 v16, v68
    s_nop 1
    v_permlane16_swap_b32 v68, v16
    v_max_f32 v68, v68, v16
    v_mov_b32 v16, v64
    s_nop 1
    v_permlane32_swap_b32 v64, v16
    v_max_f32 v64, v64, v16
    v_mov_b32 v17, v65
    s_nop 1
    v_permlane32_swap_b32 v65, v17
    v_max_f32 v65, v65, v17
    v_mov_b32 v16, v66
    s_nop 1
    v_permlane32_swap_b32 v66, v16
    v_max_f32 v66, v66, v16
    v_mov_b32 v17, v67
    s_nop 1
    v_permlane32_swap_b32 v67, v17
    v_max_f32 v67, v67, v17
    v_mov_b32 v16, v68
    s_nop 1
    v_permlane32_swap_b32 v68, v16
    v_max_f32 v68, v68, v16
    v_mul_f32 v64, s42, v64
    v_mul_f32 v65, s42, v65
    v_mul_f32 v66, s42, v66
    v_mul_f32 v67, s42, v67
    v_mul_f32 v68, s42, v68
    v_sub_f32 v16, v64, v11
    v_sub_f32 v17, v65, v12
    v_max_f32 v16, v16, v17
    v_sub_f32 v17, v66, v13
    v_max_f32 v16, v16, v17
    v_sub_f32 v17, v67, v14
    v_max_f32 v16, v16, v17
    v_sub_f32 v17, v68, v15
    v_max_f32 v16, v16, v17
    s_mov_b32 s33, 0x41200000
    v_cmp_lt_f32 vcc, s33, v16
    s_nop 3
    s_cmp_lg_u64 vcc, 0
    s_cselect_b32 s3, 1, 0
    v_mov_b32 v18, s3
    v_and_b32 v24, 15, v0
    v_lshlrev_b32 v24, 2, v24
    s_mul_i32 s33, s28, 320
    s_add_u32 s33, s33, 159744
    v_add_u32 v25, s33, v24
    s_xor_b32 s33, s28, 2
    s_mul_i32 s33, s33, 320
    s_add_u32 s33, s33, 159744
    v_add_u32 v24, s33, v24
    ds_write_b32 v25, v11
    ds_write_b32 v25, v12 offset:64
    ds_write_b32 v25, v13 offset:128
    ds_write_b32 v25, v14 offset:192
    ds_write_b32 v25, v15 offset:256
    s_lshl_b32 s33, s28, 2
    s_add_u32 s33, s33, 161280
    v_mov_b32 v19, s33
    ds_write_b32 v19, v18
    s_waitcnt lgkmcnt(0)
    s_waitcnt vmcnt(13)
    s_barrier
    v_mov_b32 v19, 161280
    ds_read_b128 v[32:35], v19
    ds_read_b32 v26, v24
    ds_read_b32 v27, v24 offset:64
    ds_read_b32 v28, v24 offset:128
    ds_read_b32 v29, v24 offset:192
    ds_read_b32 v30, v24 offset:256
    s_waitcnt lgkmcnt(5)
    v_or3_b32 v18, v32, v33, v34
    v_or_b32 v18, v18, v35
    s_nop 0
    v_readfirstlane_b32 s33, v18
    s_nop 3
    s_andn2_b32 s33, s33, s0
    s_cmp_lg_u32 s33, 0
    s_cbranch_scc1 FALLBACK
    s_waitcnt lgkmcnt(4)
    v_max_f32 v16, v11, v26
    v_sub_f32 v11, v11, v16
    v_sub_f32 v26, v26, v16
    s_waitcnt lgkmcnt(3)
    v_max_f32 v16, v12, v27
    v_sub_f32 v12, v12, v16
    v_sub_f32 v27, v27, v16
    s_waitcnt lgkmcnt(2)
    v_max_f32 v16, v13, v28
    v_sub_f32 v13, v13, v16
    v_sub_f32 v28, v28, v16
    s_waitcnt lgkmcnt(1)
    v_max_f32 v16, v14, v29
    v_sub_f32 v14, v14, v16
    v_sub_f32 v29, v29, v16
    s_waitcnt lgkmcnt(0)
    v_max_f32 v16, v15, v30
    v_sub_f32 v15, v15, v16
    v_sub_f32 v30, v30, v16
    v_exp_f32 v11, v11
    v_exp_f32 v12, v12
    v_exp_f32 v13, v13
    v_exp_f32 v14, v14
    v_exp_f32 v15, v15
    v_exp_f32 v26, v26
    v_exp_f32 v27, v27
    v_exp_f32 v28, v28
    v_exp_f32 v29, v29
    v_exp_f32 v30, v30
    v_accvgpr_write_b32 a108, v26
    v_accvgpr_write_b32 a109, v27
    v_accvgpr_write_b32 a110, v28
    v_accvgpr_write_b32 a111, v29
    v_accvgpr_write_b32 a112, v30
    v_mov_b32 v16, 0x3f803f80
    v_accvgpr_write_b32 a100, v16
    v_accvgpr_write_b32 a101, v16
    v_accvgpr_write_b32 a102, v16
    v_accvgpr_write_b32 a103, v16
    v_lshlrev_b32 v16, 6, v0
    buffer_load_dword v16, v16, s[60:63], 0 offen sc1
    ds_read_b64_tr_b16 v[24:25], v20
    ds_read_b64_tr_b16 v[26:27], v20 offset:4096
    ds_read_b64_tr_b16 v[28:29], v21
    ds_read_b64_tr_b16 v[30:31], v21 offset:4096
    ds_read_b64_tr_b16 v[32:33], v22
    ds_read_b64_tr_b16 v[34:35], v22 offset:4096
    ds_read_b64_tr_b16 v[36:37], v23
    ds_read_b64_tr_b16 v[38:39], v23 offset:4096
    s_waitcnt lgkmcnt(6)
    v_mfma_f32_16x16x32_bf16 a[0:3], v[24:27], v[72:75], 0
    ds_read_b64_tr_b16 v[40:41], v20 offset:8192
    v_mfma_f32_16x16x32_bf16 a[4:7], v[24:27], v[76:79], 0
    ds_read_b64_tr_b16 v[42:43], v20 offset:12288
    v_mfma_f32_16x16x32_bf16 a[8:11], v[24:27], v[80:83], 0
    ds_read_b64_tr_b16 v[44:45], v21 offset:8192
    s_mov_b32 s41, 2176
    buffer_load_dwordx4 v5, s[20:23], s41 offen offset:1024 nt lds
    v_mfma_f32_16x16x32_bf16 a[12:15], v[24:27], v[84:87], 0
    v_mfma_f32_16x16x32_bf16 a[16:19], v[24:27], v[88:91], 0
    ds_read_b64_tr_b16 v[46:47], v21 offset:12288
    s_waitcnt lgkmcnt(8)
    v_mfma_f32_16x16x32_bf16 a[20:23], v[28:31], v[72:75], 0
    ds_read_b64_tr_b16 v[48:49], v22 offset:8192
    v_mfma_f32_16x16x32_bf16 a[24:27], v[28:31], v[76:79], 0
    ds_read_b64_tr_b16 v[50:51], v22 offset:12288
    v_mfma_f32_16x16x32_bf16 a[28:31], v[28:31], v[80:83], 0
    v_mfma_f32_16x16x32_bf16 a[32:35], v[28:31], v[84:87], 0
    ds_read_b64_tr_b16 v[52:53], v23 offset:8192
    v_mfma_f32_16x16x32_bf16 a[36:39], v[28:31], v[88:91], 0
    ds_read_b64_tr_b16 v[54:55], v23 offset:12288
    s_mov_b32 s41, 4224
    buffer_load_dwordx4 v5, s[20:23], s41 offen offset:2048 nt lds
    s_waitcnt lgkmcnt(10)
    v_mfma_f32_16x16x32_bf16 a[40:43], v[32:35], v[72:75], 0
    v_mfma_f32_16x16x32_bf16 a[44:47], v[32:35], v[76:79], 0
    v_mfma_f32_16x16x32_bf16 a[48:51], v[32:35], v[80:83], 0
    v_mfma_f32_16x16x32_bf16 a[52:55], v[32:35], v[84:87], 0
    v_mfma_f32_16x16x32_bf16 a[56:59], v[32:35], v[88:91], 0
    s_waitcnt lgkmcnt(8)
    v_mfma_f32_16x16x32_bf16 a[60:63], v[36:39], v[72:75], 0
    v_mfma_f32_16x16x32_bf16 a[64:67], v[36:39], v[76:79], 0
    s_mov_b32 s41, 6272
    buffer_load_dwordx4 v5, s[20:23], s41 offen offset:3072 nt lds
    v_mfma_f32_16x16x32_bf16 a[68:71], v[36:39], v[80:83], 0
    v_mfma_f32_16x16x32_bf16 a[72:75], v[36:39], v[84:87], 0
    v_mfma_f32_16x16x32_bf16 a[76:79], v[36:39], v[88:91], 0
    v_mfma_f32_16x16x32_bf16 a[80:83], a[100:103], v[72:75], 0
    v_mfma_f32_16x16x32_bf16 a[84:87], a[100:103], v[76:79], 0
    v_mfma_f32_16x16x32_bf16 a[88:91], a[100:103], v[80:83], 0
    v_mfma_f32_16x16x32_bf16 a[92:95], a[100:103], v[84:87], 0
    v_mfma_f32_16x16x32_bf16 a[96:99], a[100:103], v[88:91], 0
    s_waitcnt lgkmcnt(0)
    s_waitcnt vmcnt(13)
    s_barrier
    v_mfma_f32_16x16x32_bf16 a[0:3], v[40:43], v[92:95], a[0:3]
    v_add_u32 v20, 0x4000, v20
    v_add_u32 v21, 0x4000, v21
    v_mfma_f32_16x16x32_bf16 a[4:7], v[40:43], v[96:99], a[4:7]
    v_add_u32 v22, 0x4000, v22
    v_mfma_f32_16x16x32_bf16 a[8:11], v[40:43], v[100:103], a[8:11]
    v_add_u32 v23, 0x4000, v23
    s_mov_b32 s41, 49280
    s_add_u32 m0, s37, 94208
    s_nop 0
    buffer_load_dwordx4 v5, s[20:23], s41 offen nt lds
    v_mfma_f32_16x16x32_bf16 a[12:15], v[40:43], v[104:107], a[12:15]
    ds_read_b64_tr_b16 v[24:25], v20
    v_mfma_f32_16x16x32_bf16 a[16:19], v[40:43], v[108:111], a[16:19]
    ds_read_b64_tr_b16 v[26:27], v20 offset:4096
    v_mfma_f32_16x16x32_bf16 a[20:23], v[44:47], v[92:95], a[20:23]
    ds_read_b64_tr_b16 v[28:29], v21
    v_mfma_f32_16x16x32_bf16 a[24:27], v[44:47], v[96:99], a[24:27]
    ds_read_b64_tr_b16 v[30:31], v21 offset:4096
    v_mfma_f32_16x16x32_bf16 a[28:31], v[44:47], v[100:103], a[28:31]
    ds_read_b64_tr_b16 v[32:33], v22
    v_mfma_f32_16x16x32_bf16 a[32:35], v[44:47], v[104:107], a[32:35]
    ds_read_b64_tr_b16 v[34:35], v22 offset:4096
    v_mfma_f32_16x16x32_bf16 a[36:39], v[44:47], v[108:111], a[36:39]
    ds_read_b64_tr_b16 v[36:37], v23
    s_mov_b32 s41, 51328
    buffer_load_dwordx4 v5, s[20:23], s41 offen offset:1024 nt lds
    v_mfma_f32_16x16x32_bf16 a[40:43], v[48:51], v[92:95], a[40:43]
    ds_read_b64_tr_b16 v[38:39], v23 offset:4096
    v_mfma_f32_16x16x32_bf16 a[44:47], v[48:51], v[96:99], a[44:47]
    v_mfma_f32_16x16x32_bf16 a[48:51], v[48:51], v[100:103], a[48:51]
    v_mfma_f32_16x16x32_bf16 a[52:55], v[48:51], v[104:107], a[52:55]
    v_mfma_f32_16x16x32_bf16 a[56:59], v[48:51], v[108:111], a[56:59]
    v_mfma_f32_16x16x32_bf16 a[60:63], v[52:55], v[92:95], a[60:63]
    v_mfma_f32_16x16x32_bf16 a[64:67], v[52:55], v[96:99], a[64:67]
    s_mov_b32 s41, 53376
    buffer_load_dwordx4 v5, s[20:23], s41 offen offset:2048 nt lds
    v_mfma_f32_16x16x32_bf16 a[68:71], v[52:55], v[100:103], a[68:71]
    v_mfma_f32_16x16x32_bf16 a[72:75], v[52:55], v[104:107], a[72:75]
    v_mfma_f32_16x16x32_bf16 a[76:79], v[52:55], v[108:111], a[76:79]
    v_mfma_f32_16x16x32_bf16 a[80:83], a[100:103], v[92:95], a[80:83]
    v_mfma_f32_16x16x32_bf16 a[84:87], a[100:103], v[96:99], a[84:87]
    v_mfma_f32_16x16x32_bf16 a[88:91], a[100:103], v[100:103], a[88:91]
    v_mfma_f32_16x16x32_bf16 a[92:95], a[100:103], v[104:107], a[92:95]
    v_mfma_f32_16x16x32_bf16 a[96:99], a[100:103], v[108:111], a[96:99]
    s_waitcnt lgkmcnt(6)
    v_mfma_f32_16x16x32_bf16 a[0:3], v[24:27], v[112:115], a[0:3]
    ds_read_b64_tr_b16 v[40:41], v20 offset:8192
    v_mfma_f32_16x16x32_bf16 a[4:7], v[24:27], v[116:119], a[4:7]
    ds_read_b64_tr_b16 v[42:43], v20 offset:12288
    v_mfma_f32_16x16x32_bf16 a[8:11], v[24:27], v[120:123], a[8:11]
    ds_read_b64_tr_b16 v[44:45], v21 offset:8192
    s_mov_b32 s41, 55424
    buffer_load_dwordx4 v5, s[20:23], s41 offen offset:3072 nt lds
    v_mfma_f32_16x16x32_bf16 a[12:15], v[24:27], v[124:127], a[12:15]
    v_mfma_f32_16x16x32_bf16 a[16:19], v[24:27], v[128:131], a[16:19]
    ds_read_b64_tr_b16 v[46:47], v21 offset:12288
    s_waitcnt lgkmcnt(8)
    v_mfma_f32_16x16x32_bf16 a[20:23], v[28:31], v[112:115], a[20:23]
    ds_read_b64_tr_b16 v[48:49], v22 offset:8192
    v_mfma_f32_16x16x32_bf16 a[24:27], v[28:31], v[116:119], a[24:27]
    ds_read_b64_tr_b16 v[50:51], v22 offset:12288
    v_mfma_f32_16x16x32_bf16 a[28:31], v[28:31], v[120:123], a[28:31]
    v_mfma_f32_16x16x32_bf16 a[32:35], v[28:31], v[124:127], a[32:35]
    ds_read_b64_tr_b16 v[52:53], v23 offset:8192
    v_mfma_f32_16x16x32_bf16 a[36:39], v[28:31], v[128:131], a[36:39]
    ds_read_b64_tr_b16 v[54:55], v23 offset:12288
    s_mov_b32 s41, 98432
    s_add_u32 m0, s37, 110592
    s_nop 0
    buffer_load_dwordx4 v5, s[20:23], s41 offen nt lds
    s_waitcnt lgkmcnt(10)
    v_mfma_f32_16x16x32_bf16 a[40:43], v[32:35], v[112:115], a[40:43]
    v_mfma_f32_16x16x32_bf16 a[44:47], v[32:35], v[116:119], a[44:47]
    v_mfma_f32_16x16x32_bf16 a[48:51], v[32:35], v[120:123], a[48:51]
    v_mfma_f32_16x16x32_bf16 a[52:55], v[32:35], v[124:127], a[52:55]
    v_mfma_f32_16x16x32_bf16 a[56:59], v[32:35], v[128:131], a[56:59]
    s_waitcnt lgkmcnt(8)
    v_mfma_f32_16x16x32_bf16 a[60:63], v[36:39], v[112:115], a[60:63]
    v_mfma_f32_16x16x32_bf16 a[64:67], v[36:39], v[116:119], a[64:67]
    s_mov_b32 s41, 100480
    buffer_load_dwordx4 v5, s[20:23], s41 offen offset:1024 nt lds
    v_mfma_f32_16x16x32_bf16 a[68:71], v[36:39], v[120:123], a[68:71]
    v_mfma_f32_16x16x32_bf16 a[72:75], v[36:39], v[124:127], a[72:75]
    v_mfma_f32_16x16x32_bf16 a[76:79], v[36:39], v[128:131], a[76:79]
    v_mfma_f32_16x16x32_bf16 a[80:83], a[100:103], v[112:115], a[80:83]
    v_mfma_f32_16x16x32_bf16 a[84:87], a[100:103], v[116:119], a[84:87]
    v_mfma_f32_16x16x32_bf16 a[88:91], a[100:103], v[120:123], a[88:91]
    v_mfma_f32_16x16x32_bf16 a[92:95], a[100:103], v[124:127], a[92:95]
    v_mfma_f32_16x16x32_bf16 a[96:99], a[100:103], v[128:131], a[96:99]
    s_waitcnt lgkmcnt(0)
    s_waitcnt vmcnt(15)
    s_barrier
    v_mfma_f32_16x16x32_bf16 a[0:3], v[40:43], v[132:135], a[0:3]
    v_add_u32 v20, 0x4000, v20
    v_add_u32 v21, 0x4000, v21
    v_mfma_f32_16x16x32_bf16 a[4:7], v[40:43], v[136:139], a[4:7]
    v_add_u32 v22, 0x4000, v22
    v_mfma_f32_16x16x32_bf16 a[8:11], v[40:43], v[140:143], a[8:11]
    v_add_u32 v23, 0x4000, v23
    s_mov_b32 s41, 102528
    buffer_load_dwordx4 v5, s[20:23], s41 offen offset:2048 nt lds
    v_mfma_f32_16x16x32_bf16 a[12:15], v[40:43], v[144:147], a[12:15]
    ds_read_b64_tr_b16 v[24:25], v20
    v_mfma_f32_16x16x32_bf16 a[16:19], v[40:43], v[148:151], a[16:19]
    ds_read_b64_tr_b16 v[26:27], v20 offset:4096
    v_mfma_f32_16x16x32_bf16 a[20:23], v[44:47], v[132:135], a[20:23]
    ds_read_b64_tr_b16 v[28:29], v21
    v_mfma_f32_16x16x32_bf16 a[24:27], v[44:47], v[136:139], a[24:27]
    ds_read_b64_tr_b16 v[30:31], v21 offset:4096
    v_mfma_f32_16x16x32_bf16 a[28:31], v[44:47], v[140:143], a[28:31]
    ds_read_b64_tr_b16 v[32:33], v22
    v_mfma_f32_16x16x32_bf16 a[32:35], v[44:47], v[144:147], a[32:35]
    ds_read_b64_tr_b16 v[34:35], v22 offset:4096
    v_mfma_f32_16x16x32_bf16 a[36:39], v[44:47], v[148:151], a[36:39]
    ds_read_b64_tr_b16 v[36:37], v23
    s_mov_b32 s41, 104576
    buffer_load_dwordx4 v5, s[20:23], s41 offen offset:3072 nt lds
    v_mfma_f32_16x16x32_bf16 a[40:43], v[48:51], v[132:135], a[40:43]
    ds_read_b64_tr_b16 v[38:39], v23 offset:4096
    v_mfma_f32_16x16x32_bf16 a[44:47], v[48:51], v[136:139], a[44:47]
    v_mfma_f32_16x16x32_bf16 a[48:51], v[48:51], v[140:143], a[48:51]
    v_mfma_f32_16x16x32_bf16 a[52:55], v[48:51], v[144:147], a[52:55]
    v_mfma_f32_16x16x32_bf16 a[56:59], v[48:51], v[148:151], a[56:59]
    v_mfma_f32_16x16x32_bf16 a[60:63], v[52:55], v[132:135], a[60:63]
    v_mfma_f32_16x16x32_bf16 a[64:67], v[52:55], v[136:139], a[64:67]
    s_mov_b32 s41, 147584
    s_add_u32 m0, s37, 126976
    s_nop 0
    buffer_load_dwordx4 v5, s[20:23], s41 offen nt lds
    v_mfma_f32_16x16x32_bf16 a[68:71], v[52:55], v[140:143], a[68:71]
    v_mfma_f32_16x16x32_bf16 a[72:75], v[52:55], v[144:147], a[72:75]
    v_mfma_f32_16x16x32_bf16 a[76:79], v[52:55], v[148:151], a[76:79]
    v_mfma_f32_16x16x32_bf16 a[80:83], a[100:103], v[132:135], a[80:83]
    v_mfma_f32_16x16x32_bf16 a[84:87], a[100:103], v[136:139], a[84:87]
    v_mfma_f32_16x16x32_bf16 a[88:91], a[100:103], v[140:143], a[88:91]
    v_mfma_f32_16x16x32_bf16 a[92:95], a[100:103], v[144:147], a[92:95]
    v_mfma_f32_16x16x32_bf16 a[96:99], a[100:103], v[148:151], a[96:99]
    s_waitcnt lgkmcnt(6)
    v_mfma_f32_16x16x32_bf16 a[0:3], v[24:27], v[152:155], a[0:3]
    ds_read_b64_tr_b16 v[40:41], v20 offset:8192
    v_mfma_f32_16x16x32_bf16 a[4:7], v[24:27], v[156:159], a[4:7]
    ds_read_b64_tr_b16 v[42:43], v20 offset:12288
    v_mfma_f32_16x16x32_bf16 a[8:11], v[24:27], v[160:163], a[8:11]
    ds_read_b64_tr_b16 v[44:45], v21 offset:8192
    s_mov_b32 s41, 149632
    buffer_load_dwordx4 v5, s[20:23], s41 offen offset:1024 nt lds
    v_mfma_f32_16x16x32_bf16 a[12:15], v[24:27], v[164:167], a[12:15]
    v_mfma_f32_16x16x32_bf16 a[16:19], v[24:27], v[168:171], a[16:19]
    ds_read_b64_tr_b16 v[46:47], v21 offset:12288
    s_waitcnt lgkmcnt(8)
    v_mfma_f32_16x16x32_bf16 a[20:23], v[28:31], v[152:155], a[20:23]
    ds_read_b64_tr_b16 v[48:49], v22 offset:8192
    v_mfma_f32_16x16x32_bf16 a[24:27], v[28:31], v[156:159], a[24:27]
    ds_read_b64_tr_b16 v[50:51], v22 offset:12288
    v_mfma_f32_16x16x32_bf16 a[28:31], v[28:31], v[160:163], a[28:31]
    v_mfma_f32_16x16x32_bf16 a[32:35], v[28:31], v[164:167], a[32:35]
    ds_read_b64_tr_b16 v[52:53], v23 offset:8192
    v_mfma_f32_16x16x32_bf16 a[36:39], v[28:31], v[168:171], a[36:39]
    ds_read_b64_tr_b16 v[54:55], v23 offset:12288
    s_mov_b32 s41, 151680
    buffer_load_dwordx4 v5, s[20:23], s41 offen offset:2048 nt lds
    s_waitcnt lgkmcnt(10)
    v_mfma_f32_16x16x32_bf16 a[40:43], v[32:35], v[152:155], a[40:43]
    v_mfma_f32_16x16x32_bf16 a[44:47], v[32:35], v[156:159], a[44:47]
    v_mfma_f32_16x16x32_bf16 a[48:51], v[32:35], v[160:163], a[48:51]
    v_mfma_f32_16x16x32_bf16 a[52:55], v[32:35], v[164:167], a[52:55]
    v_mfma_f32_16x16x32_bf16 a[56:59], v[32:35], v[168:171], a[56:59]
    s_waitcnt lgkmcnt(8)
    v_mfma_f32_16x16x32_bf16 a[60:63], v[36:39], v[152:155], a[60:63]
    v_mfma_f32_16x16x32_bf16 a[64:67], v[36:39], v[156:159], a[64:67]
    s_mov_b32 s41, 153728
    buffer_load_dwordx4 v5, s[20:23], s41 offen offset:3072 nt lds
    v_mfma_f32_16x16x32_bf16 a[68:71], v[36:39], v[160:163], a[68:71]
    v_mfma_f32_16x16x32_bf16 a[72:75], v[36:39], v[164:167], a[72:75]
    v_mfma_f32_16x16x32_bf16 a[76:79], v[36:39], v[168:171], a[76:79]
    v_mfma_f32_16x16x32_bf16 a[80:83], a[100:103], v[152:155], a[80:83]
    v_mfma_f32_16x16x32_bf16 a[84:87], a[100:103], v[156:159], a[84:87]
    v_mfma_f32_16x16x32_bf16 a[88:91], a[100:103], v[160:163], a[88:91]
    v_mfma_f32_16x16x32_bf16 a[92:95], a[100:103], v[164:167], a[92:95]
    v_mfma_f32_16x16x32_bf16 a[96:99], a[100:103], v[168:171], a[96:99]
    s_waitcnt lgkmcnt(0)
    s_waitcnt vmcnt(17)
    s_barrier
    v_mfma_f32_16x16x32_bf16 a[0:3], v[40:43], v[172:175], a[0:3]
    v_add_u32 v20, 0x4000, v20
    v_add_u32 v21, 0x4000, v21
    v_mfma_f32_16x16x32_bf16 a[4:7], v[40:43], v[176:179], a[4:7]
    v_add_u32 v22, 0x4000, v22
    v_mfma_f32_16x16x32_bf16 a[8:11], v[40:43], v[180:183], a[8:11]
    v_add_u32 v23, 0x4000, v23
    s_mov_b32 s41, 256
    s_add_u32 m0, s37, 143360
    s_nop 0
    buffer_load_dwordx4 v5, s[20:23], s41 offen nt lds
    v_mfma_f32_16x16x32_bf16 a[12:15], v[40:43], v[184:187], a[12:15]
    ds_read_b64_tr_b16 v[24:25], v20
    v_mfma_f32_16x16x32_bf16 a[16:19], v[40:43], v[188:191], a[16:19]
    ds_read_b64_tr_b16 v[26:27], v20 offset:4096
    v_mfma_f32_16x16x32_bf16 a[20:23], v[44:47], v[172:175], a[20:23]
    ds_read_b64_tr_b16 v[28:29], v21
    v_mfma_f32_16x16x32_bf16 a[24:27], v[44:47], v[176:179], a[24:27]
    ds_read_b64_tr_b16 v[30:31], v21 offset:4096
    v_mfma_f32_16x16x32_bf16 a[28:31], v[44:47], v[180:183], a[28:31]
    ds_read_b64_tr_b16 v[32:33], v22
    v_mfma_f32_16x16x32_bf16 a[32:35], v[44:47], v[184:187], a[32:35]
    ds_read_b64_tr_b16 v[34:35], v22 offset:4096
    v_mfma_f32_16x16x32_bf16 a[36:39], v[44:47], v[188:191], a[36:39]
    ds_read_b64_tr_b16 v[36:37], v23
    s_mov_b32 s41, 2304
    buffer_load_dwordx4 v5, s[20:23], s41 offen offset:1024 nt lds
    v_mfma_f32_16x16x32_bf16 a[40:43], v[48:51], v[172:175], a[40:43]
    ds_read_b64_tr_b16 v[38:39], v23 offset:4096
    v_mfma_f32_16x16x32_bf16 a[44:47], v[48:51], v[176:179], a[44:47]
    v_mfma_f32_16x16x32_bf16 a[48:51], v[48:51], v[180:183], a[48:51]
    v_mfma_f32_16x16x32_bf16 a[52:55], v[48:51], v[184:187], a[52:55]
    v_mfma_f32_16x16x32_bf16 a[56:59], v[48:51], v[188:191], a[56:59]
    v_mfma_f32_16x16x32_bf16 a[60:63], v[52:55], v[172:175], a[60:63]
    v_mfma_f32_16x16x32_bf16 a[64:67], v[52:55], v[176:179], a[64:67]
    s_mov_b32 s41, 4352
    buffer_load_dwordx4 v5, s[20:23], s41 offen offset:2048 nt lds
    v_mfma_f32_16x16x32_bf16 a[68:71], v[52:55], v[180:183], a[68:71]
    v_mfma_f32_16x16x32_bf16 a[72:75], v[52:55], v[184:187], a[72:75]
    v_mfma_f32_16x16x32_bf16 a[76:79], v[52:55], v[188:191], a[76:79]
    v_mfma_f32_16x16x32_bf16 a[80:83], a[100:103], v[172:175], a[80:83]
    v_mfma_f32_16x16x32_bf16 a[84:87], a[100:103], v[176:179], a[84:87]
    v_mfma_f32_16x16x32_bf16 a[88:91], a[100:103], v[180:183], a[88:91]
    v_mfma_f32_16x16x32_bf16 a[92:95], a[100:103], v[184:187], a[92:95]
    v_mfma_f32_16x16x32_bf16 a[96:99], a[100:103], v[188:191], a[96:99]
    s_waitcnt lgkmcnt(6)
    v_mfma_f32_16x16x32_bf16 a[0:3], v[24:27], v[192:195], a[0:3]
    ds_read_b64_tr_b16 v[40:41], v20 offset:8192
    v_mfma_f32_16x16x32_bf16 a[4:7], v[24:27], v[196:199], a[4:7]
    ds_read_b64_tr_b16 v[42:43], v20 offset:12288
    v_mfma_f32_16x16x32_bf16 a[8:11], v[24:27], v[200:203], a[8:11]
    ds_read_b64_tr_b16 v[44:45], v21 offset:8192
    s_mov_b32 s41, 6400
    buffer_load_dwordx4 v5, s[20:23], s41 offen offset:3072 nt lds
    v_mfma_f32_16x16x32_bf16 a[12:15], v[24:27], v[204:207], a[12:15]
    v_mfma_f32_16x16x32_bf16 a[16:19], v[24:27], v[208:211], a[16:19]
    ds_read_b64_tr_b16 v[46:47], v21 offset:12288
    s_waitcnt lgkmcnt(8)
    v_mfma_f32_16x16x32_bf16 a[20:23], v[28:31], v[192:195], a[20:23]
    ds_read_b64_tr_b16 v[48:49], v22 offset:8192
    v_mfma_f32_16x16x32_bf16 a[24:27], v[28:31], v[196:199], a[24:27]
    ds_read_b64_tr_b16 v[50:51], v22 offset:12288
    v_mfma_f32_16x16x32_bf16 a[28:31], v[28:31], v[200:203], a[28:31]
    v_mfma_f32_16x16x32_bf16 a[32:35], v[28:31], v[204:207], a[32:35]
    ds_read_b64_tr_b16 v[52:53], v23 offset:8192
    v_mfma_f32_16x16x32_bf16 a[36:39], v[28:31], v[208:211], a[36:39]
    ds_read_b64_tr_b16 v[54:55], v23 offset:12288
    s_mov_b32 s41, 49408
    s_add_u32 m0, s37, 12288
    s_nop 0
    buffer_load_dwordx4 v5, s[20:23], s41 offen nt lds
    s_waitcnt lgkmcnt(10)
    v_mfma_f32_16x16x32_bf16 a[40:43], v[32:35], v[192:195], a[40:43]
    v_mfma_f32_16x16x32_bf16 a[44:47], v[32:35], v[196:199], a[44:47]
    v_mfma_f32_16x16x32_bf16 a[48:51], v[32:35], v[200:203], a[48:51]
    v_mfma_f32_16x16x32_bf16 a[52:55], v[32:35], v[204:207], a[52:55]
    v_mfma_f32_16x16x32_bf16 a[56:59], v[32:35], v[208:211], a[56:59]
    s_waitcnt lgkmcnt(8)
    v_mfma_f32_16x16x32_bf16 a[60:63], v[36:39], v[192:195], a[60:63]
    v_mfma_f32_16x16x32_bf16 a[64:67], v[36:39], v[196:199], a[64:67]
    s_mov_b32 s41, 51456
    buffer_load_dwordx4 v5, s[20:23], s41 offen offset:1024 nt lds
    v_mfma_f32_16x16x32_bf16 a[68:71], v[36:39], v[200:203], a[68:71]
    v_mfma_f32_16x16x32_bf16 a[72:75], v[36:39], v[204:207], a[72:75]
    v_mfma_f32_16x16x32_bf16 a[76:79], v[36:39], v[208:211], a[76:79]
    v_mfma_f32_16x16x32_bf16 a[80:83], a[100:103], v[192:195], a[80:83]
    v_mfma_f32_16x16x32_bf16 a[84:87], a[100:103], v[196:199], a[84:87]
    v_mfma_f32_16x16x32_bf16 a[88:91], a[100:103], v[200:203], a[88:91]
    v_mfma_f32_16x16x32_bf16 a[92:95], a[100:103], v[204:207], a[92:95]
    v_mfma_f32_16x16x32_bf16 a[96:99], a[100:103], v[208:211], a[96:99]
    s_waitcnt lgkmcnt(0)
    s_waitcnt vmcnt(18)
    s_barrier
    v_mfma_f32_16x16x32_bf16 a[0:3], v[40:43], v[212:215], a[0:3]
    v_add_u32 v20, 0x4000, v20
    v_add_u32 v21, 0x4000, v21
    v_mfma_f32_16x16x32_bf16 a[4:7], v[40:43], v[216:219], a[4:7]
    v_add_u32 v22, 0x4000, v22
    v_mfma_f32_16x16x32_bf16 a[8:11], v[40:43], v[220:223], a[8:11]
    v_add_u32 v23, 0x4000, v23
    s_mov_b32 s41, 53504
    buffer_load_dwordx4 v5, s[20:23], s41 offen offset:2048 nt lds
    v_mfma_f32_16x16x32_bf16 a[12:15], v[40:43], v[224:227], a[12:15]
    ds_read_b64_tr_b16 v[24:25], v20
    v_mfma_f32_16x16x32_bf16 a[16:19], v[40:43], v[228:231], a[16:19]
    ds_read_b64_tr_b16 v[26:27], v20 offset:4096
    v_mfma_f32_16x16x32_bf16 a[20:23], v[44:47], v[212:215], a[20:23]
    ds_read_b64_tr_b16 v[28:29], v21
    v_mfma_f32_16x16x32_bf16 a[24:27], v[44:47], v[216:219], a[24:27]
    ds_read_b64_tr_b16 v[30:31], v21 offset:4096
    v_mfma_f32_16x16x32_bf16 a[28:31], v[44:47], v[220:223], a[28:31]
    ds_read_b64_tr_b16 v[32:33], v22
    v_mfma_f32_16x16x32_bf16 a[32:35], v[44:47], v[224:227], a[32:35]
    ds_read_b64_tr_b16 v[34:35], v22 offset:4096
    v_mfma_f32_16x16x32_bf16 a[36:39], v[44:47], v[228:231], a[36:39]
    ds_read_b64_tr_b16 v[36:37], v23
    s_mov_b32 s41, 55552
    buffer_load_dwordx4 v5, s[20:23], s41 offen offset:3072 nt lds
    v_mfma_f32_16x16x32_bf16 a[40:43], v[48:51], v[212:215], a[40:43]
    ds_read_b64_tr_b16 v[38:39], v23 offset:4096
    v_mfma_f32_16x16x32_bf16 a[44:47], v[48:51], v[216:219], a[44:47]
    v_mfma_f32_16x16x32_bf16 a[48:51], v[48:51], v[220:223], a[48:51]
    v_mfma_f32_16x16x32_bf16 a[52:55], v[48:51], v[224:227], a[52:55]
    v_mfma_f32_16x16x32_bf16 a[56:59], v[48:51], v[228:231], a[56:59]
    v_mfma_f32_16x16x32_bf16 a[60:63], v[52:55], v[212:215], a[60:63]
    v_mfma_f32_16x16x32_bf16 a[64:67], v[52:55], v[216:219], a[64:67]
    s_mov_b32 s41, 98560
    s_add_u32 m0, s37, 28672
    s_nop 0
    buffer_load_dwordx4 v5, s[20:23], s41 offen nt lds
    v_mfma_f32_16x16x32_bf16 a[68:71], v[52:55], v[220:223], a[68:71]
    v_mfma_f32_16x16x32_bf16 a[72:75], v[52:55], v[224:227], a[72:75]
    v_mfma_f32_16x16x32_bf16 a[76:79], v[52:55], v[228:231], a[76:79]
    v_mfma_f32_16x16x32_bf16 a[80:83], a[100:103], v[212:215], a[80:83]
    v_mfma_f32_16x16x32_bf16 a[84:87], a[100:103], v[216:219], a[84:87]
    v_mfma_f32_16x16x32_bf16 a[88:91], a[100:103], v[220:223], a[88:91]
    v_mfma_f32_16x16x32_bf16 a[92:95], a[100:103], v[224:227], a[92:95]
    v_mfma_f32_16x16x32_bf16 a[96:99], a[100:103], v[228:231], a[96:99]
    v_cmp_eq_u32 vcc, 64, v16
    s_nop 3
    s_and_b32 s79, vcc_lo, 15
    s_cmp_eq_u32 s79, 15
    s_cbranch_scc0 SLOW_I0
BACK_I0:
    s_waitcnt lgkmcnt(6)
    v_mfma_f32_16x16x32_bf16 a[120:123], v[24:27], v[72:75], 0
    ds_read_b64_tr_b16 v[40:41], v20 offset:8192
    v_mfma_f32_16x16x32_bf16 a[124:127], v[24:27], v[76:79], 0
    ds_read_b64_tr_b16 v[42:43], v20 offset:12288
    v_lshrrev_b32 v56, 4, v0
    v_bfe_u32 v57, v0, 2, 2
    v_mfma_f32_16x16x32_bf16 a[128:131], v[24:27], v[80:83], 0
    ds_read_b64_tr_b16 v[44:45], v21 offset:8192
    v_and_b32 v58, 3, v0
    s_mov_b32 s41, 100608
    buffer_load_dwordx4 v5, s[20:23], s41 offen offset:1024 nt lds
    v_mfma_f32_16x16x32_bf16 a[132:135], v[24:27], v[84:87], 0
    ds_read_b64_tr_b16 v[46:47], v21 offset:12288
    v_lshl_add_u32 v59, v56, 2, v57
    v_mul_u32_u24 v59, 320, v59
    v_mfma_f32_16x16x32_bf16 a[136:139], v[24:27], v[88:91], 0
    ds_read_b64_tr_b16 v[48:49], v22 offset:8192
    v_lshl_add_u32 v60, v58, 3, v59
    s_waitcnt lgkmcnt(9)
    v_mfma_f32_16x16x32_bf16 a[140:143], v[28:31], v[72:75], 0
    ds_read_b64_tr_b16 v[50:51], v22 offset:12288
    v_and_b32 v61, 1, v56
    s_mul_i32 s81, s30, 5
    v_mfma_f32_16x16x32_bf16 a[144:147], v[28:31], v[76:79], 0
    ds_read_b64_tr_b16 v[52:53], v23 offset:8192
    s_add_u32 s79, s81, 0
    v_mfma_f32_16x16x32_bf16 a[148:151], v[28:31], v[80:83], 0
    ds_read_b64_tr_b16 v[54:55], v23 offset:12288
    v_xor_b32 v59, s79, v61
    v_lshl_add_u32 v66, v59, 5, v60
    s_mov_b32 s41, 102656
    buffer_load_dwordx4 v5, s[20:23], s41 offen offset:2048 nt lds
    v_mfma_f32_16x16x32_bf16 a[152:155], v[28:31], v[84:87], 0
    s_add_u32 s79, s81, 1
    v_mfma_f32_16x16x32_bf16 a[156:159], v[28:31], v[88:91], 0
    v_xor_b32 v59, s79, v61
    v_lshl_add_u32 v67, v59, 5, v60
    s_waitcnt lgkmcnt(10)
    v_mfma_f32_16x16x32_bf16 a[160:163], v[32:35], v[72:75], 0
    s_add_u32 s79, s81, 2
    v_mfma_f32_16x16x32_bf16 a[164:167], v[32:35], v[76:79], 0
    v_xor_b32 v59, s79, v61
    v_lshl_add_u32 v68, v59, 5, v60
    v_mfma_f32_16x16x32_bf16 a[168:171], v[32:35], v[80:83], 0
    s_add_u32 s79, s81, 3
    s_mov_b32 s41, 104704
    buffer_load_dwordx4 v5, s[20:23], s41 offen offset:3072 nt lds
    v_mfma_f32_16x16x32_bf16 a[172:175], v[32:35], v[84:87], 0
    v_xor_b32 v59, s79, v61
    v_lshl_add_u32 v69, v59, 5, v60
    v_mfma_f32_16x16x32_bf16 a[176:179], v[32:35], v[88:91], 0
    s_add_u32 s79, s81, 4
    s_waitcnt lgkmcnt(8)
    v_mfma_f32_16x16x32_bf16 a[180:183], v[36:39], v[72:75], 0
    v_xor_b32 v59, s79, v61
    v_lshl_add_u32 v70, v59, 5, v60
    v_mfma_f32_16x16x32_bf16 a[184:187], v[36:39], v[76:79], 0
    v_lshlrev_b32 v59, 4, v0
    v_mfma_f32_16x16x32_bf16 a[188:191], v[36:39], v[80:83], 0
    s_mul_i32 s79, s29, 5120
    s_add_u32 s79, s79, 20480
    v_mfma_f32_16x16x32_bf16 a[192:195], v[36:39], v[84:87], 0
    v_add_u32 v71, s79, v59
    v_mfma_f32_16x16x32_bf16 a[196:199], v[36:39], v[88:91], 0
    s_waitcnt lgkmcnt(0)
    s_waitcnt vmcnt(20)
    s_barrier
    v_mfma_f32_16x16x32_bf16 a[120:123], v[40:43], v[92:95], a[120:123]
    v_add_u32 v20, 0x4000, v20
    v_add_u32 v21, 0x4000, v21
    v_mfma_f32_16x16x32_bf16 a[124:127], v[40:43], v[96:99], a[124:127]
    v_add_u32 v22, 0x4000, v22
    v_lshlrev_b32 v64, 4, v0
    s_mul_i32 s33, s28, 10240
    v_mfma_f32_16x16x32_bf16 a[128:131], v[40:43], v[100:103], a[128:131]
    v_add_u32 v23, 0x4000, v23
    s_add_u32 s33, s33, 61440
    s_mov_b32 s41, 147712
    s_add_u32 m0, s37, 45056
    s_nop 0
    buffer_load_dwordx4 v5, s[20:23], s41 offen nt lds
    v_mfma_f32_16x16x32_bf16 a[132:135], v[40:43], v[104:107], a[132:135]
    ds_read_b64_tr_b16 v[24:25], v20
    ds_read_b64_tr_b16 v[26:27], v20 offset:4096
    s_cmp_eq_u32 s28, 3
    s_cselect_b32 s33, 0, s33
    v_mfma_f32_16x16x32_bf16 a[136:139], v[40:43], v[108:111], a[136:139]
    ds_read_b64_tr_b16 v[28:29], v21
    v_add_u32 v65, s33, v64
    v_mfma_f32_16x16x32_bf16 a[140:143], v[44:47], v[92:95], a[140:143]
    ds_read_b64_tr_b16 v[30:31], v21 offset:4096
    ds_write_b128 v65, a[40:43]
    v_mfma_f32_16x16x32_bf16 a[144:147], v[44:47], v[96:99], a[144:147]
    ds_read_b64_tr_b16 v[32:33], v22
    ds_read_b64_tr_b16 v[34:35], v22 offset:4096
    ds_write_b128 v65, a[44:47] offset:1024
    v_mfma_f32_16x16x32_bf16 a[148:151], v[44:47], v[100:103], a[148:151]
    ds_read_b64_tr_b16 v[36:37], v23
    ds_write_b128 v65, a[48:51] offset:2048
    s_mov_b32 s41, 149760
    buffer_load_dwordx4 v5, s[20:23], s41 offen offset:1024 nt lds
    v_mfma_f32_16x16x32_bf16 a[152:155], v[44:47], v[104:107], a[152:155]
    ds_read_b64_tr_b16 v[38:39], v23 offset:4096
    ds_write_b128 v65, a[52:55] offset:3072
    v_mfma_f32_16x16x32_bf16 a[156:159], v[44:47], v[108:111], a[156:159]
    ds_write_b128 v65, a[56:59] offset:4096
    v_mfma_f32_16x16x32_bf16 a[160:163], v[48:51], v[92:95], a[160:163]
    ds_write_b128 v65, a[60:63] offset:5120
    v_mfma_f32_16x16x32_bf16 a[164:167], v[48:51], v[96:99], a[164:167]
    ds_write_b128 v65, a[64:67] offset:6144
    v_mfma_f32_16x16x32_bf16 a[168:171], v[48:51], v[100:103], a[168:171]
    ds_write_b128 v65, a[68:71] offset:7168
    s_mov_b32 s41, 151808
    buffer_load_dwordx4 v5, s[20:23], s41 offen offset:2048 nt lds
    v_mfma_f32_16x16x32_bf16 a[172:175], v[48:51], v[104:107], a[172:175]
    ds_write_b128 v65, a[72:75] offset:8192
    v_mfma_f32_16x16x32_bf16 a[176:179], v[48:51], v[108:111], a[176:179]
    ds_write_b128 v65, a[76:79] offset:9216
    v_mfma_f32_16x16x32_bf16 a[180:183], v[52:55], v[92:95], a[180:183]
    v_and_b32 v18, 15, v0
    v_mfma_f32_16x16x32_bf16 a[184:187], v[52:55], v[96:99], a[184:187]
    v_lshlrev_b32 v18, 2, v18
    v_mfma_f32_16x16x32_bf16 a[188:191], v[52:55], v[100:103], a[188:191]
    s_mul_i32 s33, s28, 320
    v_mfma_f32_16x16x32_bf16 a[192:195], v[52:55], v[104:107], a[192:195]
    s_add_u32 s33, s33, 161792
    v_mfma_f32_16x16x32_bf16 a[196:199], v[52:55], v[108:111], a[196:199]
    s_waitcnt lgkmcnt(15)
    v_mfma_f32_16x16x32_bf16 a[120:123], v[24:27], v[112:115], a[120:123]
    ds_read_b64_tr_b16 v[40:41], v20 offset:8192
    v_mfma_f32_16x16x32_bf16 a[124:127], v[24:27], v[116:119], a[124:127]
    ds_read_b64_tr_b16 v[42:43], v20 offset:12288
    v_add_u32 v19, s33, v18
    v_accvgpr_read_b32 v56, a80
    v_mfma_f32_16x16x32_bf16 a[128:131], v[24:27], v[120:123], a[128:131]
    ds_read_b64_tr_b16 v[44:45], v21 offset:8192
    ds_write_b32 v19, v56
    s_mov_b32 s41, 153856
    buffer_load_dwordx4 v5, s[20:23], s41 offen offset:3072 nt lds
    v_mfma_f32_16x16x32_bf16 a[132:135], v[24:27], v[124:127], a[132:135]
    ds_read_b64_tr_b16 v[46:47], v21 offset:12288
    v_accvgpr_read_b32 v57, a84
    v_mfma_f32_16x16x32_bf16 a[136:139], v[24:27], v[128:131], a[136:139]
    ds_read_b64_tr_b16 v[48:49], v22 offset:8192
    ds_write_b32 v19, v57 offset:64
    s_waitcnt lgkmcnt(15)
    v_mfma_f32_16x16x32_bf16 a[140:143], v[28:31], v[112:115], a[140:143]
    ds_read_b64_tr_b16 v[50:51], v22 offset:12288
    v_accvgpr_read_b32 v58, a88
    v_mfma_f32_16x16x32_bf16 a[144:147], v[28:31], v[116:119], a[144:147]
    ds_read_b64_tr_b16 v[52:53], v23 offset:8192
    ds_write_b32 v19, v58 offset:128
    v_mfma_f32_16x16x32_bf16 a[148:151], v[28:31], v[120:123], a[148:151]
    ds_read_b64_tr_b16 v[54:55], v23 offset:12288
    v_accvgpr_read_b32 v59, a92
    v_mfma_f32_16x16x32_bf16 a[152:155], v[28:31], v[124:127], a[152:155]
    ds_write_b32 v19, v59 offset:192
    v_mfma_f32_16x16x32_bf16 a[156:159], v[28:31], v[128:131], a[156:159]
    v_accvgpr_read_b32 v60, a96
    v_mfma_f32_16x16x32_bf16 a[160:163], v[32:35], v[112:115], a[160:163]
    ds_write_b32 v19, v60 offset:256
    s_xor_b32 s3, s28, 2
    v_mfma_f32_16x16x32_bf16 a[164:167], v[32:35], v[116:119], a[164:167]
    s_mul_i32 s3, s3, 320
    v_mfma_f32_16x16x32_bf16 a[168:171], v[32:35], v[120:123], a[168:171]
    s_add_u32 s3, s3, 161792
    v_mfma_f32_16x16x32_bf16 a[172:175], v[32:35], v[124:127], a[172:175]
    v_add_u32 v19, s3, v18
    v_mfma_f32_16x16x32_bf16 a[176:179], v[32:35], v[128:131], a[176:179]
    s_xor_b32 s3, s28, 2
    s_waitcnt lgkmcnt(15)
    v_mfma_f32_16x16x32_bf16 a[180:183], v[36:39], v[112:115], a[180:183]
    s_mul_i32 s33, s3, 10240
    v_mfma_f32_16x16x32_bf16 a[184:187], v[36:39], v[116:119], a[184:187]
    s_add_u32 s33, s33, 61440
    v_mfma_f32_16x16x32_bf16 a[188:191], v[36:39], v[120:123], a[188:191]
    s_cmp_eq_u32 s3, 3
    s_cselect_b32 s33, 0, s33
    v_mfma_f32_16x16x32_bf16 a[192:195], v[36:39], v[124:127], a[192:195]
    v_add_u32 v65, s33, v64
    v_mfma_f32_16x16x32_bf16 a[196:199], v[36:39], v[128:131], a[196:199]
    s_waitcnt lgkmcnt(0)
    s_waitcnt vmcnt(20)
    s_barrier
    v_mfma_f32_16x16x32_bf16 a[120:123], v[40:43], v[132:135], a[120:123]
    v_add_u32 v20, 0x4000, v20
    v_add_u32 v21, 0x4000, v21
    v_mfma_f32_16x16x32_bf16 a[124:127], v[40:43], v[136:139], a[124:127]
    v_add_u32 v22, 0x4000, v22
    ds_read_b32 v56, v19
    ds_read_b32 v57, v19 offset:64
    ds_read_b32 v58, v19 offset:128
    v_mfma_f32_16x16x32_bf16 a[128:131], v[40:43], v[140:143], a[128:131]
    v_add_u32 v23, 0x4000, v23
    ds_read_b32 v59, v19 offset:192
    ds_read_b32 v60, v19 offset:256
    v_accvgpr_read_b32 v61, a80
    v_mfma_f32_16x16x32_bf16 a[132:135], v[40:43], v[144:147], a[132:135]
    ds_read_b64_tr_b16 v[24:25], v20
    ds_read_b64_tr_b16 v[26:27], v20 offset:4096
    v_accvgpr_read_b32 v62, a108
    v_mul_f32 v61, v61, v11
    s_waitcnt lgkmcnt(6)
    v_fma_f32 v61, v56, v62, v61
    v_mfma_f32_16x16x32_bf16 a[136:139], v[40:43], v[148:151], a[136:139]
    ds_read_b64_tr_b16 v[28:29], v21
    v_rcp_f32 v61, v61
    s_nop 0
    v_mul_f32 v11, v11, v61
    v_mul_f32 v62, v62, v61
    v_mfma_f32_16x16x32_bf16 a[140:143], v[44:47], v[132:135], a[140:143]
    ds_read_b64_tr_b16 v[30:31], v21 offset:4096
    v_accvgpr_write_b32 a108, v62
    v_accvgpr_read_b32 v61, a84
    v_accvgpr_read_b32 v62, a109
    v_mfma_f32_16x16x32_bf16 a[144:147], v[44:47], v[136:139], a[144:147]
    ds_read_b64_tr_b16 v[32:33], v22
    ds_read_b64_tr_b16 v[34:35], v22 offset:4096
    v_mul_f32 v61, v61, v12
    s_waitcnt lgkmcnt(9)
    v_fma_f32 v61, v57, v62, v61
    v_rcp_f32 v61, v61
    v_mfma_f32_16x16x32_bf16 a[148:151], v[44:47], v[140:143], a[148:151]
    ds_read_b64_tr_b16 v[36:37], v23
    v_mul_f32 v12, v12, v61
    v_mul_f32 v62, v62, v61
    v_accvgpr_write_b32 a109, v62
    v_mfma_f32_16x16x32_bf16 a[152:155], v[44:47], v[144:147], a[152:155]
    ds_read_b64_tr_b16 v[38:39], v23 offset:4096
    v_accvgpr_read_b32 v61, a88
    v_accvgpr_read_b32 v62, a110
    v_mul_f32 v61, v61, v13
    v_mfma_f32_16x16x32_bf16 a[156:159], v[44:47], v[148:151], a[156:159]
    s_waitcnt lgkmcnt(10)
    v_fma_f32 v61, v58, v62, v61
    v_rcp_f32 v61, v61
    v_mfma_f32_16x16x32_bf16 a[160:163], v[48:51], v[132:135], a[160:163]
    v_mul_f32 v13, v13, v61
    v_mul_f32 v62, v62, v61
    v_accvgpr_write_b32 a110, v62
    v_mfma_f32_16x16x32_bf16 a[164:167], v[48:51], v[136:139], a[164:167]
    v_accvgpr_read_b32 v61, a92
    v_accvgpr_read_b32 v62, a111
    v_mul_f32 v61, v61, v14
    v_mfma_f32_16x16x32_bf16 a[168:171], v[48:51], v[140:143], a[168:171]
    s_waitcnt lgkmcnt(9)
    v_fma_f32 v61, v59, v62, v61
    v_rcp_f32 v61, v61
    s_nop 0
    v_mul_f32 v14, v14, v61
    v_mfma_f32_16x16x32_bf16 a[172:175], v[48:51], v[144:147], a[172:175]
    v_mul_f32 v62, v62, v61
    v_accvgpr_write_b32 a111, v62
    v_accvgpr_read_b32 v61, a96
    v_mfma_f32_16x16x32_bf16 a[176:179], v[48:51], v[148:151], a[176:179]
    v_accvgpr_read_b32 v62, a112
    v_mul_f32 v61, v61, v15
    s_waitcnt lgkmcnt(8)
    v_fma_f32 v61, v60, v62, v61
    v_mfma_f32_16x16x32_bf16 a[180:183], v[52:55], v[132:135], a[180:183]
    v_rcp_f32 v61, v61
    s_nop 0
    v_mul_f32 v15, v15, v61
    v_mul_f32 v62, v62, v61
    v_mfma_f32_16x16x32_bf16 a[184:187], v[52:55], v[136:139], a[184:187]
    v_accvgpr_write_b32 a112, v62
    s_mul_i32 s33, s30, 10240
    s_mul_i32 s3, s29, 5120
    v_mfma_f32_16x16x32_bf16 a[188:191], v[52:55], v[140:143], a[188:191]
    s_add_u32 s33, s33, s3
    v_add_u32 v64, s33, v64
    s_mov_b32 s43, 0
    v_mfma_f32_16x16x32_bf16 a[192:195], v[52:55], v[144:147], a[192:195]
    v_add_u32 v18, 4096, v64
    ds_read_b128 v[232:235], v65
    v_mfma_f32_16x16x32_bf16 a[196:199], v[52:55], v[148:151], a[196:199]
    s_waitcnt lgkmcnt(7)
    v_mfma_f32_16x16x32_bf16 a[120:123], v[24:27], v[152:155], a[120:123]
    ds_read_b64_tr_b16 v[40:41], v20 offset:8192
    v_mfma_f32_16x16x32_bf16 a[124:127], v[24:27], v[156:159], a[124:127]
    ds_read_b64_tr_b16 v[42:43], v20 offset:12288
    ds_read_b128 v[236:239], v65 offset:5120
    ds_read_b128 v[240:243], v65 offset:1024
    ds_read_b128 v[244:247], v65 offset:6144
    v_mfma_f32_16x16x32_bf16 a[128:131], v[24:27], v[160:163], a[128:131]
    ds_read_b64_tr_b16 v[44:45], v21 offset:8192
    v_accvgpr_read_b32 v56, a0
    v_accvgpr_read_b32 v57, a1
    v_accvgpr_read_b32 v58, a2
    v_mfma_f32_16x16x32_bf16 a[132:135], v[24:27], v[164:167], a[132:135]
    ds_read_b64_tr_b16 v[46:47], v21 offset:12288
    v_accvgpr_read_b32 v59, a3
    v_accvgpr_read_b32 v60, a20
    v_accvgpr_read_b32 v61, a21
    v_mfma_f32_16x16x32_bf16 a[136:139], v[24:27], v[168:171], a[136:139]
    ds_read_b64_tr_b16 v[48:49], v22 offset:8192
    v_accvgpr_read_b32 v62, a22
    v_accvgpr_read_b32 v63, a23
    v_accvgpr_read_b32 v252, a108
    s_waitcnt lgkmcnt(13)
    v_mfma_f32_16x16x32_bf16 a[140:143], v[28:31], v[152:155], a[140:143]
    ds_read_b64_tr_b16 v[50:51], v22 offset:12288
    v_mul_f32 v56, v56, v11
    v_mul_f32 v57, v57, v11
    v_mul_f32 v58, v58, v11
    v_mfma_f32_16x16x32_bf16 a[144:147], v[28:31], v[156:159], a[144:147]
    ds_read_b64_tr_b16 v[52:53], v23 offset:8192
    v_mul_f32 v59, v59, v11
    v_mul_f32 v60, v60, v11
    v_mul_f32 v61, v61, v11
    v_mfma_f32_16x16x32_bf16 a[148:151], v[28:31], v[160:163], a[148:151]
    ds_read_b64_tr_b16 v[54:55], v23 offset:12288
    v_mul_f32 v62, v62, v11
    v_mul_f32 v63, v63, v11
    s_waitcnt lgkmcnt(11)
    v_fma_f32 v56, v232, v252, v56
    v_mfma_f32_16x16x32_bf16 a[152:155], v[28:31], v[164:167], a[152:155]
    v_fma_f32 v57, v233, v252, v57
    v_fma_f32 v58, v234, v252, v58
    v_fma_f32 v59, v235, v252, v59
    v_mfma_f32_16x16x32_bf16 a[156:159], v[28:31], v[168:171], a[156:159]
    s_waitcnt lgkmcnt(8)
    v_fma_f32 v60, v236, v252, v60
    v_fma_f32 v61, v237, v252, v61
    v_fma_f32 v62, v238, v252, v62
    v_mfma_f32_16x16x32_bf16 a[160:163], v[32:35], v[152:155], a[160:163]
    v_fma_f32 v63, v239, v252, v63
    v_cvt_pk_bf16_f32 v248, v56, v57
    v_cvt_pk_bf16_f32 v249, v58, v59
    v_mfma_f32_16x16x32_bf16 a[164:167], v[32:35], v[156:159], a[164:167]
    v_cvt_pk_bf16_f32 v250, v60, v61
    v_cvt_pk_bf16_f32 v251, v62, v63
    buffer_store_dwordx4 v[248:251], v64, s[24:27], s43 offen sc1
    v_mfma_f32_16x16x32_bf16 a[168:171], v[32:35], v[160:163], a[168:171]
    ds_read_b128 v[232:235], v65 offset:2048
    ds_read_b128 v[236:239], v65 offset:7168
    v_accvgpr_read_b32 v56, a4
    v_mfma_f32_16x16x32_bf16 a[172:175], v[32:35], v[164:167], a[172:175]
    v_accvgpr_read_b32 v57, a5
    v_accvgpr_read_b32 v58, a6
    v_accvgpr_read_b32 v59, a7
    v_mfma_f32_16x16x32_bf16 a[176:179], v[32:35], v[168:171], a[176:179]
    v_accvgpr_read_b32 v60, a24
    v_accvgpr_read_b32 v61, a25
    v_accvgpr_read_b32 v62, a26
    v_mfma_f32_16x16x32_bf16 a[180:183], v[36:39], v[152:155], a[180:183]
    v_accvgpr_read_b32 v63, a27
    v_accvgpr_read_b32 v248, a109
    v_mul_f32 v56, v56, v12
    v_mfma_f32_16x16x32_bf16 a[184:187], v[36:39], v[156:159], a[184:187]
    v_mul_f32 v57, v57, v12
    v_mul_f32 v58, v58, v12
    v_mul_f32 v59, v59, v12
    v_mfma_f32_16x16x32_bf16 a[188:191], v[36:39], v[160:163], a[188:191]
    v_mul_f32 v60, v60, v12
    v_mul_f32 v61, v61, v12
    v_mul_f32 v62, v62, v12
    v_mfma_f32_16x16x32_bf16 a[192:195], v[36:39], v[164:167], a[192:195]
    v_mul_f32 v63, v63, v12
    s_waitcnt lgkmcnt(9)
    v_fma_f32 v56, v240, v248, v56
    v_mfma_f32_16x16x32_bf16 a[196:199], v[36:39], v[168:171], a[196:199]
    s_waitcnt lgkmcnt(0)
    s_waitcnt vmcnt(17)
    s_barrier
    v_mfma_f32_16x16x32_bf16 a[120:123], v[40:43], v[172:175], a[120:123]
    v_add_u32 v20, 0x4000, v20
    v_add_u32 v21, 0x4000, v21
    v_mfma_f32_16x16x32_bf16 a[124:127], v[40:43], v[176:179], a[124:127]
    v_add_u32 v22, 0x4000, v22
    v_fma_f32 v57, v241, v248, v57
    v_fma_f32 v58, v242, v248, v58
    v_fma_f32 v59, v243, v248, v59
    v_mfma_f32_16x16x32_bf16 a[128:131], v[40:43], v[180:183], a[128:131]
    v_add_u32 v23, 0x4000, v23
    v_fma_f32 v60, v244, v248, v60
    v_fma_f32 v61, v245, v248, v61
    v_fma_f32 v62, v246, v248, v62
    v_mfma_f32_16x16x32_bf16 a[132:135], v[40:43], v[184:187], a[132:135]
    ds_read_b64_tr_b16 v[24:25], v20
    ds_read_b64_tr_b16 v[26:27], v20 offset:4096
    v_fma_f32 v63, v247, v248, v63
    v_cvt_pk_bf16_f32 v252, v56, v57
    v_cvt_pk_bf16_f32 v253, v58, v59
    v_mfma_f32_16x16x32_bf16 a[136:139], v[40:43], v[188:191], a[136:139]
    ds_read_b64_tr_b16 v[28:29], v21
    v_cvt_pk_bf16_f32 v254, v60, v61
    v_cvt_pk_bf16_f32 v255, v62, v63
    buffer_store_dwordx4 v[252:255], v64, s[24:27], s43 offen offset:1024 sc1
    v_mfma_f32_16x16x32_bf16 a[140:143], v[44:47], v[172:175], a[140:143]
    ds_read_b64_tr_b16 v[30:31], v21 offset:4096
    ds_read_b128 v[240:243], v65 offset:3072
    ds_read_b128 v[244:247], v65 offset:8192
    v_accvgpr_read_b32 v56, a8
    v_mfma_f32_16x16x32_bf16 a[144:147], v[44:47], v[176:179], a[144:147]
    ds_read_b64_tr_b16 v[32:33], v22
    ds_read_b64_tr_b16 v[34:35], v22 offset:4096
    v_accvgpr_read_b32 v57, a9
    v_accvgpr_read_b32 v58, a10
    v_accvgpr_read_b32 v59, a11
    v_mfma_f32_16x16x32_bf16 a[148:151], v[44:47], v[180:183], a[148:151]
    ds_read_b64_tr_b16 v[36:37], v23
    v_accvgpr_read_b32 v60, a28
    v_accvgpr_read_b32 v61, a29
    v_accvgpr_read_b32 v62, a30
    v_mfma_f32_16x16x32_bf16 a[152:155], v[44:47], v[184:187], a[152:155]
    ds_read_b64_tr_b16 v[38:39], v23 offset:4096
    v_accvgpr_read_b32 v63, a31
    v_accvgpr_read_b32 v252, a110
    v_mul_f32 v56, v56, v13
    v_mfma_f32_16x16x32_bf16 a[156:159], v[44:47], v[188:191], a[156:159]
    v_mul_f32 v57, v57, v13
    v_mul_f32 v58, v58, v13
    v_mul_f32 v59, v59, v13
    v_mfma_f32_16x16x32_bf16 a[160:163], v[48:51], v[172:175], a[160:163]
    v_mul_f32 v60, v60, v13
    v_mul_f32 v61, v61, v13
    v_mul_f32 v62, v62, v13
    v_mfma_f32_16x16x32_bf16 a[164:167], v[48:51], v[176:179], a[164:167]
    v_mul_f32 v63, v63, v13
    v_fma_f32 v56, v232, v252, v56
    v_fma_f32 v57, v233, v252, v57
    v_mfma_f32_16x16x32_bf16 a[168:171], v[48:51], v[180:183], a[168:171]
    v_fma_f32 v58, v234, v252, v58
    v_fma_f32 v59, v235, v252, v59
    v_fma_f32 v60, v236, v252, v60
    v_mfma_f32_16x16x32_bf16 a[172:175], v[48:51], v[184:187], a[172:175]
    v_fma_f32 v61, v237, v252, v61
    v_fma_f32 v62, v238, v252, v62
    v_fma_f32 v63, v239, v252, v63
    v_mfma_f32_16x16x32_bf16 a[176:179], v[48:51], v[188:191], a[176:179]
    v_cvt_pk_bf16_f32 v248, v56, v57
    v_cvt_pk_bf16_f32 v249, v58, v59
    v_cvt_pk_bf16_f32 v250, v60, v61
    v_mfma_f32_16x16x32_bf16 a[180:183], v[52:55], v[172:175], a[180:183]
    v_cvt_pk_bf16_f32 v251, v62, v63
    buffer_store_dwordx4 v[248:251], v64, s[24:27], s43 offen offset:2048 sc1
    ds_read_b128 v[232:235], v65 offset:4096
    v_mfma_f32_16x16x32_bf16 a[184:187], v[52:55], v[176:179], a[184:187]
    ds_read_b128 v[236:239], v65 offset:9216
    v_accvgpr_read_b32 v56, a12
    v_accvgpr_read_b32 v57, a13
    v_mfma_f32_16x16x32_bf16 a[188:191], v[52:55], v[180:183], a[188:191]
    v_accvgpr_read_b32 v58, a14
    v_accvgpr_read_b32 v59, a15
    v_accvgpr_read_b32 v60, a32
    v_mfma_f32_16x16x32_bf16 a[192:195], v[52:55], v[184:187], a[192:195]
    v_accvgpr_read_b32 v61, a33
    v_accvgpr_read_b32 v62, a34
    v_mfma_f32_16x16x32_bf16 a[196:199], v[52:55], v[188:191], a[196:199]
    s_waitcnt lgkmcnt(10)
    v_mfma_f32_16x16x32_bf16 a[120:123], v[24:27], v[192:195], a[120:123]
    ds_read_b64_tr_b16 v[40:41], v20 offset:8192
    v_mfma_f32_16x16x32_bf16 a[124:127], v[24:27], v[196:199], a[124:127]
    ds_read_b64_tr_b16 v[42:43], v20 offset:12288
    v_accvgpr_read_b32 v63, a35
    v_accvgpr_read_b32 v248, a111
    v_mul_f32 v56, v56, v14
    v_mfma_f32_16x16x32_bf16 a[128:131], v[24:27], v[200:203], a[128:131]
    ds_read_b64_tr_b16 v[44:45], v21 offset:8192
    v_mul_f32 v57, v57, v14
    v_mul_f32 v58, v58, v14
    v_mul_f32 v59, v59, v14
    v_mfma_f32_16x16x32_bf16 a[132:135], v[24:27], v[204:207], a[132:135]
    ds_read_b64_tr_b16 v[46:47], v21 offset:12288
    v_mul_f32 v60, v60, v14
    v_mul_f32 v61, v61, v14
    v_mul_f32 v62, v62, v14
    v_mfma_f32_16x16x32_bf16 a[136:139], v[24:27], v[208:211], a[136:139]
    ds_read_b64_tr_b16 v[48:49], v22 offset:8192
    v_mul_f32 v63, v63, v14
    s_waitcnt lgkmcnt(12)
    v_fma_f32 v56, v240, v248, v56
    v_fma_f32 v57, v241, v248, v57
    v_mfma_f32_16x16x32_bf16 a[140:143], v[28:31], v[192:195], a[140:143]
    ds_read_b64_tr_b16 v[50:51], v22 offset:12288
    v_fma_f32 v58, v242, v248, v58
    v_fma_f32 v59, v243, v248, v59
    s_waitcnt lgkmcnt(12)
    v_fma_f32 v60, v244, v248, v60
    v_mfma_f32_16x16x32_bf16 a[144:147], v[28:31], v[196:199], a[144:147]
    ds_read_b64_tr_b16 v[52:53], v23 offset:8192
    v_fma_f32 v61, v245, v248, v61
    v_fma_f32 v62, v246, v248, v62
    v_fma_f32 v63, v247, v248, v63
    v_mfma_f32_16x16x32_bf16 a[148:151], v[28:31], v[200:203], a[148:151]
    ds_read_b64_tr_b16 v[54:55], v23 offset:12288
    v_cvt_pk_bf16_f32 v252, v56, v57
    v_cvt_pk_bf16_f32 v253, v58, v59
    v_cvt_pk_bf16_f32 v254, v60, v61
    v_mfma_f32_16x16x32_bf16 a[152:155], v[28:31], v[204:207], a[152:155]
    v_cvt_pk_bf16_f32 v255, v62, v63
    buffer_store_dwordx4 v[252:255], v64, s[24:27], s43 offen offset:3072 sc1
    v_accvgpr_read_b32 v56, a16
    v_mfma_f32_16x16x32_bf16 a[156:159], v[28:31], v[208:211], a[156:159]
    v_accvgpr_read_b32 v57, a17
    v_accvgpr_read_b32 v58, a18
    v_accvgpr_read_b32 v59, a19
    s_waitcnt lgkmcnt(12)
    v_mfma_f32_16x16x32_bf16 a[160:163], v[32:35], v[192:195], a[160:163]
    v_accvgpr_read_b32 v60, a36
    v_accvgpr_read_b32 v61, a37
    v_accvgpr_read_b32 v62, a38
    v_mfma_f32_16x16x32_bf16 a[164:167], v[32:35], v[196:199], a[164:167]
    v_accvgpr_read_b32 v63, a39
    v_accvgpr_read_b32 v252, a112
    v_mul_f32 v56, v56, v15
    v_mfma_f32_16x16x32_bf16 a[168:171], v[32:35], v[200:203], a[168:171]
    v_mul_f32 v57, v57, v15
    v_mul_f32 v58, v58, v15
    v_mul_f32 v59, v59, v15
    v_mfma_f32_16x16x32_bf16 a[172:175], v[32:35], v[204:207], a[172:175]
    v_mul_f32 v60, v60, v15
    v_mul_f32 v61, v61, v15
    v_mul_f32 v62, v62, v15
    v_mfma_f32_16x16x32_bf16 a[176:179], v[32:35], v[208:211], a[176:179]
    v_mul_f32 v63, v63, v15
    s_waitcnt lgkmcnt(9)
    v_fma_f32 v56, v232, v252, v56
    v_fma_f32 v57, v233, v252, v57
    v_mfma_f32_16x16x32_bf16 a[180:183], v[36:39], v[192:195], a[180:183]
    v_fma_f32 v58, v234, v252, v58
    v_fma_f32 v59, v235, v252, v59
    s_waitcnt lgkmcnt(8)
    v_fma_f32 v60, v236, v252, v60
    v_mfma_f32_16x16x32_bf16 a[184:187], v[36:39], v[196:199], a[184:187]
    v_fma_f32 v61, v237, v252, v61
    v_fma_f32 v62, v238, v252, v62
    v_fma_f32 v63, v239, v252, v63
    v_mfma_f32_16x16x32_bf16 a[188:191], v[36:39], v[200:203], a[188:191]
    v_cvt_pk_bf16_f32 v248, v56, v57
    v_cvt_pk_bf16_f32 v249, v58, v59
    v_cvt_pk_bf16_f32 v250, v60, v61
    v_mfma_f32_16x16x32_bf16 a[192:195], v[36:39], v[204:207], a[192:195]
    v_cvt_pk_bf16_f32 v251, v62, v63
    buffer_store_dwordx4 v[248:251], v18, s[24:27], s43 offen sc1
    v_mfma_f32_16x16x32_bf16 a[196:199], v[36:39], v[208:211], a[196:199]
    s_waitcnt lgkmcnt(0)
    s_waitcnt vmcnt(17)
    s_barrier
    v_mfma_f32_16x16x32_bf16 a[120:123], v[40:43], v[212:215], a[120:123]
    v_add_u32 v20, 0x4000, v20
    v_add_u32 v21, 0x4000, v21
    v_mfma_f32_16x16x32_bf16 a[124:127], v[40:43], v[216:219], a[124:127]
    v_add_u32 v22, 0x4000, v22
    v_mfma_f32_16x16x32_bf16 a[128:131], v[40:43], v[220:223], a[128:131]
    v_add_u32 v23, 0x4000, v23
    v_mfma_f32_16x16x32_bf16 a[132:135], v[40:43], v[224:227], a[132:135]
    ds_read_b64_tr_b16 v[24:25], v20
    ds_read_b64_tr_b16 v[26:27], v20 offset:4096
    v_mfma_f32_16x16x32_bf16 a[136:139], v[40:43], v[228:231], a[136:139]
    ds_read_b64_tr_b16 v[28:29], v21
    v_mfma_f32_16x16x32_bf16 a[140:143], v[44:47], v[212:215], a[140:143]
    ds_read_b64_tr_b16 v[30:31], v21 offset:4096
    v_mfma_f32_16x16x32_bf16 a[144:147], v[44:47], v[216:219], a[144:147]
    ds_read_b64_tr_b16 v[32:33], v22
    ds_read_b64_tr_b16 v[34:35], v22 offset:4096
    v_mfma_f32_16x16x32_bf16 a[148:151], v[44:47], v[220:223], a[148:151]
    ds_read_b64_tr_b16 v[36:37], v23
    v_mfma_f32_16x16x32_bf16 a[152:155], v[44:47], v[224:227], a[152:155]
    ds_read_b64_tr_b16 v[38:39], v23 offset:4096
    v_mfma_f32_16x16x32_bf16 a[156:159], v[44:47], v[228:231], a[156:159]
    v_mfma_f32_16x16x32_bf16 a[160:163], v[48:51], v[212:215], a[160:163]
    v_mfma_f32_16x16x32_bf16 a[164:167], v[48:51], v[216:219], a[164:167]
    v_mfma_f32_16x16x32_bf16 a[168:171], v[48:51], v[220:223], a[168:171]
    v_mfma_f32_16x16x32_bf16 a[172:175], v[48:51], v[224:227], a[172:175]
    v_mfma_f32_16x16x32_bf16 a[176:179], v[48:51], v[228:231], a[176:179]
    v_mfma_f32_16x16x32_bf16 a[180:183], v[52:55], v[212:215], a[180:183]
    v_mfma_f32_16x16x32_bf16 a[184:187], v[52:55], v[216:219], a[184:187]
    v_mfma_f32_16x16x32_bf16 a[188:191], v[52:55], v[220:223], a[188:191]
    v_mfma_f32_16x16x32_bf16 a[192:195], v[52:55], v[224:227], a[192:195]
    v_mfma_f32_16x16x32_bf16 a[196:199], v[52:55], v[228:231], a[196:199]
    s_waitcnt lgkmcnt(6)
    v_mfma_f32_16x16x32_bf16 a[0:3], v[24:27], v[72:75], 0
    ds_read_b64_tr_b16 v[40:41], v20 offset:8192
    v_mfma_f32_16x16x32_bf16 a[4:7], v[24:27], v[76:79], 0
    ds_read_b64_tr_b16 v[42:43], v20 offset:12288
    v_mfma_f32_16x16x32_bf16 a[8:11], v[24:27], v[80:83], 0
    ds_read_b64_tr_b16 v[44:45], v21 offset:8192
    v_mfma_f32_16x16x32_bf16 a[12:15], v[24:27], v[84:87], 0
    ds_read_b64_tr_b16 v[46:47], v21 offset:12288
    v_mfma_f32_16x16x32_bf16 a[16:19], v[24:27], v[88:91], 0
    ds_read_b64_tr_b16 v[48:49], v22 offset:8192
    s_waitcnt lgkmcnt(9)
    v_mfma_f32_16x16x32_bf16 a[20:23], v[28:31], v[72:75], 0
    ds_read_b64_tr_b16 v[50:51], v22 offset:12288
    v_mfma_f32_16x16x32_bf16 a[24:27], v[28:31], v[76:79], 0
    ds_read_b64_tr_b16 v[52:53], v23 offset:8192
    v_mfma_f32_16x16x32_bf16 a[28:31], v[28:31], v[80:83], 0
    ds_read_b64_tr_b16 v[54:55], v23 offset:12288
    v_mfma_f32_16x16x32_bf16 a[32:35], v[28:31], v[84:87], 0
    v_mfma_f32_16x16x32_bf16 a[36:39], v[28:31], v[88:91], 0
    s_waitcnt lgkmcnt(10)
    v_mfma_f32_16x16x32_bf16 a[40:43], v[32:35], v[72:75], 0
    v_mfma_f32_16x16x32_bf16 a[44:47], v[32:35], v[76:79], 0
    v_mfma_f32_16x16x32_bf16 a[48:51], v[32:35], v[80:83], 0
    v_mfma_f32_16x16x32_bf16 a[52:55], v[32:35], v[84:87], 0
    v_mfma_f32_16x16x32_bf16 a[56:59], v[32:35], v[88:91], 0
    s_waitcnt lgkmcnt(8)
    v_mfma_f32_16x16x32_bf16 a[60:63], v[36:39], v[72:75], 0
    v_mfma_f32_16x16x32_bf16 a[64:67], v[36:39], v[76:79], 0
    v_mfma_f32_16x16x32_bf16 a[68:71], v[36:39], v[80:83], 0
    v_mfma_f32_16x16x32_bf16 a[72:75], v[36:39], v[84:87], 0
    v_mfma_f32_16x16x32_bf16 a[76:79], v[36:39], v[88:91], 0
    s_waitcnt lgkmcnt(0)
    s_waitcnt vmcnt(13)
    s_barrier
    v_mfma_f32_16x16x32_bf16 a[0:3], v[40:43], v[92:95], a[0:3]
    v_add_u32 v20, 0xfffe0000, v20
    v_add_u32 v21, 0xfffe0000, v21
    v_mfma_f32_16x16x32_bf16 a[4:7], v[40:43], v[96:99], a[4:7]
    v_add_u32 v22, 0xfffe0000, v22
    s_mov_b32 s1, 0
    buffer_load_dword a104, v10, s[8:11], s1 offen
    v_mfma_f32_16x16x32_bf16 a[8:11], v[40:43], v[100:103], a[8:11]
    v_add_u32 v23, 0xfffe0000, v23
    v_lshlrev_b32 v64, 4, v0
    s_add_u32 s77, s64, 0
    s_add_u32 m0, s75, 122880
    s_nop 0
    buffer_load_dwordx4 v1, s[44:47], s77 offen lds
    v_mfma_f32_16x16x32_bf16 a[12:15], v[40:43], v[104:107], a[12:15]
    ds_read_b64_tr_b16 v[24:25], v20
    ds_read_b64_tr_b16 v[26:27], v20 offset:4096
    v_mfma_f32_16x16x32_bf16 a[16:19], v[40:43], v[108:111], a[16:19]
    ds_read_b64_tr_b16 v[28:29], v21
    s_mul_i32 s33, s28, 10240
    v_mfma_f32_16x16x32_bf16 a[20:23], v[44:47], v[92:95], a[20:23]
    ds_read_b64_tr_b16 v[30:31], v21 offset:4096
    s_add_u32 s33, s33, 61440
    v_mfma_f32_16x16x32_bf16 a[24:27], v[44:47], v[96:99], a[24:27]
    ds_read_b64_tr_b16 v[32:33], v22
    ds_read_b64_tr_b16 v[34:35], v22 offset:4096
    v_mfma_f32_16x16x32_bf16 a[28:31], v[44:47], v[100:103], a[28:31]
    ds_read_b64_tr_b16 v[36:37], v23
    s_cmp_eq_u32 s28, 3
    s_cselect_b32 s33, 0, s33
    buffer_load_dwordx4 v3, s[44:47], s77 offen offset:1024 lds
    v_mfma_f32_16x16x32_bf16 a[32:35], v[44:47], v[104:107], a[32:35]
    ds_read_b64_tr_b16 v[38:39], v23 offset:4096
    v_mfma_f32_16x16x32_bf16 a[36:39], v[44:47], v[108:111], a[36:39]
    v_add_u32 v65, s33, v64
    v_mfma_f32_16x16x32_bf16 a[40:43], v[48:51], v[92:95], a[40:43]
    ds_write_b128 v65, a[160:163]
    v_mfma_f32_16x16x32_bf16 a[44:47], v[48:51], v[96:99], a[44:47]
    v_mfma_f32_16x16x32_bf16 a[48:51], v[48:51], v[100:103], a[48:51]
    ds_write_b128 v65, a[164:167] offset:1024
    buffer_load_dwordx4 v4, s[44:47], s77 offen offset:2048 lds
    v_mfma_f32_16x16x32_bf16 a[52:55], v[48:51], v[104:107], a[52:55]
    v_mfma_f32_16x16x32_bf16 a[56:59], v[48:51], v[108:111], a[56:59]
    ds_write_b128 v65, a[168:171] offset:2048
    v_mfma_f32_16x16x32_bf16 a[60:63], v[52:55], v[92:95], a[60:63]
    ds_write_b128 v65, a[172:175] offset:3072
    v_mfma_f32_16x16x32_bf16 a[64:67], v[52:55], v[96:99], a[64:67]
    v_mfma_f32_16x16x32_bf16 a[68:71], v[52:55], v[100:103], a[68:71]
    ds_write_b128 v65, a[176:179] offset:4096
    v_mfma_f32_16x16x32_bf16 a[72:75], v[52:55], v[104:107], a[72:75]
    v_mfma_f32_16x16x32_bf16 a[76:79], v[52:55], v[108:111], a[76:79]
    s_waitcnt lgkmcnt(11)
    v_mfma_f32_16x16x32_bf16 a[0:3], v[24:27], v[112:115], a[0:3]
    ds_read_b64_tr_b16 v[40:41], v20 offset:8192
    v_mfma_f32_16x16x32_bf16 a[4:7], v[24:27], v[116:119], a[4:7]
    ds_read_b64_tr_b16 v[42:43], v20 offset:12288
    ds_write_b128 v65, a[180:183] offset:5120
    v_mfma_f32_16x16x32_bf16 a[8:11], v[24:27], v[120:123], a[8:11]
    ds_read_b64_tr_b16 v[44:45], v21 offset:8192
    ds_write_b128 v65, a[184:187] offset:6144
    buffer_load_dwordx4 v6, s[44:47], s77 offen offset:3072 lds
    v_mfma_f32_16x16x32_bf16 a[12:15], v[24:27], v[124:127], a[12:15]
    ds_read_b64_tr_b16 v[46:47], v21 offset:12288
    v_mfma_f32_16x16x32_bf16 a[16:19], v[24:27], v[128:131], a[16:19]
    ds_read_b64_tr_b16 v[48:49], v22 offset:8192
    ds_write_b128 v65, a[188:191] offset:7168
    s_waitcnt lgkmcnt(15)
    v_mfma_f32_16x16x32_bf16 a[20:23], v[28:31], v[112:115], a[20:23]
    ds_read_b64_tr_b16 v[50:51], v22 offset:12288
    v_mfma_f32_16x16x32_bf16 a[24:27], v[28:31], v[116:119], a[24:27]
    ds_read_b64_tr_b16 v[52:53], v23 offset:8192
    ds_write_b128 v65, a[192:195] offset:8192
    v_mfma_f32_16x16x32_bf16 a[28:31], v[28:31], v[120:123], a[28:31]
    ds_read_b64_tr_b16 v[54:55], v23 offset:12288
    s_add_u32 m0, s75, 126976
    s_nop 0
    buffer_load_dwordx4 v7, s[44:47], s77 offen lds
    v_mfma_f32_16x16x32_bf16 a[32:35], v[28:31], v[124:127], a[32:35]
    ds_write_b128 v65, a[196:199] offset:9216
    v_mfma_f32_16x16x32_bf16 a[36:39], v[28:31], v[128:131], a[36:39]
    v_mfma_f32_16x16x32_bf16 a[40:43], v[32:35], v[112:115], a[40:43]
    s_xor_b32 s3, s28, 2
    v_mfma_f32_16x16x32_bf16 a[44:47], v[32:35], v[116:119], a[44:47]
    s_mul_i32 s33, s3, 10240
    v_mfma_f32_16x16x32_bf16 a[48:51], v[32:35], v[120:123], a[48:51]
    v_mfma_f32_16x16x32_bf16 a[52:55], v[32:35], v[124:127], a[52:55]
    s_add_u32 s33, s33, 61440
    v_mfma_f32_16x16x32_bf16 a[56:59], v[32:35], v[128:131], a[56:59]
    s_waitcnt lgkmcnt(15)
    v_mfma_f32_16x16x32_bf16 a[60:63], v[36:39], v[112:115], a[60:63]
    s_cmp_eq_u32 s3, 3
    s_cselect_b32 s33, 0, s33
    v_mfma_f32_16x16x32_bf16 a[64:67], v[36:39], v[116:119], a[64:67]
    v_mfma_f32_16x16x32_bf16 a[68:71], v[36:39], v[120:123], a[68:71]
    v_add_u32 v65, s33, v64
    v_mfma_f32_16x16x32_bf16 a[72:75], v[36:39], v[124:127], a[72:75]
    v_mfma_f32_16x16x32_bf16 a[76:79], v[36:39], v[128:131], a[76:79]
    s_waitcnt lgkmcnt(0)
    s_waitcnt vmcnt(15)
    s_barrier
    v_mfma_f32_16x16x32_bf16 a[0:3], v[40:43], v[132:135], a[0:3]
    v_add_u32 v20, 0x4000, v20
    v_add_u32 v21, 0x4000, v21
    v_mfma_f32_16x16x32_bf16 a[4:7], v[40:43], v[136:139], a[4:7]
    v_add_u32 v22, 0x4000, v22
    s_mul_i32 s33, s30, 10240
    s_mul_i32 s3, s29, 5120
    v_mfma_f32_16x16x32_bf16 a[8:11], v[40:43], v[140:143], a[8:11]
    v_add_u32 v23, 0x4000, v23
    s_add_u32 s33, s33, s3
    v_add_u32 v64, s33, v64
    v_mfma_f32_16x16x32_bf16 a[12:15], v[40:43], v[144:147], a[12:15]
    ds_read_b64_tr_b16 v[24:25], v20
    ds_read_b64_tr_b16 v[26:27], v20 offset:4096
    s_mov_b32 s43, 20480
    v_add_u32 v18, 4096, v64
    v_mfma_f32_16x16x32_bf16 a[16:19], v[40:43], v[148:151], a[16:19]
    ds_read_b64_tr_b16 v[28:29], v21
    ds_read_b128 v[232:235], v65
    ds_read_b128 v[236:239], v65 offset:5120
    v_mfma_f32_16x16x32_bf16 a[20:23], v[44:47], v[132:135], a[20:23]
    ds_read_b64_tr_b16 v[30:31], v21 offset:4096
    ds_read_b128 v[240:243], v65 offset:1024
    ds_read_b128 v[244:247], v65 offset:6144
    v_mfma_f32_16x16x32_bf16 a[24:27], v[44:47], v[136:139], a[24:27]
    ds_read_b64_tr_b16 v[32:33], v22
    ds_read_b64_tr_b16 v[34:35], v22 offset:4096
    v_accvgpr_read_b32 v56, a120
    v_mfma_f32_16x16x32_bf16 a[28:31], v[44:47], v[140:143], a[28:31]
    ds_read_b64_tr_b16 v[36:37], v23
    v_accvgpr_read_b32 v57, a121
    v_accvgpr_read_b32 v58, a122
    v_mfma_f32_16x16x32_bf16 a[32:35], v[44:47], v[144:147], a[32:35]
    ds_read_b64_tr_b16 v[38:39], v23 offset:4096
    v_accvgpr_read_b32 v59, a123
    v_accvgpr_read_b32 v60, a140
    v_mfma_f32_16x16x32_bf16 a[36:39], v[44:47], v[148:151], a[36:39]
    v_accvgpr_read_b32 v61, a141
    v_accvgpr_read_b32 v62, a142
    v_mfma_f32_16x16x32_bf16 a[40:43], v[48:51], v[132:135], a[40:43]
    v_accvgpr_read_b32 v63, a143
    v_accvgpr_read_b32 v252, a108
    v_mfma_f32_16x16x32_bf16 a[44:47], v[48:51], v[136:139], a[44:47]
    v_mul_f32 v56, v56, v11
    v_mul_f32 v57, v57, v11
    v_mfma_f32_16x16x32_bf16 a[48:51], v[48:51], v[140:143], a[48:51]
    v_mul_f32 v58, v58, v11
    v_mfma_f32_16x16x32_bf16 a[52:55], v[48:51], v[144:147], a[52:55]
    v_mul_f32 v59, v59, v11
    v_mul_f32 v60, v60, v11
    v_mfma_f32_16x16x32_bf16 a[56:59], v[48:51], v[148:151], a[56:59]
    v_mul_f32 v61, v61, v11
    v_mul_f32 v62, v62, v11
    v_mfma_f32_16x16x32_bf16 a[60:63], v[52:55], v[132:135], a[60:63]
    v_mul_f32 v63, v63, v11
    s_waitcnt lgkmcnt(8)
    v_fma_f32 v56, v232, v252, v56
    v_mfma_f32_16x16x32_bf16 a[64:67], v[52:55], v[136:139], a[64:67]
    v_fma_f32 v57, v233, v252, v57
    v_fma_f32 v58, v234, v252, v58
    v_mfma_f32_16x16x32_bf16 a[68:71], v[52:55], v[140:143], a[68:71]
    v_fma_f32 v59, v235, v252, v59
    s_waitcnt lgkmcnt(7)
    v_fma_f32 v60, v236, v252, v60
    v_mfma_f32_16x16x32_bf16 a[72:75], v[52:55], v[144:147], a[72:75]
    v_fma_f32 v61, v237, v252, v61
    v_mfma_f32_16x16x32_bf16 a[76:79], v[52:55], v[148:151], a[76:79]
    v_mfma_f32_16x16x32_bf16 a[0:3], v[24:27], v[152:155], a[0:3]
    ds_read_b64_tr_b16 v[40:41], v20 offset:8192
    v_mfma_f32_16x16x32_bf16 a[4:7], v[24:27], v[156:159], a[4:7]
    ds_read_b64_tr_b16 v[42:43], v20 offset:12288
    v_fma_f32 v62, v238, v252, v62
    v_fma_f32 v63, v239, v252, v63
    v_mfma_f32_16x16x32_bf16 a[8:11], v[24:27], v[160:163], a[8:11]
    ds_read_b64_tr_b16 v[44:45], v21 offset:8192
    v_cvt_pk_bf16_f32 v248, v56, v57
    v_cvt_pk_bf16_f32 v249, v58, v59
    v_mfma_f32_16x16x32_bf16 a[12:15], v[24:27], v[164:167], a[12:15]
    ds_read_b64_tr_b16 v[46:47], v21 offset:12288
    v_cvt_pk_bf16_f32 v250, v60, v61
    v_cvt_pk_bf16_f32 v251, v62, v63
    v_mfma_f32_16x16x32_bf16 a[16:19], v[24:27], v[168:171], a[16:19]
    ds_read_b64_tr_b16 v[48:49], v22 offset:8192
    buffer_store_dwordx4 v[248:251], v64, s[24:27], s43 offen sc1
    ds_read_b128 v[232:235], v65 offset:2048
    s_waitcnt lgkmcnt(12)
    v_mfma_f32_16x16x32_bf16 a[20:23], v[28:31], v[152:155], a[20:23]
    ds_read_b64_tr_b16 v[50:51], v22 offset:12288
    ds_read_b128 v[236:239], v65 offset:7168
    v_accvgpr_read_b32 v56, a124
    v_mfma_f32_16x16x32_bf16 a[24:27], v[28:31], v[156:159], a[24:27]
    ds_read_b64_tr_b16 v[52:53], v23 offset:8192
    v_accvgpr_read_b32 v57, a125
    v_mfma_f32_16x16x32_bf16 a[28:31], v[28:31], v[160:163], a[28:31]
    ds_read_b64_tr_b16 v[54:55], v23 offset:12288
    v_accvgpr_read_b32 v58, a126
    v_accvgpr_read_b32 v59, a127
    v_mfma_f32_16x16x32_bf16 a[32:35], v[28:31], v[164:167], a[32:35]
    v_accvgpr_read_b32 v60, a144
    v_accvgpr_read_b32 v61, a145
    v_mfma_f32_16x16x32_bf16 a[36:39], v[28:31], v[168:171], a[36:39]
    v_accvgpr_read_b32 v62, a146
    v_accvgpr_read_b32 v63, a147
    s_waitcnt lgkmcnt(12)
    v_mfma_f32_16x16x32_bf16 a[40:43], v[32:35], v[152:155], a[40:43]
    v_accvgpr_read_b32 v248, a109
    v_mul_f32 v56, v56, v12
    v_mfma_f32_16x16x32_bf16 a[44:47], v[32:35], v[156:159], a[44:47]
    v_mul_f32 v57, v57, v12
    v_mul_f32 v58, v58, v12
    v_mfma_f32_16x16x32_bf16 a[48:51], v[32:35], v[160:163], a[48:51]
    v_mul_f32 v59, v59, v12
    v_mfma_f32_16x16x32_bf16 a[52:55], v[32:35], v[164:167], a[52:55]
    v_mul_f32 v60, v60, v12
    v_mul_f32 v61, v61, v12
    v_mfma_f32_16x16x32_bf16 a[56:59], v[32:35], v[168:171], a[56:59]
    v_mul_f32 v62, v62, v12
    v_mul_f32 v63, v63, v12
    s_waitcnt lgkmcnt(10)
    v_mfma_f32_16x16x32_bf16 a[60:63], v[36:39], v[152:155], a[60:63]
    v_fma_f32 v56, v240, v248, v56
    v_fma_f32 v57, v241, v248, v57
    v_mfma_f32_16x16x32_bf16 a[64:67], v[36:39], v[156:159], a[64:67]
    v_fma_f32 v58, v242, v248, v58
    v_fma_f32 v59, v243, v248, v59
    v_mfma_f32_16x16x32_bf16 a[68:71], v[36:39], v[160:163], a[68:71]
    v_fma_f32 v60, v244, v248, v60
    v_fma_f32 v61, v245, v248, v61
    v_mfma_f32_16x16x32_bf16 a[72:75], v[36:39], v[164:167], a[72:75]
    v_fma_f32 v62, v246, v248, v62
    v_mfma_f32_16x16x32_bf16 a[76:79], v[36:39], v[168:171], a[76:79]
    s_waitcnt lgkmcnt(0)
    s_waitcnt vmcnt(12)
    s_waitcnt vmcnt(7)
    s_barrier
    v_mov_b32 v17, 1
    buffer_store_dword v17, v2, s[4:7], 0 offen sc1
    v_mfma_f32_16x16x32_bf16 a[0:3], v[40:43], v[172:175], a[0:3]
    v_add_u32 v20, 0x4000, v20
    v_add_u32 v21, 0x4000, v21
    v_mfma_f32_16x16x32_bf16 a[4:7], v[40:43], v[176:179], a[4:7]
    v_add_u32 v22, 0x4000, v22
    v_fma_f32 v63, v247, v248, v63
    v_cvt_pk_bf16_f32 v252, v56, v57
    v_mfma_f32_16x16x32_bf16 a[8:11], v[40:43], v[180:183], a[8:11]
    v_add_u32 v23, 0x4000, v23
    v_cvt_pk_bf16_f32 v253, v58, v59
    v_cvt_pk_bf16_f32 v254, v60, v61
    s_add_u32 s78, s68, 0
    s_add_u32 m0, s76, 122880
    s_nop 0
    buffer_load_dwordx4 v8, s[48:51], s78 offen sc1 lds
    v_mfma_f32_16x16x32_bf16 a[12:15], v[40:43], v[184:187], a[12:15]
    ds_read_b64_tr_b16 v[24:25], v20
    ds_read_b64_tr_b16 v[26:27], v20 offset:4096
    v_cvt_pk_bf16_f32 v255, v62, v63
    buffer_store_dwordx4 v[252:255], v64, s[24:27], s43 offen offset:1024 sc1
    v_mfma_f32_16x16x32_bf16 a[16:19], v[40:43], v[188:191], a[16:19]
    ds_read_b64_tr_b16 v[28:29], v21
    ds_read_b128 v[240:243], v65 offset:3072
    ds_read_b128 v[244:247], v65 offset:8192
    v_mfma_f32_16x16x32_bf16 a[20:23], v[44:47], v[172:175], a[20:23]
    ds_read_b64_tr_b16 v[30:31], v21 offset:4096
    v_accvgpr_read_b32 v56, a128
    v_accvgpr_read_b32 v57, a129
    v_mfma_f32_16x16x32_bf16 a[24:27], v[44:47], v[176:179], a[24:27]
    ds_read_b64_tr_b16 v[32:33], v22
    ds_read_b64_tr_b16 v[34:35], v22 offset:4096
    v_accvgpr_read_b32 v58, a130
    v_mfma_f32_16x16x32_bf16 a[28:31], v[44:47], v[180:183], a[28:31]
    ds_read_b64_tr_b16 v[36:37], v23
    v_accvgpr_read_b32 v59, a131
    v_accvgpr_read_b32 v60, a148
    buffer_load_dwordx4 v8, s[48:51], s78 offen offset:1024 sc1 lds
    v_mfma_f32_16x16x32_bf16 a[32:35], v[44:47], v[184:187], a[32:35]
    ds_read_b64_tr_b16 v[38:39], v23 offset:4096
    v_accvgpr_read_b32 v61, a149
    v_accvgpr_read_b32 v62, a150
    v_mfma_f32_16x16x32_bf16 a[36:39], v[44:47], v[188:191], a[36:39]
    v_accvgpr_read_b32 v63, a151
    v_accvgpr_read_b32 v252, a110
    v_mfma_f32_16x16x32_bf16 a[40:43], v[48:51], v[172:175], a[40:43]
    v_mul_f32 v56, v56, v13
    v_mul_f32 v57, v57, v13
    v_mfma_f32_16x16x32_bf16 a[44:47], v[48:51], v[176:179], a[44:47]
    v_mul_f32 v58, v58, v13
    v_mul_f32 v59, v59, v13
    v_mfma_f32_16x16x32_bf16 a[48:51], v[48:51], v[180:183], a[48:51]
    v_mul_f32 v60, v60, v13
    buffer_load_dwordx4 v8, s[48:51], s78 offen offset:2048 sc1 lds
    v_mfma_f32_16x16x32_bf16 a[52:55], v[48:51], v[184:187], a[52:55]
    v_mul_f32 v61, v61, v13
    v_mul_f32 v62, v62, v13
    v_mfma_f32_16x16x32_bf16 a[56:59], v[48:51], v[188:191], a[56:59]
    v_mul_f32 v63, v63, v13
    v_fma_f32 v56, v232, v252, v56
    v_mfma_f32_16x16x32_bf16 a[60:63], v[52:55], v[172:175], a[60:63]
    v_fma_f32 v57, v233, v252, v57
    v_fma_f32 v58, v234, v252, v58
    v_mfma_f32_16x16x32_bf16 a[64:67], v[52:55], v[176:179], a[64:67]
    v_fma_f32 v59, v235, v252, v59
    v_fma_f32 v60, v236, v252, v60
    v_mfma_f32_16x16x32_bf16 a[68:71], v[52:55], v[180:183], a[68:71]
    v_fma_f32 v61, v237, v252, v61
    v_fma_f32 v62, v238, v252, v62
    v_mfma_f32_16x16x32_bf16 a[72:75], v[52:55], v[184:187], a[72:75]
    v_fma_f32 v63, v239, v252, v63
    v_mfma_f32_16x16x32_bf16 a[76:79], v[52:55], v[188:191], a[76:79]
    s_waitcnt lgkmcnt(8)
    v_mfma_f32_16x16x32_bf16 a[0:3], v[24:27], v[192:195], a[0:3]
    ds_read_b64_tr_b16 v[40:41], v20 offset:8192
    v_mfma_f32_16x16x32_bf16 a[4:7], v[24:27], v[196:199], a[4:7]
    ds_read_b64_tr_b16 v[42:43], v20 offset:12288
    v_cvt_pk_bf16_f32 v248, v56, v57
    v_cvt_pk_bf16_f32 v249, v58, v59
    v_mfma_f32_16x16x32_bf16 a[8:11], v[24:27], v[200:203], a[8:11]
    ds_read_b64_tr_b16 v[44:45], v21 offset:8192
    v_cvt_pk_bf16_f32 v250, v60, v61
    v_cvt_pk_bf16_f32 v251, v62, v63
    buffer_load_dwordx4 v8, s[48:51], s78 offen offset:3072 sc1 lds
    v_mfma_f32_16x16x32_bf16 a[12:15], v[24:27], v[204:207], a[12:15]
    ds_read_b64_tr_b16 v[46:47], v21 offset:12288
    buffer_store_dwordx4 v[248:251], v64, s[24:27], s43 offen offset:2048 sc1
    ds_read_b128 v[232:235], v65 offset:4096
    v_mfma_f32_16x16x32_bf16 a[16:19], v[24:27], v[208:211], a[16:19]
    ds_read_b64_tr_b16 v[48:49], v22 offset:8192
    ds_read_b128 v[236:239], v65 offset:9216
    v_accvgpr_read_b32 v56, a132
    s_waitcnt lgkmcnt(11)
    v_mfma_f32_16x16x32_bf16 a[20:23], v[28:31], v[192:195], a[20:23]
    ds_read_b64_tr_b16 v[50:51], v22 offset:12288
    v_accvgpr_read_b32 v57, a133
    v_accvgpr_read_b32 v58, a134
    v_mfma_f32_16x16x32_bf16 a[24:27], v[28:31], v[196:199], a[24:27]
    ds_read_b64_tr_b16 v[52:53], v23 offset:8192
    v_accvgpr_read_b32 v59, a135
    v_mfma_f32_16x16x32_bf16 a[28:31], v[28:31], v[200:203], a[28:31]
    ds_read_b64_tr_b16 v[54:55], v23 offset:12288
    v_accvgpr_read_b32 v60, a152
    v_accvgpr_read_b32 v61, a153
    s_add_u32 m0, s76, 126976
    s_nop 0
    buffer_load_dwordx4 v9, s[48:51], s78 offen sc1 lds
    v_mfma_f32_16x16x32_bf16 a[32:35], v[28:31], v[204:207], a[32:35]
    v_accvgpr_read_b32 v62, a154
    v_accvgpr_read_b32 v63, a155
    v_mfma_f32_16x16x32_bf16 a[36:39], v[28:31], v[208:211], a[36:39]
    v_accvgpr_read_b32 v248, a111
    v_mul_f32 v56, v56, v14
    s_waitcnt lgkmcnt(12)
    v_mfma_f32_16x16x32_bf16 a[40:43], v[32:35], v[192:195], a[40:43]
    v_mul_f32 v57, v57, v14
    v_mul_f32 v58, v58, v14
    v_mfma_f32_16x16x32_bf16 a[44:47], v[32:35], v[196:199], a[44:47]
    v_mul_f32 v59, v59, v14
    v_mul_f32 v60, v60, v14
    v_mfma_f32_16x16x32_bf16 a[48:51], v[32:35], v[200:203], a[48:51]
    v_mul_f32 v61, v61, v14
    v_mfma_f32_16x16x32_bf16 a[52:55], v[32:35], v[204:207], a[52:55]
    v_mul_f32 v62, v62, v14
    v_mul_f32 v63, v63, v14
    v_mfma_f32_16x16x32_bf16 a[56:59], v[32:35], v[208:211], a[56:59]
    v_fma_f32 v56, v240, v248, v56
    v_fma_f32 v57, v241, v248, v57
    s_waitcnt lgkmcnt(10)
    v_mfma_f32_16x16x32_bf16 a[60:63], v[36:39], v[192:195], a[60:63]
    v_fma_f32 v58, v242, v248, v58
    v_fma_f32 v59, v243, v248, v59
    v_mfma_f32_16x16x32_bf16 a[64:67], v[36:39], v[196:199], a[64:67]
    v_fma_f32 v60, v244, v248, v60
    v_fma_f32 v61, v245, v248, v61
    v_mfma_f32_16x16x32_bf16 a[68:71], v[36:39], v[200:203], a[68:71]
    v_fma_f32 v62, v246, v248, v62
    v_fma_f32 v63, v247, v248, v63
    v_mfma_f32_16x16x32_bf16 a[72:75], v[36:39], v[204:207], a[72:75]
    v_cvt_pk_bf16_f32 v252, v56, v57
    v_mfma_f32_16x16x32_bf16 a[76:79], v[36:39], v[208:211], a[76:79]
    s_waitcnt lgkmcnt(2)
    v_mfma_f32_16x16x32_bf16 a[40:43], v[48:51], v[212:215], a[40:43]
    v_cvt_pk_bf16_f32 v253, v58, v59
    v_cvt_pk_bf16_f32 v254, v60, v61
    v_mfma_f32_16x16x32_bf16 a[44:47], v[48:51], v[216:219], a[44:47]
    v_cvt_pk_bf16_f32 v255, v62, v63
    buffer_store_dwordx4 v[252:255], v64, s[24:27], s43 offen offset:3072 sc1
    v_mfma_f32_16x16x32_bf16 a[48:51], v[48:51], v[220:223], a[48:51]
    v_accvgpr_read_b32 v56, a136
    v_accvgpr_read_b32 v57, a137
    v_mfma_f32_16x16x32_bf16 a[52:55], v[48:51], v[224:227], a[52:55]
    v_accvgpr_read_b32 v58, a138
    v_mfma_f32_16x16x32_bf16 a[56:59], v[48:51], v[228:231], a[56:59]
    v_accvgpr_read_b32 v59, a139
    v_accvgpr_read_b32 v60, a156
    s_waitcnt lgkmcnt(0)
    v_mfma_f32_16x16x32_bf16 a[60:63], v[52:55], v[212:215], a[60:63]
    v_accvgpr_read_b32 v61, a157
    v_accvgpr_read_b32 v62, a158
    v_mfma_f32_16x16x32_bf16 a[64:67], v[52:55], v[216:219], a[64:67]
    v_accvgpr_read_b32 v63, a159
    v_mfma_f32_16x16x32_bf16 a[68:71], v[52:55], v[220:223], a[68:71]
    v_accvgpr_read_b32 v252, a112
    v_mul_f32 v56, v56, v15
    v_mfma_f32_16x16x32_bf16 a[72:75], v[52:55], v[224:227], a[72:75]
    v_mul_f32 v57, v57, v15
    v_mul_f32 v58, v58, v15
    v_mfma_f32_16x16x32_bf16 a[76:79], v[52:55], v[228:231], a[76:79]
    v_mul_f32 v59, v59, v15
    v_mfma_f32_16x16x32_bf16 a[0:3], v[40:43], v[212:215], a[0:3]
    v_mul_f32 v60, v60, v15
    v_mul_f32 v61, v61, v15
    v_mfma_f32_16x16x32_bf16 a[4:7], v[40:43], v[216:219], a[4:7]
    v_mul_f32 v62, v62, v15
    v_mul_f32 v63, v63, v15
    v_mfma_f32_16x16x32_bf16 a[8:11], v[40:43], v[220:223], a[8:11]
    v_fma_f32 v56, v232, v252, v56
    v_fma_f32 v57, v233, v252, v57
    v_mfma_f32_16x16x32_bf16 a[12:15], v[40:43], v[224:227], a[12:15]
    v_fma_f32 v58, v234, v252, v58
    v_mfma_f32_16x16x32_bf16 a[16:19], v[40:43], v[228:231], a[16:19]
    v_fma_f32 v59, v235, v252, v59
    v_fma_f32 v60, v236, v252, v60
    v_mfma_f32_16x16x32_bf16 a[20:23], v[44:47], v[212:215], a[20:23]
    v_fma_f32 v61, v237, v252, v61
    v_fma_f32 v62, v238, v252, v62
    v_mfma_f32_16x16x32_bf16 a[24:27], v[44:47], v[216:219], a[24:27]
    v_fma_f32 v63, v239, v252, v63
    v_mfma_f32_16x16x32_bf16 a[28:31], v[44:47], v[220:223], a[28:31]
    v_cvt_pk_bf16_f32 v248, v56, v57
    v_cvt_pk_bf16_f32 v249, v58, v59
    v_mfma_f32_16x16x32_bf16 a[32:35], v[44:47], v[224:227], a[32:35]
    v_cvt_pk_bf16_f32 v250, v60, v61
    v_cvt_pk_bf16_f32 v251, v62, v63
    v_mfma_f32_16x16x32_bf16 a[36:39], v[44:47], v[228:231], a[36:39]
    buffer_store_dwordx4 v[248:251], v18, s[24:27], s43 offen sc1
    s_mov_b32 s1, 7680
    buffer_load_dword a105, v10, s[8:11], s1 offen
    s_mov_b32 s1, 15360
    buffer_load_dword a106, v10, s[8:11], s1 offen
    s_mov_b32 s1, 23040
    buffer_load_dword a107, v10, s[8:11], s1 offen
    s_barrier
    v_lshlrev_b32 v64, 4, v0
    s_mul_i32 s33, s28, 10240
    s_add_u32 s77, s65, 0
    s_add_u32 m0, s75, 81920
    s_nop 0
    buffer_load_dwordx4 v1, s[44:47], s77 offen lds
    v_add_u32 v65, s33, v64
    ds_write_b128 v65, a[40:43]
    ds_write_b128 v65, a[44:47] offset:1024
    buffer_load_dwordx4 v3, s[44:47], s77 offen offset:1024 lds
    ds_write_b128 v65, a[48:51] offset:2048
    ds_write_b128 v65, a[52:55] offset:3072
    ds_write_b128 v65, a[56:59] offset:4096
    buffer_load_dwordx4 v4, s[44:47], s77 offen offset:2048 lds
    ds_write_b128 v65, a[60:63] offset:5120
    ds_write_b128 v65, a[64:67] offset:6144
    ds_write_b128 v65, a[68:71] offset:7168
    buffer_load_dwordx4 v6, s[44:47], s77 offen offset:3072 lds
    ds_write_b128 v65, a[72:75] offset:8192
    ds_write_b128 v65, a[76:79] offset:9216
    s_xor_b32 s3, s28, 2
    s_add_u32 m0, s75, 86016
    s_nop 0
    buffer_load_dwordx4 v7, s[44:47], s77 offen lds
    s_mul_i32 s33, s3, 10240
    v_add_u32 v65, s33, v64
    s_waitcnt lgkmcnt(0)
    s_barrier
    s_lshl_b32 s79, s31, 5
    s_add_u32 s79, s79, s72
    s_lshl_b32 s79, s79, 7
    v_lshlrev_b32 v19, 10, v0
    v_add_u32 v19, s79, v19
    buffer_load_dword v16, v19, s[4:7], 0 offen sc1
    s_mul_i32 s33, s30, 10240
    s_mul_i32 s3, s29, 5120
    s_add_u32 s33, s33, s3
    v_add_u32 v64, s33, v64
    s_mov_b32 s43, 40960
    v_add_u32 v18, 4096, v64
    ds_read_b128 v[232:235], v65
    ds_read_b128 v[236:239], v65 offset:5120
    ds_read_b128 v[240:243], v65 offset:1024
    ds_read_b128 v[244:247], v65 offset:6144
    v_accvgpr_read_b32 v56, a0
    v_accvgpr_read_b32 v57, a1
    v_accvgpr_read_b32 v58, a2
    v_accvgpr_read_b32 v59, a3
    v_accvgpr_read_b32 v60, a20
    v_accvgpr_read_b32 v61, a21
    v_accvgpr_read_b32 v62, a22
    v_accvgpr_read_b32 v63, a23
    v_accvgpr_read_b32 v252, a108
    v_mul_f32 v56, v56, v11
    v_mul_f32 v57, v57, v11
    v_mul_f32 v58, v58, v11
    v_mul_f32 v59, v59, v11
    v_mul_f32 v60, v60, v11
    v_mul_f32 v61, v61, v11
    v_mul_f32 v62, v62, v11
    v_mul_f32 v63, v63, v11
    s_waitcnt lgkmcnt(3)
    v_fma_f32 v56, v232, v252, v56
    v_fma_f32 v57, v233, v252, v57
    v_fma_f32 v58, v234, v252, v58
    v_fma_f32 v59, v235, v252, v59
    s_waitcnt lgkmcnt(2)
    v_fma_f32 v60, v236, v252, v60
    v_fma_f32 v61, v237, v252, v61
    v_fma_f32 v62, v238, v252, v62
    v_fma_f32 v63, v239, v252, v63
    v_cvt_pk_bf16_f32 v248, v56, v57
    v_cvt_pk_bf16_f32 v249, v58, v59
    v_cvt_pk_bf16_f32 v250, v60, v61
    v_cvt_pk_bf16_f32 v251, v62, v63
    buffer_store_dwordx4 v[248:251], v64, s[24:27], s43 offen sc1
    ds_read_b128 v[232:235], v65 offset:2048
    ds_read_b128 v[236:239], v65 offset:7168
    v_accvgpr_read_b32 v56, a4
    v_accvgpr_read_b32 v57, a5
    v_accvgpr_read_b32 v58, a6
    v_accvgpr_read_b32 v59, a7
    v_accvgpr_read_b32 v60, a24
    v_accvgpr_read_b32 v61, a25
    v_accvgpr_read_b32 v62, a26
    v_accvgpr_read_b32 v63, a27
    v_accvgpr_read_b32 v248, a109
    v_mul_f32 v56, v56, v12
    v_mul_f32 v57, v57, v12
    v_mul_f32 v58, v58, v12
    v_mul_f32 v59, v59, v12
    v_mul_f32 v60, v60, v12
    v_mul_f32 v61, v61, v12
    v_mul_f32 v62, v62, v12
    v_mul_f32 v63, v63, v12
    s_waitcnt lgkmcnt(3)
    v_fma_f32 v56, v240, v248, v56
    v_fma_f32 v57, v241, v248, v57
    v_fma_f32 v58, v242, v248, v58
    v_fma_f32 v59, v243, v248, v59
    s_waitcnt lgkmcnt(2)
    v_fma_f32 v60, v244, v248, v60
    v_fma_f32 v61, v245, v248, v61
    v_fma_f32 v62, v246, v248, v62
    v_fma_f32 v63, v247, v248, v63
    v_cvt_pk_bf16_f32 v252, v56, v57
    v_cvt_pk_bf16_f32 v253, v58, v59
    v_cvt_pk_bf16_f32 v254, v60, v61
    v_cvt_pk_bf16_f32 v255, v62, v63
    buffer_store_dwordx4 v[252:255], v64, s[24:27], s43 offen offset:1024 sc1
    ds_read_b128 v[240:243], v65 offset:3072
    ds_read_b128 v[244:247], v65 offset:8192
    v_accvgpr_read_b32 v56, a8
    v_accvgpr_read_b32 v57, a9
    v_accvgpr_read_b32 v58, a10
    v_accvgpr_read_b32 v59, a11
    v_accvgpr_read_b32 v60, a28
    v_accvgpr_read_b32 v61, a29
    v_accvgpr_read_b32 v62, a30
    v_accvgpr_read_b32 v63, a31
    v_accvgpr_read_b32 v252, a110
    s_waitcnt vmcnt(2)
    v_cmp_le_u32 vcc, 1, v16
    s_nop 3
    s_and_b32 s79, vcc_lo, 15
    s_cmp_eq_u32 s79, 15
    s_cbranch_scc0 SLOW_P1
BACK_P1:
    v_mul_f32 v56, v56, v13
    v_mul_f32 v57, v57, v13
    v_mul_f32 v58, v58, v13
    v_mul_f32 v59, v59, v13
    s_add_u32 s78, s69, 0
    s_add_u32 m0, s76, 81920
    s_nop 0
    buffer_load_dwordx4 v8, s[48:51], s78 offen sc1 lds
    v_mul_f32 v60, v60, v13
    v_mul_f32 v61, v61, v13
    v_mul_f32 v62, v62, v13
    v_mul_f32 v63, v63, v13
    s_waitcnt lgkmcnt(3)
    v_fma_f32 v56, v232, v252, v56
    v_fma_f32 v57, v233, v252, v57
    v_fma_f32 v58, v234, v252, v58
    v_fma_f32 v59, v235, v252, v59
    buffer_load_dwordx4 v8, s[48:51], s78 offen offset:1024 sc1 lds
    s_waitcnt lgkmcnt(2)
    v_fma_f32 v60, v236, v252, v60
    v_fma_f32 v61, v237, v252, v61
    v_fma_f32 v62, v238, v252, v62
    v_fma_f32 v63, v239, v252, v63
    v_cvt_pk_bf16_f32 v248, v56, v57
    v_cvt_pk_bf16_f32 v249, v58, v59
    v_cvt_pk_bf16_f32 v250, v60, v61
    v_cvt_pk_bf16_f32 v251, v62, v63
    buffer_store_dwordx4 v[248:251], v64, s[24:27], s43 offen offset:2048 sc1
    buffer_load_dwordx4 v8, s[48:51], s78 offen offset:2048 sc1 lds
    ds_read_b128 v[232:235], v65 offset:4096
    ds_read_b128 v[236:239], v65 offset:9216
    v_accvgpr_read_b32 v56, a12
    v_accvgpr_read_b32 v57, a13
    v_accvgpr_read_b32 v58, a14
    v_accvgpr_read_b32 v59, a15
    v_accvgpr_read_b32 v60, a32
    v_accvgpr_read_b32 v61, a33
    buffer_load_dwordx4 v8, s[48:51], s78 offen offset:3072 sc1 lds
    v_accvgpr_read_b32 v62, a34
    v_accvgpr_read_b32 v63, a35
    v_accvgpr_read_b32 v248, a111
    v_mul_f32 v56, v56, v14
    v_mul_f32 v57, v57, v14
    v_mul_f32 v58, v58, v14
    v_mul_f32 v59, v59, v14
    v_mul_f32 v60, v60, v14
    s_add_u32 m0, s76, 86016
    s_nop 0
    buffer_load_dwordx4 v9, s[48:51], s78 offen sc1 lds
    v_mul_f32 v61, v61, v14
    v_mul_f32 v62, v62, v14
    v_mul_f32 v63, v63, v14
    s_waitcnt lgkmcnt(3)
    v_fma_f32 v56, v240, v248, v56
    v_fma_f32 v57, v241, v248, v57
    v_fma_f32 v58, v242, v248, v58
    v_fma_f32 v59, v243, v248, v59
    s_waitcnt lgkmcnt(2)
    v_fma_f32 v60, v244, v248, v60
    v_fma_f32 v61, v245, v248, v61
    s_add_u32 s77, s66, 0
    s_add_u32 m0, s75, 40960
    s_nop 0
    buffer_load_dwordx4 v1, s[44:47], s77 offen lds
    v_fma_f32 v62, v246, v248, v62
    v_fma_f32 v63, v247, v248, v63
    v_cvt_pk_bf16_f32 v252, v56, v57
    v_cvt_pk_bf16_f32 v253, v58, v59
    v_cvt_pk_bf16_f32 v254, v60, v61
    v_cvt_pk_bf16_f32 v255, v62, v63
    buffer_store_dwordx4 v[252:255], v64, s[24:27], s43 offen offset:3072 sc1
    v_accvgpr_read_b32 v56, a16
    buffer_load_dwordx4 v3, s[44:47], s77 offen offset:1024 lds
    v_accvgpr_read_b32 v57, a17
    v_accvgpr_read_b32 v58, a18
    v_accvgpr_read_b32 v59, a19
    v_accvgpr_read_b32 v60, a36
    v_accvgpr_read_b32 v61, a37
    v_accvgpr_read_b32 v62, a38
    v_accvgpr_read_b32 v63, a39
    v_accvgpr_read_b32 v252, a112
    buffer_load_dwordx4 v4, s[44:47], s77 offen offset:2048 lds
    v_mul_f32 v56, v56, v15
    v_mul_f32 v57, v57, v15
    v_mul_f32 v58, v58, v15
    v_mul_f32 v59, v59, v15
    v_mul_f32 v60, v60, v15
    v_mul_f32 v61, v61, v15
    v_mul_f32 v62, v62, v15
    v_mul_f32 v63, v63, v15
    s_waitcnt lgkmcnt(1)
    v_fma_f32 v56, v232, v252, v56
    buffer_load_dwordx4 v6, s[44:47], s77 offen offset:3072 lds
    v_fma_f32 v57, v233, v252, v57
    v_fma_f32 v58, v234, v252, v58
    v_fma_f32 v59, v235, v252, v59
    s_waitcnt lgkmcnt(0)
    v_fma_f32 v60, v236, v252, v60
    v_fma_f32 v61, v237, v252, v61
    v_fma_f32 v62, v238, v252, v62
    v_fma_f32 v63, v239, v252, v63
    v_cvt_pk_bf16_f32 v248, v56, v57
    s_add_u32 m0, s75, 45056
    s_nop 0
    buffer_load_dwordx4 v7, s[44:47], s77 offen lds
    v_cvt_pk_bf16_f32 v249, v58, v59
    v_cvt_pk_bf16_f32 v250, v60, v61
    v_cvt_pk_bf16_f32 v251, v62, v63
    buffer_store_dwordx4 v[248:251], v18, s[24:27], s43 offen sc1
    s_barrier
    v_add_u32 v24, 122880, v66
    v_add_u32 v25, 122880, v67
    v_add_u32 v26, 122880, v68
    v_add_u32 v27, 122880, v69
    v_add_u32 v28, 122880, v70
    v_add_u32 v29, 122880, v71
    ds_read_b64_tr_b16 a[120:121], v24
    ds_read_b64_tr_b16 a[122:123], v24 offset:5120
    ds_read_b128 a[140:143], v29
    ds_read_b64_tr_b16 a[124:125], v25
    ds_read_b64_tr_b16 a[126:127], v25 offset:5120
    ds_read_b128 a[144:147], v29 offset:1024
    ds_read_b64_tr_b16 a[128:129], v26
    ds_read_b64_tr_b16 a[130:131], v26 offset:5120
    ds_read_b128 a[148:151], v29 offset:2048
    ds_read_b64_tr_b16 a[132:133], v27
    ds_read_b64_tr_b16 a[134:135], v27 offset:5120
    ds_read_b128 a[152:155], v29 offset:3072
    ds_read_b64_tr_b16 a[136:137], v28
    ds_read_b64_tr_b16 a[138:139], v28 offset:5120
    ds_read_b128 a[156:159], v29 offset:4096
    s_waitcnt lgkmcnt(12)
    v_mfma_f32_16x16x32_bf16 v[72:75], a[120:123], a[140:143], 0
    ds_read_b64_tr_b16 a[160:161], v24 offset:10240
    s_waitcnt lgkmcnt(10)
    v_mfma_f32_16x16x32_bf16 v[76:79], a[120:123], a[144:147], 0
    ds_read_b64_tr_b16 a[162:163], v24 offset:15360
    s_waitcnt lgkmcnt(8)
    v_mfma_f32_16x16x32_bf16 v[80:83], a[120:123], a[148:151], 0
    s_add_u32 s78, s70, 0
    s_add_u32 m0, s76, 40960
    s_nop 0
    buffer_load_dwordx4 v8, s[48:51], s78 offen sc1 lds
    s_waitcnt lgkmcnt(5)
    v_mfma_f32_16x16x32_bf16 v[84:87], a[120:123], a[152:155], 0
    ds_read_b128 a[180:183], v29 offset:10240
    s_waitcnt lgkmcnt(3)
    v_mfma_f32_16x16x32_bf16 v[88:91], a[120:123], a[156:159], 0
    ds_read_b64_tr_b16 a[164:165], v25 offset:10240
    v_mfma_f32_16x16x32_bf16 v[92:95], a[124:127], a[140:143], 0
    ds_read_b64_tr_b16 a[166:167], v25 offset:15360
    v_mfma_f32_16x16x32_bf16 v[96:99], a[124:127], a[144:147], 0
    buffer_load_dwordx4 v8, s[48:51], s78 offen offset:1024 sc1 lds
    v_mfma_f32_16x16x32_bf16 v[100:103], a[124:127], a[148:151], 0
    ds_read_b128 a[184:187], v29 offset:11264
    v_mfma_f32_16x16x32_bf16 v[104:107], a[124:127], a[152:155], 0
    ds_read_b64_tr_b16 a[168:169], v26 offset:10240
    v_mfma_f32_16x16x32_bf16 v[108:111], a[124:127], a[156:159], 0
    ds_read_b64_tr_b16 a[170:171], v26 offset:15360
    v_mfma_f32_16x16x32_bf16 v[112:115], a[128:131], a[140:143], 0
    buffer_load_dwordx4 v8, s[48:51], s78 offen offset:2048 sc1 lds
    v_mfma_f32_16x16x32_bf16 v[116:119], a[128:131], a[144:147], 0
    ds_read_b128 a[188:191], v29 offset:12288
    v_mfma_f32_16x16x32_bf16 v[120:123], a[128:131], a[148:151], 0
    ds_read_b64_tr_b16 a[172:173], v27 offset:10240
    v_mfma_f32_16x16x32_bf16 v[124:127], a[128:131], a[152:155], 0
    ds_read_b64_tr_b16 a[174:175], v27 offset:15360
    v_mfma_f32_16x16x32_bf16 v[128:131], a[128:131], a[156:159], 0
    buffer_load_dwordx4 v8, s[48:51], s78 offen offset:3072 sc1 lds
    v_mfma_f32_16x16x32_bf16 v[132:135], a[132:135], a[140:143], 0
    ds_read_b128 a[192:195], v29 offset:13312
    v_mfma_f32_16x16x32_bf16 v[136:139], a[132:135], a[144:147], 0
    ds_read_b64_tr_b16 a[176:177], v28 offset:10240
    v_mfma_f32_16x16x32_bf16 v[140:143], a[132:135], a[148:151], 0
    ds_read_b64_tr_b16 a[178:179], v28 offset:15360
    v_mfma_f32_16x16x32_bf16 v[144:147], a[132:135], a[152:155], 0
    s_add_u32 m0, s76, 45056
    s_nop 0
    buffer_load_dwordx4 v9, s[48:51], s78 offen sc1 lds
    v_mfma_f32_16x16x32_bf16 v[148:151], a[132:135], a[156:159], 0
    ds_read_b128 a[196:199], v29 offset:14336
    v_mfma_f32_16x16x32_bf16 v[152:155], a[136:139], a[140:143], 0
    v_mfma_f32_16x16x32_bf16 v[156:159], a[136:139], a[144:147], 0
    v_mfma_f32_16x16x32_bf16 v[160:163], a[136:139], a[148:151], 0
    v_mfma_f32_16x16x32_bf16 v[164:167], a[136:139], a[152:155], 0
    v_mfma_f32_16x16x32_bf16 v[168:171], a[136:139], a[156:159], 0
    s_waitcnt lgkmcnt(0)
    s_waitcnt vmcnt(12)
    s_barrier
    v_mfma_f32_16x16x32_bf16 v[72:75], a[160:163], a[180:183], v[72:75]
    v_add_u32 v24, 81920, v66
    v_add_u32 v25, 81920, v67
    v_mfma_f32_16x16x32_bf16 v[76:79], a[160:163], a[184:187], v[76:79]
    s_add_u32 s77, s67, 0
    s_add_u32 m0, s75, 0
    s_nop 0
    buffer_load_dwordx4 v1, s[44:47], s77 offen lds
    v_mfma_f32_16x16x32_bf16 v[80:83], a[160:163], a[188:191], v[80:83]
    v_add_u32 v26, 81920, v68
    v_mfma_f32_16x16x32_bf16 v[84:87], a[160:163], a[192:195], v[84:87]
    v_add_u32 v27, 81920, v69
    v_mfma_f32_16x16x32_bf16 v[88:91], a[160:163], a[196:199], v[88:91]
    v_add_u32 v28, 81920, v70
    v_mfma_f32_16x16x32_bf16 v[92:95], a[164:167], a[180:183], v[92:95]
    v_add_u32 v29, 81920, v71
    buffer_load_dwordx4 v3, s[44:47], s77 offen offset:1024 lds
    v_mfma_f32_16x16x32_bf16 v[96:99], a[164:167], a[184:187], v[96:99]
    ds_read_b64_tr_b16 a[120:121], v24
    v_mfma_f32_16x16x32_bf16 v[100:103], a[164:167], a[188:191], v[100:103]
    ds_read_b64_tr_b16 a[122:123], v24 offset:5120
    v_mfma_f32_16x16x32_bf16 v[104:107], a[164:167], a[192:195], v[104:107]
    ds_read_b128 a[140:143], v29
    v_mfma_f32_16x16x32_bf16 v[108:111], a[164:167], a[196:199], v[108:111]
    ds_read_b64_tr_b16 a[124:125], v25
    v_mfma_f32_16x16x32_bf16 v[112:115], a[168:171], a[180:183], v[112:115]
    ds_read_b64_tr_b16 a[126:127], v25 offset:5120
    v_mfma_f32_16x16x32_bf16 v[116:119], a[168:171], a[184:187], v[116:119]
    buffer_load_dwordx4 v4, s[44:47], s77 offen offset:2048 lds
    ds_read_b128 a[144:147], v29 offset:1024
    v_mfma_f32_16x16x32_bf16 v[120:123], a[168:171], a[188:191], v[120:123]
    ds_read_b64_tr_b16 a[128:129], v26
    v_mfma_f32_16x16x32_bf16 v[124:127], a[168:171], a[192:195], v[124:127]
    ds_read_b64_tr_b16 a[130:131], v26 offset:5120
    v_mfma_f32_16x16x32_bf16 v[128:131], a[168:171], a[196:199], v[128:131]
    ds_read_b128 a[148:151], v29 offset:2048
    v_mfma_f32_16x16x32_bf16 v[132:135], a[172:175], a[180:183], v[132:135]
    buffer_load_dwordx4 v6, s[44:47], s77 offen offset:3072 lds
    v_mfma_f32_16x16x32_bf16 v[136:139], a[172:175], a[184:187], v[136:139]
    ds_read_b64_tr_b16 a[132:133], v27
    ds_read_b64_tr_b16 a[134:135], v27 offset:5120
    v_mfma_f32_16x16x32_bf16 v[140:143], a[172:175], a[188:191], v[140:143]
    ds_read_b128 a[152:155], v29 offset:3072
    v_mfma_f32_16x16x32_bf16 v[144:147], a[172:175], a[192:195], v[144:147]
    ds_read_b64_tr_b16 a[136:137], v28
    v_mfma_f32_16x16x32_bf16 v[148:151], a[172:175], a[196:199], v[148:151]
    s_add_u32 m0, s75, 4096
    s_nop 0
    buffer_load_dwordx4 v7, s[44:47], s77 offen lds
    v_mfma_f32_16x16x32_bf16 v[152:155], a[176:179], a[180:183], v[152:155]
    ds_read_b64_tr_b16 a[138:139], v28 offset:5120
    v_mfma_f32_16x16x32_bf16 v[156:159], a[176:179], a[184:187], v[156:159]
    ds_read_b128 a[156:159], v29 offset:4096
    v_mfma_f32_16x16x32_bf16 v[160:163], a[176:179], a[188:191], v[160:163]
    v_mfma_f32_16x16x32_bf16 v[164:167], a[176:179], a[192:195], v[164:167]
    v_mfma_f32_16x16x32_bf16 v[168:171], a[176:179], a[196:199], v[168:171]
    s_waitcnt lgkmcnt(12)
    v_mfma_f32_16x16x32_bf16 v[72:75], a[120:123], a[140:143], v[72:75]
    ds_read_b64_tr_b16 a[160:161], v24 offset:10240
    s_waitcnt lgkmcnt(10)
    v_mfma_f32_16x16x32_bf16 v[76:79], a[120:123], a[144:147], v[76:79]
    ds_read_b64_tr_b16 a[162:163], v24 offset:15360
    s_waitcnt lgkmcnt(8)
    v_mfma_f32_16x16x32_bf16 v[80:83], a[120:123], a[148:151], v[80:83]
    s_add_u32 s78, s71, 0
    s_add_u32 m0, s76, 0
    s_nop 0
    buffer_load_dwordx4 v8, s[48:51], s78 offen sc1 lds
    s_waitcnt lgkmcnt(5)
    v_mfma_f32_16x16x32_bf16 v[84:87], a[120:123], a[152:155], v[84:87]
    ds_read_b128 a[180:183], v29 offset:10240
    s_waitcnt lgkmcnt(3)
    v_mfma_f32_16x16x32_bf16 v[88:91], a[120:123], a[156:159], v[88:91]
    ds_read_b64_tr_b16 a[164:165], v25 offset:10240
    v_mfma_f32_16x16x32_bf16 v[92:95], a[124:127], a[140:143], v[92:95]
    ds_read_b64_tr_b16 a[166:167], v25 offset:15360
    v_mfma_f32_16x16x32_bf16 v[96:99], a[124:127], a[144:147], v[96:99]
    buffer_load_dwordx4 v8, s[48:51], s78 offen offset:1024 sc1 lds
    v_mfma_f32_16x16x32_bf16 v[100:103], a[124:127], a[148:151], v[100:103]
    ds_read_b128 a[184:187], v29 offset:11264
    v_mfma_f32_16x16x32_bf16 v[104:107], a[124:127], a[152:155], v[104:107]
    ds_read_b64_tr_b16 a[168:169], v26 offset:10240
    v_mfma_f32_16x16x32_bf16 v[108:111], a[124:127], a[156:159], v[108:111]
    ds_read_b64_tr_b16 a[170:171], v26 offset:15360
    v_mfma_f32_16x16x32_bf16 v[112:115], a[128:131], a[140:143], v[112:115]
    buffer_load_dwordx4 v8, s[48:51], s78 offen offset:2048 sc1 lds
    v_mfma_f32_16x16x32_bf16 v[116:119], a[128:131], a[144:147], v[116:119]
    ds_read_b128 a[188:191], v29 offset:12288
    v_mfma_f32_16x16x32_bf16 v[120:123], a[128:131], a[148:151], v[120:123]
    ds_read_b64_tr_b16 a[172:173], v27 offset:10240
    v_mfma_f32_16x16x32_bf16 v[124:127], a[128:131], a[152:155], v[124:127]
    ds_read_b64_tr_b16 a[174:175], v27 offset:15360
    v_mfma_f32_16x16x32_bf16 v[128:131], a[128:131], a[156:159], v[128:131]
    buffer_load_dwordx4 v8, s[48:51], s78 offen offset:3072 sc1 lds
    v_mfma_f32_16x16x32_bf16 v[132:135], a[132:135], a[140:143], v[132:135]
    ds_read_b128 a[192:195], v29 offset:13312
    v_mfma_f32_16x16x32_bf16 v[136:139], a[132:135], a[144:147], v[136:139]
    ds_read_b64_tr_b16 a[176:177], v28 offset:10240
    v_mfma_f32_16x16x32_bf16 v[140:143], a[132:135], a[148:151], v[140:143]
    ds_read_b64_tr_b16 a[178:179], v28 offset:15360
    v_mfma_f32_16x16x32_bf16 v[144:147], a[132:135], a[152:155], v[144:147]
    s_add_u32 m0, s76, 4096
    s_nop 0
    buffer_load_dwordx4 v9, s[48:51], s78 offen sc1 lds
    v_mfma_f32_16x16x32_bf16 v[148:151], a[132:135], a[156:159], v[148:151]
    ds_read_b128 a[196:199], v29 offset:14336
    v_mfma_f32_16x16x32_bf16 v[152:155], a[136:139], a[140:143], v[152:155]
    v_mfma_f32_16x16x32_bf16 v[156:159], a[136:139], a[144:147], v[156:159]
    v_mfma_f32_16x16x32_bf16 v[160:163], a[136:139], a[148:151], v[160:163]
    v_mfma_f32_16x16x32_bf16 v[164:167], a[136:139], a[152:155], v[164:167]
    v_mfma_f32_16x16x32_bf16 v[168:171], a[136:139], a[156:159], v[168:171]
    s_waitcnt lgkmcnt(0)
    s_waitcnt vmcnt(10)
    s_barrier
    v_mov_b32 v17, 3
    buffer_store_dword v17, v2, s[4:7], 0 offen sc1
    v_mfma_f32_16x16x32_bf16 v[72:75], a[160:163], a[180:183], v[72:75]
    v_add_u32 v24, 40960, v66
    v_add_u32 v25, 40960, v67
    v_mfma_f32_16x16x32_bf16 v[76:79], a[160:163], a[184:187], v[76:79]
    s_add_u32 s77, s64, 81920
    s_add_u32 m0, s75, 122880
    s_nop 0
    buffer_load_dwordx4 v1, s[44:47], s77 offen lds
    v_mfma_f32_16x16x32_bf16 v[80:83], a[160:163], a[188:191], v[80:83]
    v_add_u32 v26, 40960, v68
    v_mfma_f32_16x16x32_bf16 v[84:87], a[160:163], a[192:195], v[84:87]
    v_add_u32 v27, 40960, v69
    v_mfma_f32_16x16x32_bf16 v[88:91], a[160:163], a[196:199], v[88:91]
    v_add_u32 v28, 40960, v70
    v_mfma_f32_16x16x32_bf16 v[92:95], a[164:167], a[180:183], v[92:95]
    v_add_u32 v29, 40960, v71
    buffer_load_dwordx4 v3, s[44:47], s77 offen offset:1024 lds
    v_mfma_f32_16x16x32_bf16 v[96:99], a[164:167], a[184:187], v[96:99]
    ds_read_b64_tr_b16 a[120:121], v24
    v_mfma_f32_16x16x32_bf16 v[100:103], a[164:167], a[188:191], v[100:103]
    ds_read_b64_tr_b16 a[122:123], v24 offset:5120
    v_mfma_f32_16x16x32_bf16 v[104:107], a[164:167], a[192:195], v[104:107]
    ds_read_b128 a[140:143], v29
    v_mfma_f32_16x16x32_bf16 v[108:111], a[164:167], a[196:199], v[108:111]
    ds_read_b64_tr_b16 a[124:125], v25
    v_mfma_f32_16x16x32_bf16 v[112:115], a[168:171], a[180:183], v[112:115]
    ds_read_b64_tr_b16 a[126:127], v25 offset:5120
    v_mfma_f32_16x16x32_bf16 v[116:119], a[168:171], a[184:187], v[116:119]
    buffer_load_dwordx4 v4, s[44:47], s77 offen offset:2048 lds
    ds_read_b128 a[144:147], v29 offset:1024
    v_mfma_f32_16x16x32_bf16 v[120:123], a[168:171], a[188:191], v[120:123]
    ds_read_b64_tr_b16 a[128:129], v26
    v_mfma_f32_16x16x32_bf16 v[124:127], a[168:171], a[192:195], v[124:127]
    ds_read_b64_tr_b16 a[130:131], v26 offset:5120
    v_mfma_f32_16x16x32_bf16 v[128:131], a[168:171], a[196:199], v[128:131]
    ds_read_b128 a[148:151], v29 offset:2048
    v_mfma_f32_16x16x32_bf16 v[132:135], a[172:175], a[180:183], v[132:135]
    buffer_load_dwordx4 v6, s[44:47], s77 offen offset:3072 lds
    v_mfma_f32_16x16x32_bf16 v[136:139], a[172:175], a[184:187], v[136:139]
    ds_read_b64_tr_b16 a[132:133], v27
    ds_read_b64_tr_b16 a[134:135], v27 offset:5120
    v_mfma_f32_16x16x32_bf16 v[140:143], a[172:175], a[188:191], v[140:143]
    ds_read_b128 a[152:155], v29 offset:3072
    v_mfma_f32_16x16x32_bf16 v[144:147], a[172:175], a[192:195], v[144:147]
    ds_read_b64_tr_b16 a[136:137], v28
    v_mfma_f32_16x16x32_bf16 v[148:151], a[172:175], a[196:199], v[148:151]
    s_add_u32 m0, s75, 126976
    s_nop 0
    buffer_load_dwordx4 v7, s[44:47], s77 offen lds
    v_mfma_f32_16x16x32_bf16 v[152:155], a[176:179], a[180:183], v[152:155]
    ds_read_b64_tr_b16 a[138:139], v28 offset:5120
    v_mfma_f32_16x16x32_bf16 v[156:159], a[176:179], a[184:187], v[156:159]
    ds_read_b128 a[156:159], v29 offset:4096
    v_mfma_f32_16x16x32_bf16 v[160:163], a[176:179], a[188:191], v[160:163]
    v_mfma_f32_16x16x32_bf16 v[164:167], a[176:179], a[192:195], v[164:167]
    v_mfma_f32_16x16x32_bf16 v[168:171], a[176:179], a[196:199], v[168:171]
    s_waitcnt lgkmcnt(12)
    v_mfma_f32_16x16x32_bf16 v[72:75], a[120:123], a[140:143], v[72:75]
    ds_read_b64_tr_b16 a[160:161], v24 offset:10240
    s_waitcnt lgkmcnt(10)
    v_mfma_f32_16x16x32_bf16 v[76:79], a[120:123], a[144:147], v[76:79]
    ds_read_b64_tr_b16 a[162:163], v24 offset:15360
    s_waitcnt lgkmcnt(8)
    v_mfma_f32_16x16x32_bf16 v[80:83], a[120:123], a[148:151], v[80:83]
    s_add_u32 s78, s68, 20480
    s_add_u32 m0, s76, 122880
    s_nop 0
    buffer_load_dwordx4 v8, s[48:51], s78 offen sc1 lds
    s_waitcnt lgkmcnt(5)
    v_mfma_f32_16x16x32_bf16 v[84:87], a[120:123], a[152:155], v[84:87]
    ds_read_b128 a[180:183], v29 offset:10240
    s_waitcnt lgkmcnt(3)
    v_mfma_f32_16x16x32_bf16 v[88:91], a[120:123], a[156:159], v[88:91]
    ds_read_b64_tr_b16 a[164:165], v25 offset:10240
    v_mfma_f32_16x16x32_bf16 v[92:95], a[124:127], a[140:143], v[92:95]
    ds_read_b64_tr_b16 a[166:167], v25 offset:15360
    v_mfma_f32_16x16x32_bf16 v[96:99], a[124:127], a[144:147], v[96:99]
    buffer_load_dwordx4 v8, s[48:51], s78 offen offset:1024 sc1 lds
    v_mfma_f32_16x16x32_bf16 v[100:103], a[124:127], a[148:151], v[100:103]
    ds_read_b128 a[184:187], v29 offset:11264
    v_mfma_f32_16x16x32_bf16 v[104:107], a[124:127], a[152:155], v[104:107]
    ds_read_b64_tr_b16 a[168:169], v26 offset:10240
    v_mfma_f32_16x16x32_bf16 v[108:111], a[124:127], a[156:159], v[108:111]
    ds_read_b64_tr_b16 a[170:171], v26 offset:15360
    v_mfma_f32_16x16x32_bf16 v[112:115], a[128:131], a[140:143], v[112:115]
    buffer_load_dwordx4 v8, s[48:51], s78 offen offset:2048 sc1 lds
    v_mfma_f32_16x16x32_bf16 v[116:119], a[128:131], a[144:147], v[116:119]
    ds_read_b128 a[188:191], v29 offset:12288
    v_mfma_f32_16x16x32_bf16 v[120:123], a[128:131], a[148:151], v[120:123]
    ds_read_b64_tr_b16 a[172:173], v27 offset:10240
    v_mfma_f32_16x16x32_bf16 v[124:127], a[128:131], a[152:155], v[124:127]
    ds_read_b64_tr_b16 a[174:175], v27 offset:15360
    v_mfma_f32_16x16x32_bf16 v[128:131], a[128:131], a[156:159], v[128:131]
    buffer_load_dwordx4 v8, s[48:51], s78 offen offset:3072 sc1 lds
    v_mfma_f32_16x16x32_bf16 v[132:135], a[132:135], a[140:143], v[132:135]
    ds_read_b128 a[192:195], v29 offset:13312
    v_mfma_f32_16x16x32_bf16 v[136:139], a[132:135], a[144:147], v[136:139]
    ds_read_b64_tr_b16 a[176:177], v28 offset:10240
    v_mfma_f32_16x16x32_bf16 v[140:143], a[132:135], a[148:151], v[140:143]
    ds_read_b64_tr_b16 a[178:179], v28 offset:15360
    v_mfma_f32_16x16x32_bf16 v[144:147], a[132:135], a[152:155], v[144:147]
    s_add_u32 m0, s76, 126976
    s_nop 0
    buffer_load_dwordx4 v9, s[48:51], s78 offen sc1 lds
    v_mfma_f32_16x16x32_bf16 v[148:151], a[132:135], a[156:159], v[148:151]
    ds_read_b128 a[196:199], v29 offset:14336
    v_mfma_f32_16x16x32_bf16 v[152:155], a[136:139], a[140:143], v[152:155]
    v_mfma_f32_16x16x32_bf16 v[156:159], a[136:139], a[144:147], v[156:159]
    v_mfma_f32_16x16x32_bf16 v[160:163], a[136:139], a[148:151], v[160:163]
    v_mfma_f32_16x16x32_bf16 v[164:167], a[136:139], a[152:155], v[164:167]
    v_mfma_f32_16x16x32_bf16 v[168:171], a[136:139], a[156:159], v[168:171]
    s_waitcnt lgkmcnt(0)
    s_waitcnt vmcnt(11)
    s_barrier
    v_mfma_f32_16x16x32_bf16 v[72:75], a[160:163], a[180:183], v[72:75]
    v_add_u32 v24, 0, v66
    v_add_u32 v25, 0, v67
    v_mfma_f32_16x16x32_bf16 v[76:79], a[160:163], a[184:187], v[76:79]
    s_add_u32 s77, s64, 163840
    s_add_u32 m0, s75, 81920
    s_nop 0
    buffer_load_dwordx4 v1, s[44:47], s77 offen lds
    v_mfma_f32_16x16x32_bf16 v[80:83], a[160:163], a[188:191], v[80:83]
    v_add_u32 v26, 0, v68
    v_mfma_f32_16x16x32_bf16 v[84:87], a[160:163], a[192:195], v[84:87]
    v_add_u32 v27, 0, v69
    v_mfma_f32_16x16x32_bf16 v[88:91], a[160:163], a[196:199], v[88:91]
    v_add_u32 v28, 0, v70
    v_mfma_f32_16x16x32_bf16 v[92:95], a[164:167], a[180:183], v[92:95]
    v_add_u32 v29, 0, v71
    buffer_load_dwordx4 v3, s[44:47], s77 offen offset:1024 lds
    v_mfma_f32_16x16x32_bf16 v[96:99], a[164:167], a[184:187], v[96:99]
    ds_read_b64_tr_b16 a[120:121], v24
    v_mfma_f32_16x16x32_bf16 v[100:103], a[164:167], a[188:191], v[100:103]
    ds_read_b64_tr_b16 a[122:123], v24 offset:5120
    v_mfma_f32_16x16x32_bf16 v[104:107], a[164:167], a[192:195], v[104:107]
    ds_read_b128 a[140:143], v29
    v_mfma_f32_16x16x32_bf16 v[108:111], a[164:167], a[196:199], v[108:111]
    ds_read_b64_tr_b16 a[124:125], v25
    v_mfma_f32_16x16x32_bf16 v[112:115], a[168:171], a[180:183], v[112:115]
    ds_read_b64_tr_b16 a[126:127], v25 offset:5120
    v_mfma_f32_16x16x32_bf16 v[116:119], a[168:171], a[184:187], v[116:119]
    buffer_load_dwordx4 v4, s[44:47], s77 offen offset:2048 lds
    ds_read_b128 a[144:147], v29 offset:1024
    v_mfma_f32_16x16x32_bf16 v[120:123], a[168:171], a[188:191], v[120:123]
    ds_read_b64_tr_b16 a[128:129], v26
    v_mfma_f32_16x16x32_bf16 v[124:127], a[168:171], a[192:195], v[124:127]
    ds_read_b64_tr_b16 a[130:131], v26 offset:5120
    v_mfma_f32_16x16x32_bf16 v[128:131], a[168:171], a[196:199], v[128:131]
    ds_read_b128 a[148:151], v29 offset:2048
    v_mfma_f32_16x16x32_bf16 v[132:135], a[172:175], a[180:183], v[132:135]
    buffer_load_dwordx4 v6, s[44:47], s77 offen offset:3072 lds
    v_mfma_f32_16x16x32_bf16 v[136:139], a[172:175], a[184:187], v[136:139]
    ds_read_b64_tr_b16 a[132:133], v27
    ds_read_b64_tr_b16 a[134:135], v27 offset:5120
    v_mfma_f32_16x16x32_bf16 v[140:143], a[172:175], a[188:191], v[140:143]
    ds_read_b128 a[152:155], v29 offset:3072
    v_mfma_f32_16x16x32_bf16 v[144:147], a[172:175], a[192:195], v[144:147]
    ds_read_b64_tr_b16 a[136:137], v28
    v_mfma_f32_16x16x32_bf16 v[148:151], a[172:175], a[196:199], v[148:151]
    s_add_u32 m0, s75, 86016
    s_nop 0
    buffer_load_dwordx4 v7, s[44:47], s77 offen lds
    v_mfma_f32_16x16x32_bf16 v[152:155], a[176:179], a[180:183], v[152:155]
    ds_read_b64_tr_b16 a[138:139], v28 offset:5120
    v_mfma_f32_16x16x32_bf16 v[156:159], a[176:179], a[184:187], v[156:159]
    ds_read_b128 a[156:159], v29 offset:4096
    v_mfma_f32_16x16x32_bf16 v[160:163], a[176:179], a[188:191], v[160:163]
    v_mfma_f32_16x16x32_bf16 v[164:167], a[176:179], a[192:195], v[164:167]
    v_mfma_f32_16x16x32_bf16 v[168:171], a[176:179], a[196:199], v[168:171]
    s_waitcnt lgkmcnt(12)
    v_mfma_f32_16x16x32_bf16 v[72:75], a[120:123], a[140:143], v[72:75]
    ds_read_b64_tr_b16 a[160:161], v24 offset:10240
    s_lshl_b32 s79, s31, 5
    s_waitcnt lgkmcnt(10)
    v_mfma_f32_16x16x32_bf16 v[76:79], a[120:123], a[144:147], v[76:79]
    ds_read_b64_tr_b16 a[162:163], v24 offset:15360
    s_waitcnt lgkmcnt(8)
    v_mfma_f32_16x16x32_bf16 v[80:83], a[120:123], a[148:151], v[80:83]
    s_add_u32 s78, s68, 40960
    s_add_u32 m0, s76, 81920
    s_nop 0
    buffer_load_dwordx4 v8, s[48:51], s78 offen sc1 lds
    s_waitcnt lgkmcnt(5)
    v_mfma_f32_16x16x32_bf16 v[84:87], a[120:123], a[152:155], v[84:87]
    ds_read_b128 a[180:183], v29 offset:10240
    ds_read_b64_tr_b16 a[164:165], v25 offset:10240
    s_waitcnt lgkmcnt(4)
    v_mfma_f32_16x16x32_bf16 v[88:91], a[120:123], a[156:159], v[88:91]
    s_add_u32 s79, s79, s72
    v_mfma_f32_16x16x32_bf16 v[92:95], a[124:127], a[140:143], v[92:95]
    ds_read_b64_tr_b16 a[166:167], v25 offset:15360
    v_mfma_f32_16x16x32_bf16 v[96:99], a[124:127], a[144:147], v[96:99]
    buffer_load_dwordx4 v8, s[48:51], s78 offen offset:1024 sc1 lds
    ds_read_b128 a[184:187], v29 offset:11264
    v_mfma_f32_16x16x32_bf16 v[100:103], a[124:127], a[148:151], v[100:103]
    s_lshl_b32 s79, s79, 7
    v_mfma_f32_16x16x32_bf16 v[104:107], a[124:127], a[152:155], v[104:107]
    ds_read_b64_tr_b16 a[168:169], v26 offset:10240
    v_mfma_f32_16x16x32_bf16 v[108:111], a[124:127], a[156:159], v[108:111]
    ds_read_b64_tr_b16 a[170:171], v26 offset:15360
    v_mfma_f32_16x16x32_bf16 v[112:115], a[128:131], a[140:143], v[112:115]
    buffer_load_dwordx4 v8, s[48:51], s78 offen offset:2048 sc1 lds
    ds_read_b128 a[188:191], v29 offset:12288
    v_mfma_f32_16x16x32_bf16 v[116:119], a[128:131], a[144:147], v[116:119]
    v_lshlrev_b32 v19, 10, v0
    v_mfma_f32_16x16x32_bf16 v[120:123], a[128:131], a[148:151], v[120:123]
    ds_read_b64_tr_b16 a[172:173], v27 offset:10240
    v_mfma_f32_16x16x32_bf16 v[124:127], a[128:131], a[152:155], v[124:127]
    ds_read_b64_tr_b16 a[174:175], v27 offset:15360
    buffer_load_dwordx4 v8, s[48:51], s78 offen offset:3072 sc1 lds
    v_mfma_f32_16x16x32_bf16 v[128:131], a[128:131], a[156:159], v[128:131]
    v_add_u32 v19, s79, v19
    v_mfma_f32_16x16x32_bf16 v[132:135], a[132:135], a[140:143], v[132:135]
    ds_read_b128 a[192:195], v29 offset:13312
    v_mfma_f32_16x16x32_bf16 v[136:139], a[132:135], a[144:147], v[136:139]
    ds_read_b64_tr_b16 a[176:177], v28 offset:10240
    ds_read_b64_tr_b16 a[178:179], v28 offset:15360
    v_mfma_f32_16x16x32_bf16 v[140:143], a[132:135], a[148:151], v[140:143]
    s_add_u32 m0, s76, 86016
    s_nop 0
    buffer_load_dwordx4 v9, s[48:51], s78 offen sc1 lds
    v_mfma_f32_16x16x32_bf16 v[144:147], a[132:135], a[152:155], v[144:147]
    buffer_load_dword v16, v19, s[4:7], 0 offen sc1
    v_mfma_f32_16x16x32_bf16 v[148:151], a[132:135], a[156:159], v[148:151]
    ds_read_b128 a[196:199], v29 offset:14336
    v_mfma_f32_16x16x32_bf16 v[152:155], a[136:139], a[140:143], v[152:155]
    v_mfma_f32_16x16x32_bf16 v[156:159], a[136:139], a[144:147], v[156:159]
    v_mfma_f32_16x16x32_bf16 v[160:163], a[136:139], a[148:151], v[160:163]
    v_mfma_f32_16x16x32_bf16 v[164:167], a[136:139], a[152:155], v[164:167]
    v_mfma_f32_16x16x32_bf16 v[168:171], a[136:139], a[156:159], v[168:171]
    s_waitcnt lgkmcnt(0)
    s_waitcnt vmcnt(11)
    s_barrier
    v_mfma_f32_16x16x32_bf16 v[72:75], a[160:163], a[180:183], v[72:75]
    v_add_u32 v24, 122880, v66
    v_add_u32 v25, 122880, v67
    v_mfma_f32_16x16x32_bf16 v[76:79], a[160:163], a[184:187], v[76:79]
    s_add_u32 s77, s65, 81920
    s_add_u32 m0, s75, 40960
    s_nop 0
    buffer_load_dwordx4 v1, s[44:47], s77 offen lds
    v_mfma_f32_16x16x32_bf16 v[80:83], a[160:163], a[188:191], v[80:83]
    v_add_u32 v26, 122880, v68
    v_mfma_f32_16x16x32_bf16 v[84:87], a[160:163], a[192:195], v[84:87]
    v_add_u32 v27, 122880, v69
    v_mfma_f32_16x16x32_bf16 v[88:91], a[160:163], a[196:199], v[88:91]
    v_add_u32 v28, 122880, v70
    v_mfma_f32_16x16x32_bf16 v[92:95], a[164:167], a[180:183], v[92:95]
    v_add_u32 v29, 122880, v71
    buffer_load_dwordx4 v3, s[44:47], s77 offen offset:1024 lds
    v_mfma_f32_16x16x32_bf16 v[96:99], a[164:167], a[184:187], v[96:99]
    ds_read_b64_tr_b16 a[120:121], v24
    v_mfma_f32_16x16x32_bf16 v[100:103], a[164:167], a[188:191], v[100:103]
    ds_read_b64_tr_b16 a[122:123], v24 offset:5120
    v_mfma_f32_16x16x32_bf16 v[104:107], a[164:167], a[192:195], v[104:107]
    ds_read_b128 a[140:143], v29
    v_mfma_f32_16x16x32_bf16 v[108:111], a[164:167], a[196:199], v[108:111]
    ds_read_b64_tr_b16 a[124:125], v25
    v_mfma_f32_16x16x32_bf16 v[112:115], a[168:171], a[180:183], v[112:115]
    ds_read_b64_tr_b16 a[126:127], v25 offset:5120
    v_mfma_f32_16x16x32_bf16 v[116:119], a[168:171], a[184:187], v[116:119]
    buffer_load_dwordx4 v4, s[44:47], s77 offen offset:2048 lds
    ds_read_b128 a[144:147], v29 offset:1024
    v_mfma_f32_16x16x32_bf16 v[120:123], a[168:171], a[188:191], v[120:123]
    ds_read_b64_tr_b16 a[128:129], v26
    v_mfma_f32_16x16x32_bf16 v[124:127], a[168:171], a[192:195], v[124:127]
    ds_read_b64_tr_b16 a[130:131], v26 offset:5120
    v_mfma_f32_16x16x32_bf16 v[128:131], a[168:171], a[196:199], v[128:131]
    ds_read_b128 a[148:151], v29 offset:2048
    v_mfma_f32_16x16x32_bf16 v[132:135], a[172:175], a[180:183], v[132:135]
    buffer_load_dwordx4 v6, s[44:47], s77 offen offset:3072 lds
    v_mfma_f32_16x16x32_bf16 v[136:139], a[172:175], a[184:187], v[136:139]
    ds_read_b64_tr_b16 a[132:133], v27
    ds_read_b64_tr_b16 a[134:135], v27 offset:5120
    v_mfma_f32_16x16x32_bf16 v[140:143], a[172:175], a[188:191], v[140:143]
    ds_read_b128 a[152:155], v29 offset:3072
    v_mfma_f32_16x16x32_bf16 v[144:147], a[172:175], a[192:195], v[144:147]
    ds_read_b64_tr_b16 a[136:137], v28
    v_mfma_f32_16x16x32_bf16 v[148:151], a[172:175], a[196:199], v[148:151]
    s_add_u32 m0, s75, 45056
    s_nop 0
    buffer_load_dwordx4 v7, s[44:47], s77 offen lds
    v_mfma_f32_16x16x32_bf16 v[152:155], a[176:179], a[180:183], v[152:155]
    ds_read_b64_tr_b16 a[138:139], v28 offset:5120
    v_mfma_f32_16x16x32_bf16 v[156:159], a[176:179], a[184:187], v[156:159]
    ds_read_b128 a[156:159], v29 offset:4096
    v_mfma_f32_16x16x32_bf16 v[160:163], a[176:179], a[188:191], v[160:163]
    v_mfma_f32_16x16x32_bf16 v[164:167], a[176:179], a[192:195], v[164:167]
    v_mfma_f32_16x16x32_bf16 v[168:171], a[176:179], a[196:199], v[168:171]
    s_waitcnt lgkmcnt(12)
    v_mfma_f32_16x16x32_bf16 v[72:75], a[120:123], a[140:143], v[72:75]
    ds_read_b64_tr_b16 a[160:161], v24 offset:10240
    s_waitcnt lgkmcnt(10)
    v_mfma_f32_16x16x32_bf16 v[76:79], a[120:123], a[144:147], v[76:79]
    ds_read_b64_tr_b16 a[162:163], v24 offset:15360
    s_waitcnt lgkmcnt(8)
    v_mfma_f32_16x16x32_bf16 v[80:83], a[120:123], a[148:151], v[80:83]
    s_waitcnt lgkmcnt(5)
    v_mfma_f32_16x16x32_bf16 v[84:87], a[120:123], a[152:155], v[84:87]
    ds_read_b128 a[180:183], v29 offset:10240
    s_waitcnt lgkmcnt(3)
    v_mfma_f32_16x16x32_bf16 v[88:91], a[120:123], a[156:159], v[88:91]
    ds_read_b64_tr_b16 a[164:165], v25 offset:10240
    v_mfma_f32_16x16x32_bf16 v[92:95], a[124:127], a[140:143], v[92:95]
    ds_read_b64_tr_b16 a[166:167], v25 offset:15360
    v_mfma_f32_16x16x32_bf16 v[96:99], a[124:127], a[144:147], v[96:99]
    v_mfma_f32_16x16x32_bf16 v[100:103], a[124:127], a[148:151], v[100:103]
    ds_read_b128 a[184:187], v29 offset:11264
    v_mfma_f32_16x16x32_bf16 v[104:107], a[124:127], a[152:155], v[104:107]
    ds_read_b64_tr_b16 a[168:169], v26 offset:10240
    v_mfma_f32_16x16x32_bf16 v[108:111], a[124:127], a[156:159], v[108:111]
    ds_read_b64_tr_b16 a[170:171], v26 offset:15360
    v_mfma_f32_16x16x32_bf16 v[112:115], a[128:131], a[140:143], v[112:115]
    v_mfma_f32_16x16x32_bf16 v[116:119], a[128:131], a[144:147], v[116:119]
    ds_read_b128 a[188:191], v29 offset:12288
    v_mfma_f32_16x16x32_bf16 v[120:123], a[128:131], a[148:151], v[120:123]
    ds_read_b64_tr_b16 a[172:173], v27 offset:10240
    v_mfma_f32_16x16x32_bf16 v[124:127], a[128:131], a[152:155], v[124:127]
    ds_read_b64_tr_b16 a[174:175], v27 offset:15360
    v_mfma_f32_16x16x32_bf16 v[128:131], a[128:131], a[156:159], v[128:131]
    v_mfma_f32_16x16x32_bf16 v[132:135], a[132:135], a[140:143], v[132:135]
    ds_read_b128 a[192:195], v29 offset:13312
    v_mfma_f32_16x16x32_bf16 v[136:139], a[132:135], a[144:147], v[136:139]
    ds_read_b64_tr_b16 a[176:177], v28 offset:10240
    v_mfma_f32_16x16x32_bf16 v[140:143], a[132:135], a[148:151], v[140:143]
    ds_read_b64_tr_b16 a[178:179], v28 offset:15360
    v_mfma_f32_16x16x32_bf16 v[144:147], a[132:135], a[152:155], v[144:147]
    v_mfma_f32_16x16x32_bf16 v[148:151], a[132:135], a[156:159], v[148:151]
    ds_read_b128 a[196:199], v29 offset:14336
    v_mfma_f32_16x16x32_bf16 v[152:155], a[136:139], a[140:143], v[152:155]
    v_mfma_f32_16x16x32_bf16 v[156:159], a[136:139], a[144:147], v[156:159]
    v_mfma_f32_16x16x32_bf16 v[160:163], a[136:139], a[148:151], v[160:163]
    v_mfma_f32_16x16x32_bf16 v[164:167], a[136:139], a[152:155], v[164:167]
    v_mfma_f32_16x16x32_bf16 v[168:171], a[136:139], a[156:159], v[168:171]
    s_waitcnt lgkmcnt(0)
    s_waitcnt vmcnt(6)
    s_barrier
    s_waitcnt vmcnt(5)
    v_cmp_le_u32 vcc, 3, v16
    s_nop 3
    s_and_b32 s79, vcc_lo, 15
    s_cmp_eq_u32 s79, 15
    s_cbranch_scc0 SLOW_P2
BACK_P2:
    v_mfma_f32_16x16x32_bf16 v[72:75], a[160:163], a[180:183], v[72:75]
    v_add_u32 v24, 81920, v66
    v_add_u32 v25, 81920, v67
    v_mfma_f32_16x16x32_bf16 v[76:79], a[160:163], a[184:187], v[76:79]
    s_add_u32 s78, s69, 20480
    s_add_u32 m0, s76, 40960
    s_nop 0
    buffer_load_dwordx4 v8, s[48:51], s78 offen sc1 lds
    v_mfma_f32_16x16x32_bf16 v[80:83], a[160:163], a[188:191], v[80:83]
    v_add_u32 v26, 81920, v68
    v_mfma_f32_16x16x32_bf16 v[84:87], a[160:163], a[192:195], v[84:87]
    v_add_u32 v27, 81920, v69
    v_mfma_f32_16x16x32_bf16 v[88:91], a[160:163], a[196:199], v[88:91]
    v_add_u32 v28, 81920, v70
    v_mfma_f32_16x16x32_bf16 v[92:95], a[164:167], a[180:183], v[92:95]
    v_add_u32 v29, 81920, v71
    buffer_load_dwordx4 v8, s[48:51], s78 offen offset:1024 sc1 lds
    v_mfma_f32_16x16x32_bf16 v[96:99], a[164:167], a[184:187], v[96:99]
    ds_read_b64_tr_b16 a[120:121], v24
    v_mfma_f32_16x16x32_bf16 v[100:103], a[164:167], a[188:191], v[100:103]
    ds_read_b64_tr_b16 a[122:123], v24 offset:5120
    v_mfma_f32_16x16x32_bf16 v[104:107], a[164:167], a[192:195], v[104:107]
    ds_read_b128 a[140:143], v29
    v_mfma_f32_16x16x32_bf16 v[108:111], a[164:167], a[196:199], v[108:111]
    ds_read_b64_tr_b16 a[124:125], v25
    v_mfma_f32_16x16x32_bf16 v[112:115], a[168:171], a[180:183], v[112:115]
    ds_read_b64_tr_b16 a[126:127], v25 offset:5120
    v_mfma_f32_16x16x32_bf16 v[116:119], a[168:171], a[184:187], v[116:119]
    buffer_load_dwordx4 v8, s[48:51], s78 offen offset:2048 sc1 lds
    ds_read_b128 a[144:147], v29 offset:1024
    v_mfma_f32_16x16x32_bf16 v[120:123], a[168:171], a[188:191], v[120:123]
    ds_read_b64_tr_b16 a[128:129], v26
    v_mfma_f32_16x16x32_bf16 v[124:127], a[168:171], a[192:195], v[124:127]
    ds_read_b64_tr_b16 a[130:131], v26 offset:5120
    v_mfma_f32_16x16x32_bf16 v[128:131], a[168:171], a[196:199], v[128:131]
    ds_read_b128 a[148:151], v29 offset:2048
    v_mfma_f32_16x16x32_bf16 v[132:135], a[172:175], a[180:183], v[132:135]
    buffer_load_dwordx4 v8, s[48:51], s78 offen offset:3072 sc1 lds
    v_mfma_f32_16x16x32_bf16 v[136:139], a[172:175], a[184:187], v[136:139]
    ds_read_b64_tr_b16 a[132:133], v27
    ds_read_b64_tr_b16 a[134:135], v27 offset:5120
    v_mfma_f32_16x16x32_bf16 v[140:143], a[172:175], a[188:191], v[140:143]
    ds_read_b128 a[152:155], v29 offset:3072
    v_mfma_f32_16x16x32_bf16 v[144:147], a[172:175], a[192:195], v[144:147]
    ds_read_b64_tr_b16 a[136:137], v28
    v_mfma_f32_16x16x32_bf16 v[148:151], a[172:175], a[196:199], v[148:151]
    s_add_u32 m0, s76, 45056
    s_nop 0
    buffer_load_dwordx4 v9, s[48:51], s78 offen sc1 lds
    v_mfma_f32_16x16x32_bf16 v[152:155], a[176:179], a[180:183], v[152:155]
    ds_read_b64_tr_b16 a[138:139], v28 offset:5120
    v_mfma_f32_16x16x32_bf16 v[156:159], a[176:179], a[184:187], v[156:159]
    ds_read_b128 a[156:159], v29 offset:4096
    v_mfma_f32_16x16x32_bf16 v[160:163], a[176:179], a[188:191], v[160:163]
    v_mfma_f32_16x16x32_bf16 v[164:167], a[176:179], a[192:195], v[164:167]
    v_mfma_f32_16x16x32_bf16 v[168:171], a[176:179], a[196:199], v[168:171]
    s_waitcnt lgkmcnt(12)
    v_mfma_f32_16x16x32_bf16 v[72:75], a[120:123], a[140:143], v[72:75]
    ds_read_b64_tr_b16 a[160:161], v24 offset:10240
    s_waitcnt lgkmcnt(10)
    v_mfma_f32_16x16x32_bf16 v[76:79], a[120:123], a[144:147], v[76:79]
    ds_read_b64_tr_b16 a[162:163], v24 offset:15360
    s_waitcnt lgkmcnt(8)
    v_mfma_f32_16x16x32_bf16 v[80:83], a[120:123], a[148:151], v[80:83]
    s_add_u32 s77, s66, 81920
    s_add_u32 m0, s75, 0
    s_nop 0
    buffer_load_dwordx4 v1, s[44:47], s77 offen lds
    s_waitcnt lgkmcnt(5)
    v_mfma_f32_16x16x32_bf16 v[84:87], a[120:123], a[152:155], v[84:87]
    ds_read_b128 a[180:183], v29 offset:10240
    s_waitcnt lgkmcnt(3)
    v_mfma_f32_16x16x32_bf16 v[88:91], a[120:123], a[156:159], v[88:91]
    ds_read_b64_tr_b16 a[164:165], v25 offset:10240
    v_mfma_f32_16x16x32_bf16 v[92:95], a[124:127], a[140:143], v[92:95]
    ds_read_b64_tr_b16 a[166:167], v25 offset:15360
    v_mfma_f32_16x16x32_bf16 v[96:99], a[124:127], a[144:147], v[96:99]
    buffer_load_dwordx4 v3, s[44:47], s77 offen offset:1024 lds
    v_mfma_f32_16x16x32_bf16 v[100:103], a[124:127], a[148:151], v[100:103]
    ds_read_b128 a[184:187], v29 offset:11264
    v_mfma_f32_16x16x32_bf16 v[104:107], a[124:127], a[152:155], v[104:107]
    ds_read_b64_tr_b16 a[168:169], v26 offset:10240
    v_mfma_f32_16x16x32_bf16 v[108:111], a[124:127], a[156:159], v[108:111]
    ds_read_b64_tr_b16 a[170:171], v26 offset:15360
    v_mfma_f32_16x16x32_bf16 v[112:115], a[128:131], a[140:143], v[112:115]
    buffer_load_dwordx4 v4, s[44:47], s77 offen offset:2048 lds
    v_mfma_f32_16x16x32_bf16 v[116:119], a[128:131], a[144:147], v[116:119]
    ds_read_b128 a[188:191], v29 offset:12288
    v_mfma_f32_16x16x32_bf16 v[120:123], a[128:131], a[148:151], v[120:123]
    ds_read_b64_tr_b16 a[172:173], v27 offset:10240
    v_mfma_f32_16x16x32_bf16 v[124:127], a[128:131], a[152:155], v[124:127]
    ds_read_b64_tr_b16 a[174:175], v27 offset:15360
    v_mfma_f32_16x16x32_bf16 v[128:131], a[128:131], a[156:159], v[128:131]
    buffer_load_dwordx4 v6, s[44:47], s77 offen offset:3072 lds
    v_mfma_f32_16x16x32_bf16 v[132:135], a[132:135], a[140:143], v[132:135]
    ds_read_b128 a[192:195], v29 offset:13312
    v_mfma_f32_16x16x32_bf16 v[136:139], a[132:135], a[144:147], v[136:139]
    ds_read_b64_tr_b16 a[176:177], v28 offset:10240
    v_mfma_f32_16x16x32_bf16 v[140:143], a[132:135], a[148:151], v[140:143]
    ds_read_b64_tr_b16 a[178:179], v28 offset:15360
    v_mfma_f32_16x16x32_bf16 v[144:147], a[132:135], a[152:155], v[144:147]
    s_add_u32 m0, s75, 4096
    s_nop 0
    buffer_load_dwordx4 v7, s[44:47], s77 offen lds
    v_mfma_f32_16x16x32_bf16 v[148:151], a[132:135], a[156:159], v[148:151]
    ds_read_b128 a[196:199], v29 offset:14336
    v_mfma_f32_16x16x32_bf16 v[152:155], a[136:139], a[140:143], v[152:155]
    v_mfma_f32_16x16x32_bf16 v[156:159], a[136:139], a[144:147], v[156:159]
    v_mfma_f32_16x16x32_bf16 v[160:163], a[136:139], a[148:151], v[160:163]
    v_mfma_f32_16x16x32_bf16 v[164:167], a[136:139], a[152:155], v[164:167]
    v_mfma_f32_16x16x32_bf16 v[168:171], a[136:139], a[156:159], v[168:171]
    s_waitcnt lgkmcnt(0)
    s_waitcnt vmcnt(5)
    s_barrier
    v_mfma_f32_16x16x32_bf16 v[72:75], a[160:163], a[180:183], v[72:75]
    v_add_u32 v24, 40960, v66
    v_add_u32 v25, 40960, v67
    v_mfma_f32_16x16x32_bf16 v[76:79], a[160:163], a[184:187], v[76:79]
    s_add_u32 s78, s70, 20480
    s_add_u32 m0, s76, 0
    s_nop 0
    buffer_load_dwordx4 v8, s[48:51], s78 offen sc1 lds
    v_mfma_f32_16x16x32_bf16 v[80:83], a[160:163], a[188:191], v[80:83]
    v_add_u32 v26, 40960, v68
    v_mfma_f32_16x16x32_bf16 v[84:87], a[160:163], a[192:195], v[84:87]
    v_add_u32 v27, 40960, v69
    v_mfma_f32_16x16x32_bf16 v[88:91], a[160:163], a[196:199], v[88:91]
    v_add_u32 v28, 40960, v70
    v_mfma_f32_16x16x32_bf16 v[92:95], a[164:167], a[180:183], v[92:95]
    v_add_u32 v29, 40960, v71
    buffer_load_dwordx4 v8, s[48:51], s78 offen offset:1024 sc1 lds
    v_mfma_f32_16x16x32_bf16 v[96:99], a[164:167], a[184:187], v[96:99]
    ds_read_b64_tr_b16 a[120:121], v24
    v_mfma_f32_16x16x32_bf16 v[100:103], a[164:167], a[188:191], v[100:103]
    ds_read_b64_tr_b16 a[122:123], v24 offset:5120
    v_mfma_f32_16x16x32_bf16 v[104:107], a[164:167], a[192:195], v[104:107]
    ds_read_b128 a[140:143], v29
    v_mfma_f32_16x16x32_bf16 v[108:111], a[164:167], a[196:199], v[108:111]
    ds_read_b64_tr_b16 a[124:125], v25
    v_mfma_f32_16x16x32_bf16 v[112:115], a[168:171], a[180:183], v[112:115]
    ds_read_b64_tr_b16 a[126:127], v25 offset:5120
    v_mfma_f32_16x16x32_bf16 v[116:119], a[168:171], a[184:187], v[116:119]
    buffer_load_dwordx4 v8, s[48:51], s78 offen offset:2048 sc1 lds
    ds_read_b128 a[144:147], v29 offset:1024
    v_mfma_f32_16x16x32_bf16 v[120:123], a[168:171], a[188:191], v[120:123]
    ds_read_b64_tr_b16 a[128:129], v26
    v_mfma_f32_16x16x32_bf16 v[124:127], a[168:171], a[192:195], v[124:127]
    ds_read_b64_tr_b16 a[130:131], v26 offset:5120
    v_mfma_f32_16x16x32_bf16 v[128:131], a[168:171], a[196:199], v[128:131]
    ds_read_b128 a[148:151], v29 offset:2048
    v_mfma_f32_16x16x32_bf16 v[132:135], a[172:175], a[180:183], v[132:135]
    buffer_load_dwordx4 v8, s[48:51], s78 offen offset:3072 sc1 lds
    v_mfma_f32_16x16x32_bf16 v[136:139], a[172:175], a[184:187], v[136:139]
    ds_read_b64_tr_b16 a[132:133], v27
    ds_read_b64_tr_b16 a[134:135], v27 offset:5120
    v_mfma_f32_16x16x32_bf16 v[140:143], a[172:175], a[188:191], v[140:143]
    ds_read_b128 a[152:155], v29 offset:3072
    v_mfma_f32_16x16x32_bf16 v[144:147], a[172:175], a[192:195], v[144:147]
    ds_read_b64_tr_b16 a[136:137], v28
    v_mfma_f32_16x16x32_bf16 v[148:151], a[172:175], a[196:199], v[148:151]
    s_add_u32 m0, s76, 4096
    s_nop 0
    buffer_load_dwordx4 v9, s[48:51], s78 offen sc1 lds
    v_mfma_f32_16x16x32_bf16 v[152:155], a[176:179], a[180:183], v[152:155]
    ds_read_b64_tr_b16 a[138:139], v28 offset:5120
    v_mfma_f32_16x16x32_bf16 v[156:159], a[176:179], a[184:187], v[156:159]
    ds_read_b128 a[156:159], v29 offset:4096
    v_mfma_f32_16x16x32_bf16 v[160:163], a[176:179], a[188:191], v[160:163]
    v_mfma_f32_16x16x32_bf16 v[164:167], a[176:179], a[192:195], v[164:167]
    v_mfma_f32_16x16x32_bf16 v[168:171], a[176:179], a[196:199], v[168:171]
    s_waitcnt lgkmcnt(12)
    v_mfma_f32_16x16x32_bf16 v[72:75], a[120:123], a[140:143], v[72:75]
    ds_read_b64_tr_b16 a[160:161], v24 offset:10240
    s_waitcnt lgkmcnt(10)
    v_mfma_f32_16x16x32_bf16 v[76:79], a[120:123], a[144:147], v[76:79]
    ds_read_b64_tr_b16 a[162:163], v24 offset:15360
    s_waitcnt lgkmcnt(8)
    v_mfma_f32_16x16x32_bf16 v[80:83], a[120:123], a[148:151], v[80:83]
    s_add_u32 s77, s67, 81920
    s_add_u32 m0, s75, 122880
    s_nop 0
    buffer_load_dwordx4 v1, s[44:47], s77 offen lds
    s_waitcnt lgkmcnt(5)
    v_mfma_f32_16x16x32_bf16 v[84:87], a[120:123], a[152:155], v[84:87]
    ds_read_b128 a[180:183], v29 offset:10240
    s_waitcnt lgkmcnt(3)
    v_mfma_f32_16x16x32_bf16 v[88:91], a[120:123], a[156:159], v[88:91]
    ds_read_b64_tr_b16 a[164:165], v25 offset:10240
    v_mfma_f32_16x16x32_bf16 v[92:95], a[124:127], a[140:143], v[92:95]
    ds_read_b64_tr_b16 a[166:167], v25 offset:15360
    v_mfma_f32_16x16x32_bf16 v[96:99], a[124:127], a[144:147], v[96:99]
    buffer_load_dwordx4 v3, s[44:47], s77 offen offset:1024 lds
    v_mfma_f32_16x16x32_bf16 v[100:103], a[124:127], a[148:151], v[100:103]
    ds_read_b128 a[184:187], v29 offset:11264
    v_mfma_f32_16x16x32_bf16 v[104:107], a[124:127], a[152:155], v[104:107]
    ds_read_b64_tr_b16 a[168:169], v26 offset:10240
    v_mfma_f32_16x16x32_bf16 v[108:111], a[124:127], a[156:159], v[108:111]
    ds_read_b64_tr_b16 a[170:171], v26 offset:15360
    v_mfma_f32_16x16x32_bf16 v[112:115], a[128:131], a[140:143], v[112:115]
    buffer_load_dwordx4 v4, s[44:47], s77 offen offset:2048 lds
    v_mfma_f32_16x16x32_bf16 v[116:119], a[128:131], a[144:147], v[116:119]
    ds_read_b128 a[188:191], v29 offset:12288
    v_mfma_f32_16x16x32_bf16 v[120:123], a[128:131], a[148:151], v[120:123]
    ds_read_b64_tr_b16 a[172:173], v27 offset:10240
    v_mfma_f32_16x16x32_bf16 v[124:127], a[128:131], a[152:155], v[124:127]
    ds_read_b64_tr_b16 a[174:175], v27 offset:15360
    v_mfma_f32_16x16x32_bf16 v[128:131], a[128:131], a[156:159], v[128:131]
    buffer_load_dwordx4 v6, s[44:47], s77 offen offset:3072 lds
    v_mfma_f32_16x16x32_bf16 v[132:135], a[132:135], a[140:143], v[132:135]
    ds_read_b128 a[192:195], v29 offset:13312
    v_mfma_f32_16x16x32_bf16 v[136:139], a[132:135], a[144:147], v[136:139]
    ds_read_b64_tr_b16 a[176:177], v28 offset:10240
    v_mfma_f32_16x16x32_bf16 v[140:143], a[132:135], a[148:151], v[140:143]
    ds_read_b64_tr_b16 a[178:179], v28 offset:15360
    v_mfma_f32_16x16x32_bf16 v[144:147], a[132:135], a[152:155], v[144:147]
    s_add_u32 m0, s75, 126976
    s_nop 0
    buffer_load_dwordx4 v7, s[44:47], s77 offen lds
    v_mfma_f32_16x16x32_bf16 v[148:151], a[132:135], a[156:159], v[148:151]
    ds_read_b128 a[196:199], v29 offset:14336
    v_mfma_f32_16x16x32_bf16 v[152:155], a[136:139], a[140:143], v[152:155]
    v_mfma_f32_16x16x32_bf16 v[156:159], a[136:139], a[144:147], v[156:159]
    v_mfma_f32_16x16x32_bf16 v[160:163], a[136:139], a[148:151], v[160:163]
    v_mfma_f32_16x16x32_bf16 v[164:167], a[136:139], a[152:155], v[164:167]
    v_mfma_f32_16x16x32_bf16 v[168:171], a[136:139], a[156:159], v[168:171]
    s_waitcnt lgkmcnt(0)
    s_waitcnt vmcnt(5)
    s_barrier
    v_mfma_f32_16x16x32_bf16 v[72:75], a[160:163], a[180:183], v[72:75]
    v_add_u32 v24, 0, v66
    v_add_u32 v25, 0, v67
    v_mfma_f32_16x16x32_bf16 v[76:79], a[160:163], a[184:187], v[76:79]
    s_add_u32 s78, s71, 20480
    s_add_u32 m0, s76, 122880
    s_nop 0
    buffer_load_dwordx4 v8, s[48:51], s78 offen sc1 lds
    v_mfma_f32_16x16x32_bf16 v[80:83], a[160:163], a[188:191], v[80:83]
    v_add_u32 v26, 0, v68
    v_mfma_f32_16x16x32_bf16 v[84:87], a[160:163], a[192:195], v[84:87]
    v_add_u32 v27, 0, v69
    v_mfma_f32_16x16x32_bf16 v[88:91], a[160:163], a[196:199], v[88:91]
    v_add_u32 v28, 0, v70
    v_mfma_f32_16x16x32_bf16 v[92:95], a[164:167], a[180:183], v[92:95]
    v_add_u32 v29, 0, v71
    buffer_load_dwordx4 v8, s[48:51], s78 offen offset:1024 sc1 lds
    v_mfma_f32_16x16x32_bf16 v[96:99], a[164:167], a[184:187], v[96:99]
    ds_read_b64_tr_b16 a[120:121], v24
    v_mfma_f32_16x16x32_bf16 v[100:103], a[164:167], a[188:191], v[100:103]
    ds_read_b64_tr_b16 a[122:123], v24 offset:5120
    v_mfma_f32_16x16x32_bf16 v[104:107], a[164:167], a[192:195], v[104:107]
    ds_read_b128 a[140:143], v29
    v_mfma_f32_16x16x32_bf16 v[108:111], a[164:167], a[196:199], v[108:111]
    ds_read_b64_tr_b16 a[124:125], v25
    v_mfma_f32_16x16x32_bf16 v[112:115], a[168:171], a[180:183], v[112:115]
    ds_read_b64_tr_b16 a[126:127], v25 offset:5120
    v_mfma_f32_16x16x32_bf16 v[116:119], a[168:171], a[184:187], v[116:119]
    buffer_load_dwordx4 v8, s[48:51], s78 offen offset:2048 sc1 lds
    ds_read_b128 a[144:147], v29 offset:1024
    v_mfma_f32_16x16x32_bf16 v[120:123], a[168:171], a[188:191], v[120:123]
    ds_read_b64_tr_b16 a[128:129], v26
    v_mfma_f32_16x16x32_bf16 v[124:127], a[168:171], a[192:195], v[124:127]
    ds_read_b64_tr_b16 a[130:131], v26 offset:5120
    v_mfma_f32_16x16x32_bf16 v[128:131], a[168:171], a[196:199], v[128:131]
    ds_read_b128 a[148:151], v29 offset:2048
    v_mfma_f32_16x16x32_bf16 v[132:135], a[172:175], a[180:183], v[132:135]
    buffer_load_dwordx4 v8, s[48:51], s78 offen offset:3072 sc1 lds
    v_mfma_f32_16x16x32_bf16 v[136:139], a[172:175], a[184:187], v[136:139]
    ds_read_b64_tr_b16 a[132:133], v27
    ds_read_b64_tr_b16 a[134:135], v27 offset:5120
    v_mfma_f32_16x16x32_bf16 v[140:143], a[172:175], a[188:191], v[140:143]
    ds_read_b128 a[152:155], v29 offset:3072
    v_mfma_f32_16x16x32_bf16 v[144:147], a[172:175], a[192:195], v[144:147]
    ds_read_b64_tr_b16 a[136:137], v28
    v_mfma_f32_16x16x32_bf16 v[148:151], a[172:175], a[196:199], v[148:151]
    s_add_u32 m0, s76, 126976
    s_nop 0
    buffer_load_dwordx4 v9, s[48:51], s78 offen sc1 lds
    v_mfma_f32_16x16x32_bf16 v[152:155], a[176:179], a[180:183], v[152:155]
    ds_read_b64_tr_b16 a[138:139], v28 offset:5120
    v_mfma_f32_16x16x32_bf16 v[156:159], a[176:179], a[184:187], v[156:159]
    ds_read_b128 a[156:159], v29 offset:4096
    v_mfma_f32_16x16x32_bf16 v[160:163], a[176:179], a[188:191], v[160:163]
    v_mfma_f32_16x16x32_bf16 v[164:167], a[176:179], a[192:195], v[164:167]
    v_mfma_f32_16x16x32_bf16 v[168:171], a[176:179], a[196:199], v[168:171]
    s_waitcnt lgkmcnt(12)
    v_mfma_f32_16x16x32_bf16 v[72:75], a[120:123], a[140:143], v[72:75]
    ds_read_b64_tr_b16 a[160:161], v24 offset:10240
    s_waitcnt lgkmcnt(10)
    v_mfma_f32_16x16x32_bf16 v[76:79], a[120:123], a[144:147], v[76:79]
    ds_read_b64_tr_b16 a[162:163], v24 offset:15360
    s_waitcnt lgkmcnt(8)
    v_mfma_f32_16x16x32_bf16 v[80:83], a[120:123], a[148:151], v[80:83]
    s_add_u32 s77, s65, 163840
    s_add_u32 m0, s75, 81920
    s_nop 0
    buffer_load_dwordx4 v1, s[44:47], s77 offen lds
    s_waitcnt lgkmcnt(5)
    v_mfma_f32_16x16x32_bf16 v[84:87], a[120:123], a[152:155], v[84:87]
    ds_read_b128 a[180:183], v29 offset:10240
    s_waitcnt lgkmcnt(3)
    v_mfma_f32_16x16x32_bf16 v[88:91], a[120:123], a[156:159], v[88:91]
    ds_read_b64_tr_b16 a[164:165], v25 offset:10240
    v_mfma_f32_16x16x32_bf16 v[92:95], a[124:127], a[140:143], v[92:95]
    ds_read_b64_tr_b16 a[166:167], v25 offset:15360
    v_mfma_f32_16x16x32_bf16 v[96:99], a[124:127], a[144:147], v[96:99]
    buffer_load_dwordx4 v3, s[44:47], s77 offen offset:1024 lds
    v_mfma_f32_16x16x32_bf16 v[100:103], a[124:127], a[148:151], v[100:103]
    ds_read_b128 a[184:187], v29 offset:11264
    v_mfma_f32_16x16x32_bf16 v[104:107], a[124:127], a[152:155], v[104:107]
    ds_read_b64_tr_b16 a[168:169], v26 offset:10240
    v_mfma_f32_16x16x32_bf16 v[108:111], a[124:127], a[156:159], v[108:111]
    ds_read_b64_tr_b16 a[170:171], v26 offset:15360
    v_mfma_f32_16x16x32_bf16 v[112:115], a[128:131], a[140:143], v[112:115]
    buffer_load_dwordx4 v4, s[44:47], s77 offen offset:2048 lds
    v_mfma_f32_16x16x32_bf16 v[116:119], a[128:131], a[144:147], v[116:119]
    ds_read_b128 a[188:191], v29 offset:12288
    v_mfma_f32_16x16x32_bf16 v[120:123], a[128:131], a[148:151], v[120:123]
    ds_read_b64_tr_b16 a[172:173], v27 offset:10240
    v_mfma_f32_16x16x32_bf16 v[124:127], a[128:131], a[152:155], v[124:127]
    ds_read_b64_tr_b16 a[174:175], v27 offset:15360
    v_mfma_f32_16x16x32_bf16 v[128:131], a[128:131], a[156:159], v[128:131]
    buffer_load_dwordx4 v6, s[44:47], s77 offen offset:3072 lds
    v_mfma_f32_16x16x32_bf16 v[132:135], a[132:135], a[140:143], v[132:135]
    ds_read_b128 a[192:195], v29 offset:13312
    v_mfma_f32_16x16x32_bf16 v[136:139], a[132:135], a[144:147], v[136:139]
    ds_read_b64_tr_b16 a[176:177], v28 offset:10240
    v_mfma_f32_16x16x32_bf16 v[140:143], a[132:135], a[148:151], v[140:143]
    ds_read_b64_tr_b16 a[178:179], v28 offset:15360
    v_mfma_f32_16x16x32_bf16 v[144:147], a[132:135], a[152:155], v[144:147]
    s_add_u32 m0, s75, 86016
    s_nop 0
    buffer_load_dwordx4 v7, s[44:47], s77 offen lds
    v_mfma_f32_16x16x32_bf16 v[148:151], a[132:135], a[156:159], v[148:151]
    ds_read_b128 a[196:199], v29 offset:14336
    v_mfma_f32_16x16x32_bf16 v[152:155], a[136:139], a[140:143], v[152:155]
    v_mfma_f32_16x16x32_bf16 v[156:159], a[136:139], a[144:147], v[156:159]
    v_mfma_f32_16x16x32_bf16 v[160:163], a[136:139], a[148:151], v[160:163]
    v_mfma_f32_16x16x32_bf16 v[164:167], a[136:139], a[152:155], v[164:167]
    v_mfma_f32_16x16x32_bf16 v[168:171], a[136:139], a[156:159], v[168:171]
    s_waitcnt lgkmcnt(0)
    s_waitcnt vmcnt(5)
    s_barrier
    v_mfma_f32_16x16x32_bf16 v[72:75], a[160:163], a[180:183], v[72:75]
    v_add_u32 v24, 122880, v66
    v_add_u32 v25, 122880, v67
    v_mfma_f32_16x16x32_bf16 v[76:79], a[160:163], a[184:187], v[76:79]
    s_add_u32 s78, s69, 40960
    s_add_u32 m0, s76, 81920
    s_nop 0
    buffer_load_dwordx4 v8, s[48:51], s78 offen sc1 lds
    v_mfma_f32_16x16x32_bf16 v[80:83], a[160:163], a[188:191], v[80:83]
    v_add_u32 v26, 122880, v68
    v_mfma_f32_16x16x32_bf16 v[84:87], a[160:163], a[192:195], v[84:87]
    v_add_u32 v27, 122880, v69
    v_mfma_f32_16x16x32_bf16 v[88:91], a[160:163], a[196:199], v[88:91]
    v_add_u32 v28, 122880, v70
    v_mfma_f32_16x16x32_bf16 v[92:95], a[164:167], a[180:183], v[92:95]
    v_add_u32 v29, 122880, v71
    buffer_load_dwordx4 v8, s[48:51], s78 offen offset:1024 sc1 lds
    v_mfma_f32_16x16x32_bf16 v[96:99], a[164:167], a[184:187], v[96:99]
    ds_read_b64_tr_b16 a[120:121], v24
    v_mfma_f32_16x16x32_bf16 v[100:103], a[164:167], a[188:191], v[100:103]
    ds_read_b64_tr_b16 a[122:123], v24 offset:5120
    v_mfma_f32_16x16x32_bf16 v[104:107], a[164:167], a[192:195], v[104:107]
    ds_read_b128 a[140:143], v29
    v_mfma_f32_16x16x32_bf16 v[108:111], a[164:167], a[196:199], v[108:111]
    ds_read_b64_tr_b16 a[124:125], v25
    v_mfma_f32_16x16x32_bf16 v[112:115], a[168:171], a[180:183], v[112:115]
    ds_read_b64_tr_b16 a[126:127], v25 offset:5120
    v_mfma_f32_16x16x32_bf16 v[116:119], a[168:171], a[184:187], v[116:119]
    buffer_load_dwordx4 v8, s[48:51], s78 offen offset:2048 sc1 lds
    ds_read_b128 a[144:147], v29 offset:1024
    v_mfma_f32_16x16x32_bf16 v[120:123], a[168:171], a[188:191], v[120:123]
    ds_read_b64_tr_b16 a[128:129], v26
    v_mfma_f32_16x16x32_bf16 v[124:127], a[168:171], a[192:195], v[124:127]
    ds_read_b64_tr_b16 a[130:131], v26 offset:5120
    v_mfma_f32_16x16x32_bf16 v[128:131], a[168:171], a[196:199], v[128:131]
    ds_read_b128 a[148:151], v29 offset:2048
    v_mfma_f32_16x16x32_bf16 v[132:135], a[172:175], a[180:183], v[132:135]
    buffer_load_dwordx4 v8, s[48:51], s78 offen offset:3072 sc1 lds
    v_mfma_f32_16x16x32_bf16 v[136:139], a[172:175], a[184:187], v[136:139]
    ds_read_b64_tr_b16 a[132:133], v27
    ds_read_b64_tr_b16 a[134:135], v27 offset:5120
    v_mfma_f32_16x16x32_bf16 v[140:143], a[172:175], a[188:191], v[140:143]
    ds_read_b128 a[152:155], v29 offset:3072
    v_mfma_f32_16x16x32_bf16 v[144:147], a[172:175], a[192:195], v[144:147]
    ds_read_b64_tr_b16 a[136:137], v28
    v_mfma_f32_16x16x32_bf16 v[148:151], a[172:175], a[196:199], v[148:151]
    s_add_u32 m0, s76, 86016
    s_nop 0
    buffer_load_dwordx4 v9, s[48:51], s78 offen sc1 lds
    v_mfma_f32_16x16x32_bf16 v[152:155], a[176:179], a[180:183], v[152:155]
    ds_read_b64_tr_b16 a[138:139], v28 offset:5120
    v_mfma_f32_16x16x32_bf16 v[156:159], a[176:179], a[184:187], v[156:159]
    ds_read_b128 a[156:159], v29 offset:4096
    v_mfma_f32_16x16x32_bf16 v[160:163], a[176:179], a[188:191], v[160:163]
    v_mfma_f32_16x16x32_bf16 v[164:167], a[176:179], a[192:195], v[164:167]
    v_mfma_f32_16x16x32_bf16 v[168:171], a[176:179], a[196:199], v[168:171]
    s_waitcnt lgkmcnt(12)
    v_mfma_f32_16x16x32_bf16 v[72:75], a[120:123], a[140:143], v[72:75]
    ds_read_b64_tr_b16 a[160:161], v24 offset:10240
    s_waitcnt lgkmcnt(10)
    v_mfma_f32_16x16x32_bf16 v[76:79], a[120:123], a[144:147], v[76:79]
    ds_read_b64_tr_b16 a[162:163], v24 offset:15360
    s_waitcnt lgkmcnt(8)
    v_mfma_f32_16x16x32_bf16 v[80:83], a[120:123], a[148:151], v[80:83]
    s_add_u32 s77, s66, 163840
    s_add_u32 m0, s75, 40960
    s_nop 0
    buffer_load_dwordx4 v1, s[44:47], s77 offen lds
    s_waitcnt lgkmcnt(5)
    v_mfma_f32_16x16x32_bf16 v[84:87], a[120:123], a[152:155], v[84:87]
    ds_read_b128 a[180:183], v29 offset:10240
    s_waitcnt lgkmcnt(3)
    v_mfma_f32_16x16x32_bf16 v[88:91], a[120:123], a[156:159], v[88:91]
    ds_read_b64_tr_b16 a[164:165], v25 offset:10240
    v_mfma_f32_16x16x32_bf16 v[92:95], a[124:127], a[140:143], v[92:95]
    ds_read_b64_tr_b16 a[166:167], v25 offset:15360
    v_mfma_f32_16x16x32_bf16 v[96:99], a[124:127], a[144:147], v[96:99]
    buffer_load_dwordx4 v3, s[44:47], s77 offen offset:1024 lds
    v_mfma_f32_16x16x32_bf16 v[100:103], a[124:127], a[148:151], v[100:103]
    ds_read_b128 a[184:187], v29 offset:11264
    v_mfma_f32_16x16x32_bf16 v[104:107], a[124:127], a[152:155], v[104:107]
    ds_read_b64_tr_b16 a[168:169], v26 offset:10240
    v_mfma_f32_16x16x32_bf16 v[108:111], a[124:127], a[156:159], v[108:111]
    ds_read_b64_tr_b16 a[170:171], v26 offset:15360
    v_mfma_f32_16x16x32_bf16 v[112:115], a[128:131], a[140:143], v[112:115]
    buffer_load_dwordx4 v4, s[44:47], s77 offen offset:2048 lds
    v_mfma_f32_16x16x32_bf16 v[116:119], a[128:131], a[144:147], v[116:119]
    ds_read_b128 a[188:191], v29 offset:12288
    v_mfma_f32_16x16x32_bf16 v[120:123], a[128:131], a[148:151], v[120:123]
    ds_read_b64_tr_b16 a[172:173], v27 offset:10240
    v_mfma_f32_16x16x32_bf16 v[124:127], a[128:131], a[152:155], v[124:127]
    ds_read_b64_tr_b16 a[174:175], v27 offset:15360
    v_mfma_f32_16x16x32_bf16 v[128:131], a[128:131], a[156:159], v[128:131]
    buffer_load_dwordx4 v6, s[44:47], s77 offen offset:3072 lds
    v_mfma_f32_16x16x32_bf16 v[132:135], a[132:135], a[140:143], v[132:135]
    ds_read_b128 a[192:195], v29 offset:13312
    v_mfma_f32_16x16x32_bf16 v[136:139], a[132:135], a[144:147], v[136:139]
    ds_read_b64_tr_b16 a[176:177], v28 offset:10240
    v_mfma_f32_16x16x32_bf16 v[140:143], a[132:135], a[148:151], v[140:143]
    ds_read_b64_tr_b16 a[178:179], v28 offset:15360
    v_mfma_f32_16x16x32_bf16 v[144:147], a[132:135], a[152:155], v[144:147]
    s_add_u32 m0, s75, 45056
    s_nop 0
    buffer_load_dwordx4 v7, s[44:47], s77 offen lds
    v_mfma_f32_16x16x32_bf16 v[148:151], a[132:135], a[156:159], v[148:151]
    ds_read_b128 a[196:199], v29 offset:14336
    v_mfma_f32_16x16x32_bf16 v[152:155], a[136:139], a[140:143], v[152:155]
    v_mfma_f32_16x16x32_bf16 v[156:159], a[136:139], a[144:147], v[156:159]
    v_mfma_f32_16x16x32_bf16 v[160:163], a[136:139], a[148:151], v[160:163]
    v_mfma_f32_16x16x32_bf16 v[164:167], a[136:139], a[152:155], v[164:167]
    v_mfma_f32_16x16x32_bf16 v[168:171], a[136:139], a[156:159], v[168:171]
    s_waitcnt lgkmcnt(0)
    s_waitcnt vmcnt(5)
    s_barrier
    v_mfma_f32_16x16x32_bf16 v[72:75], a[160:163], a[180:183], v[72:75]
    v_add_u32 v24, 81920, v66
    v_add_u32 v25, 81920, v67
    v_mfma_f32_16x16x32_bf16 v[76:79], a[160:163], a[184:187], v[76:79]
    s_add_u32 s78, s70, 40960
    s_add_u32 m0, s76, 40960
    s_nop 0
    buffer_load_dwordx4 v8, s[48:51], s78 offen sc1 lds
    v_mfma_f32_16x16x32_bf16 v[80:83], a[160:163], a[188:191], v[80:83]
    v_add_u32 v26, 81920, v68
    v_mfma_f32_16x16x32_bf16 v[84:87], a[160:163], a[192:195], v[84:87]
    v_add_u32 v27, 81920, v69
    v_mfma_f32_16x16x32_bf16 v[88:91], a[160:163], a[196:199], v[88:91]
    v_add_u32 v28, 81920, v70
    v_mfma_f32_16x16x32_bf16 v[92:95], a[164:167], a[180:183], v[92:95]
    v_add_u32 v29, 81920, v71
    buffer_load_dwordx4 v8, s[48:51], s78 offen offset:1024 sc1 lds
    v_mfma_f32_16x16x32_bf16 v[96:99], a[164:167], a[184:187], v[96:99]
    ds_read_b64_tr_b16 a[120:121], v24
    v_mfma_f32_16x16x32_bf16 v[100:103], a[164:167], a[188:191], v[100:103]
    ds_read_b64_tr_b16 a[122:123], v24 offset:5120
    v_mfma_f32_16x16x32_bf16 v[104:107], a[164:167], a[192:195], v[104:107]
    ds_read_b128 a[140:143], v29
    v_mfma_f32_16x16x32_bf16 v[108:111], a[164:167], a[196:199], v[108:111]
    ds_read_b64_tr_b16 a[124:125], v25
    v_mfma_f32_16x16x32_bf16 v[112:115], a[168:171], a[180:183], v[112:115]
    ds_read_b64_tr_b16 a[126:127], v25 offset:5120
    v_mfma_f32_16x16x32_bf16 v[116:119], a[168:171], a[184:187], v[116:119]
    buffer_load_dwordx4 v8, s[48:51], s78 offen offset:2048 sc1 lds
    ds_read_b128 a[144:147], v29 offset:1024
    v_mfma_f32_16x16x32_bf16 v[120:123], a[168:171], a[188:191], v[120:123]
    ds_read_b64_tr_b16 a[128:129], v26
    v_mfma_f32_16x16x32_bf16 v[124:127], a[168:171], a[192:195], v[124:127]
    ds_read_b64_tr_b16 a[130:131], v26 offset:5120
    v_mfma_f32_16x16x32_bf16 v[128:131], a[168:171], a[196:199], v[128:131]
    ds_read_b128 a[148:151], v29 offset:2048
    v_mfma_f32_16x16x32_bf16 v[132:135], a[172:175], a[180:183], v[132:135]
    buffer_load_dwordx4 v8, s[48:51], s78 offen offset:3072 sc1 lds
    v_mfma_f32_16x16x32_bf16 v[136:139], a[172:175], a[184:187], v[136:139]
    ds_read_b64_tr_b16 a[132:133], v27
    ds_read_b64_tr_b16 a[134:135], v27 offset:5120
    v_mfma_f32_16x16x32_bf16 v[140:143], a[172:175], a[188:191], v[140:143]
    ds_read_b128 a[152:155], v29 offset:3072
    v_mfma_f32_16x16x32_bf16 v[144:147], a[172:175], a[192:195], v[144:147]
    ds_read_b64_tr_b16 a[136:137], v28
    v_mfma_f32_16x16x32_bf16 v[148:151], a[172:175], a[196:199], v[148:151]
    s_add_u32 m0, s76, 45056
    s_nop 0
    buffer_load_dwordx4 v9, s[48:51], s78 offen sc1 lds
    v_mfma_f32_16x16x32_bf16 v[152:155], a[176:179], a[180:183], v[152:155]
    ds_read_b64_tr_b16 a[138:139], v28 offset:5120
    v_mfma_f32_16x16x32_bf16 v[156:159], a[176:179], a[184:187], v[156:159]
    ds_read_b128 a[156:159], v29 offset:4096
    v_mfma_f32_16x16x32_bf16 v[160:163], a[176:179], a[188:191], v[160:163]
    v_mfma_f32_16x16x32_bf16 v[164:167], a[176:179], a[192:195], v[164:167]
    v_mfma_f32_16x16x32_bf16 v[168:171], a[176:179], a[196:199], v[168:171]
    s_waitcnt lgkmcnt(12)
    v_mfma_f32_16x16x32_bf16 v[72:75], a[120:123], a[140:143], v[72:75]
    ds_read_b64_tr_b16 a[160:161], v24 offset:10240
    s_waitcnt lgkmcnt(10)
    v_mfma_f32_16x16x32_bf16 v[76:79], a[120:123], a[144:147], v[76:79]
    ds_read_b64_tr_b16 a[162:163], v24 offset:15360
    s_waitcnt lgkmcnt(8)
    v_mfma_f32_16x16x32_bf16 v[80:83], a[120:123], a[148:151], v[80:83]
    s_add_u32 s77, s67, 163840
    s_add_u32 m0, s75, 0
    s_nop 0
    buffer_load_dwordx4 v1, s[44:47], s77 offen lds
    s_waitcnt lgkmcnt(5)
    v_mfma_f32_16x16x32_bf16 v[84:87], a[120:123], a[152:155], v[84:87]
    ds_read_b128 a[180:183], v29 offset:10240
    s_waitcnt lgkmcnt(3)
    v_mfma_f32_16x16x32_bf16 v[88:91], a[120:123], a[156:159], v[88:91]
    ds_read_b64_tr_b16 a[164:165], v25 offset:10240
    v_mfma_f32_16x16x32_bf16 v[92:95], a[124:127], a[140:143], v[92:95]
    ds_read_b64_tr_b16 a[166:167], v25 offset:15360
    v_mfma_f32_16x16x32_bf16 v[96:99], a[124:127], a[144:147], v[96:99]
    buffer_load_dwordx4 v3, s[44:47], s77 offen offset:1024 lds
    v_mfma_f32_16x16x32_bf16 v[100:103], a[124:127], a[148:151], v[100:103]
    ds_read_b128 a[184:187], v29 offset:11264
    v_mfma_f32_16x16x32_bf16 v[104:107], a[124:127], a[152:155], v[104:107]
    ds_read_b64_tr_b16 a[168:169], v26 offset:10240
    v_mfma_f32_16x16x32_bf16 v[108:111], a[124:127], a[156:159], v[108:111]
    ds_read_b64_tr_b16 a[170:171], v26 offset:15360
    v_mfma_f32_16x16x32_bf16 v[112:115], a[128:131], a[140:143], v[112:115]
    buffer_load_dwordx4 v4, s[44:47], s77 offen offset:2048 lds
    v_mfma_f32_16x16x32_bf16 v[116:119], a[128:131], a[144:147], v[116:119]
    ds_read_b128 a[188:191], v29 offset:12288
    v_mfma_f32_16x16x32_bf16 v[120:123], a[128:131], a[148:151], v[120:123]
    ds_read_b64_tr_b16 a[172:173], v27 offset:10240
    v_mfma_f32_16x16x32_bf16 v[124:127], a[128:131], a[152:155], v[124:127]
    ds_read_b64_tr_b16 a[174:175], v27 offset:15360
    v_mfma_f32_16x16x32_bf16 v[128:131], a[128:131], a[156:159], v[128:131]
    buffer_load_dwordx4 v6, s[44:47], s77 offen offset:3072 lds
    v_mfma_f32_16x16x32_bf16 v[132:135], a[132:135], a[140:143], v[132:135]
    ds_read_b128 a[192:195], v29 offset:13312
    v_mfma_f32_16x16x32_bf16 v[136:139], a[132:135], a[144:147], v[136:139]
    ds_read_b64_tr_b16 a[176:177], v28 offset:10240
    v_mfma_f32_16x16x32_bf16 v[140:143], a[132:135], a[148:151], v[140:143]
    ds_read_b64_tr_b16 a[178:179], v28 offset:15360
    v_mfma_f32_16x16x32_bf16 v[144:147], a[132:135], a[152:155], v[144:147]
    s_add_u32 m0, s75, 4096
    s_nop 0
    buffer_load_dwordx4 v7, s[44:47], s77 offen lds
    v_mfma_f32_16x16x32_bf16 v[148:151], a[132:135], a[156:159], v[148:151]
    ds_read_b128 a[196:199], v29 offset:14336
    v_mfma_f32_16x16x32_bf16 v[152:155], a[136:139], a[140:143], v[152:155]
    v_mfma_f32_16x16x32_bf16 v[156:159], a[136:139], a[144:147], v[156:159]
    v_mfma_f32_16x16x32_bf16 v[160:163], a[136:139], a[148:151], v[160:163]
    v_mfma_f32_16x16x32_bf16 v[164:167], a[136:139], a[152:155], v[164:167]
    v_mfma_f32_16x16x32_bf16 v[168:171], a[136:139], a[156:159], v[168:171]
    s_waitcnt lgkmcnt(0)
    s_waitcnt vmcnt(5)
    s_barrier
    v_mfma_f32_16x16x32_bf16 v[72:75], a[160:163], a[180:183], v[72:75]
    v_add_u32 v24, 40960, v66
    v_add_u32 v25, 40960, v67
    v_mfma_f32_16x16x32_bf16 v[76:79], a[160:163], a[184:187], v[76:79]
    s_add_u32 s78, s71, 40960
    s_add_u32 m0, s76, 0
    s_nop 0
    buffer_load_dwordx4 v8, s[48:51], s78 offen sc1 lds
    v_mfma_f32_16x16x32_bf16 v[80:83], a[160:163], a[188:191], v[80:83]
    v_add_u32 v26, 40960, v68
    v_mfma_f32_16x16x32_bf16 v[84:87], a[160:163], a[192:195], v[84:87]
    v_add_u32 v27, 40960, v69
    v_mfma_f32_16x16x32_bf16 v[88:91], a[160:163], a[196:199], v[88:91]
    v_add_u32 v28, 40960, v70
    v_mfma_f32_16x16x32_bf16 v[92:95], a[164:167], a[180:183], v[92:95]
    v_add_u32 v29, 40960, v71
    buffer_load_dwordx4 v8, s[48:51], s78 offen offset:1024 sc1 lds
    v_mfma_f32_16x16x32_bf16 v[96:99], a[164:167], a[184:187], v[96:99]
    ds_read_b64_tr_b16 a[120:121], v24
    v_mfma_f32_16x16x32_bf16 v[100:103], a[164:167], a[188:191], v[100:103]
    ds_read_b64_tr_b16 a[122:123], v24 offset:5120
    v_mfma_f32_16x16x32_bf16 v[104:107], a[164:167], a[192:195], v[104:107]
    ds_read_b128 a[140:143], v29
    v_mfma_f32_16x16x32_bf16 v[108:111], a[164:167], a[196:199], v[108:111]
    ds_read_b64_tr_b16 a[124:125], v25
    v_mfma_f32_16x16x32_bf16 v[112:115], a[168:171], a[180:183], v[112:115]
    ds_read_b64_tr_b16 a[126:127], v25 offset:5120
    v_mfma_f32_16x16x32_bf16 v[116:119], a[168:171], a[184:187], v[116:119]
    buffer_load_dwordx4 v8, s[48:51], s78 offen offset:2048 sc1 lds
    ds_read_b128 a[144:147], v29 offset:1024
    v_mfma_f32_16x16x32_bf16 v[120:123], a[168:171], a[188:191], v[120:123]
    ds_read_b64_tr_b16 a[128:129], v26
    v_mfma_f32_16x16x32_bf16 v[124:127], a[168:171], a[192:195], v[124:127]
    ds_read_b64_tr_b16 a[130:131], v26 offset:5120
    v_mfma_f32_16x16x32_bf16 v[128:131], a[168:171], a[196:199], v[128:131]
    ds_read_b128 a[148:151], v29 offset:2048
    v_mfma_f32_16x16x32_bf16 v[132:135], a[172:175], a[180:183], v[132:135]
    buffer_load_dwordx4 v8, s[48:51], s78 offen offset:3072 sc1 lds
    v_mfma_f32_16x16x32_bf16 v[136:139], a[172:175], a[184:187], v[136:139]
    ds_read_b64_tr_b16 a[132:133], v27
    ds_read_b64_tr_b16 a[134:135], v27 offset:5120
    v_mfma_f32_16x16x32_bf16 v[140:143], a[172:175], a[188:191], v[140:143]
    ds_read_b128 a[152:155], v29 offset:3072
    v_mfma_f32_16x16x32_bf16 v[144:147], a[172:175], a[192:195], v[144:147]
    ds_read_b64_tr_b16 a[136:137], v28
    v_mfma_f32_16x16x32_bf16 v[148:151], a[172:175], a[196:199], v[148:151]
    s_add_u32 m0, s76, 4096
    s_nop 0
    buffer_load_dwordx4 v9, s[48:51], s78 offen sc1 lds
    v_mfma_f32_16x16x32_bf16 v[152:155], a[176:179], a[180:183], v[152:155]
    ds_read_b64_tr_b16 a[138:139], v28 offset:5120
    v_mfma_f32_16x16x32_bf16 v[156:159], a[176:179], a[184:187], v[156:159]
    ds_read_b128 a[156:159], v29 offset:4096
    v_mfma_f32_16x16x32_bf16 v[160:163], a[176:179], a[188:191], v[160:163]
    v_mfma_f32_16x16x32_bf16 v[164:167], a[176:179], a[192:195], v[164:167]
    v_mfma_f32_16x16x32_bf16 v[168:171], a[176:179], a[196:199], v[168:171]
    s_waitcnt lgkmcnt(12)
    v_mfma_f32_16x16x32_bf16 v[72:75], a[120:123], a[140:143], v[72:75]
    ds_read_b64_tr_b16 a[160:161], v24 offset:10240
    s_waitcnt lgkmcnt(10)
    v_mfma_f32_16x16x32_bf16 v[76:79], a[120:123], a[144:147], v[76:79]
    ds_read_b64_tr_b16 a[162:163], v24 offset:15360
    s_waitcnt lgkmcnt(8)
    v_mfma_f32_16x16x32_bf16 v[80:83], a[120:123], a[148:151], v[80:83]
    s_waitcnt lgkmcnt(5)
    v_mfma_f32_16x16x32_bf16 v[84:87], a[120:123], a[152:155], v[84:87]
    ds_read_b128 a[180:183], v29 offset:10240
    s_waitcnt lgkmcnt(3)
    v_mfma_f32_16x16x32_bf16 v[88:91], a[120:123], a[156:159], v[88:91]
    ds_read_b64_tr_b16 a[164:165], v25 offset:10240
    v_mfma_f32_16x16x32_bf16 v[92:95], a[124:127], a[140:143], v[92:95]
    ds_read_b64_tr_b16 a[166:167], v25 offset:15360
    v_mfma_f32_16x16x32_bf16 v[96:99], a[124:127], a[144:147], v[96:99]
    v_mfma_f32_16x16x32_bf16 v[100:103], a[124:127], a[148:151], v[100:103]
    ds_read_b128 a[184:187], v29 offset:11264
    v_mfma_f32_16x16x32_bf16 v[104:107], a[124:127], a[152:155], v[104:107]
    ds_read_b64_tr_b16 a[168:169], v26 offset:10240
    v_mfma_f32_16x16x32_bf16 v[108:111], a[124:127], a[156:159], v[108:111]
    ds_read_b64_tr_b16 a[170:171], v26 offset:15360
    v_mfma_f32_16x16x32_bf16 v[112:115], a[128:131], a[140:143], v[112:115]
    v_mfma_f32_16x16x32_bf16 v[116:119], a[128:131], a[144:147], v[116:119]
    ds_read_b128 a[188:191], v29 offset:12288
    v_mfma_f32_16x16x32_bf16 v[120:123], a[128:131], a[148:151], v[120:123]
    ds_read_b64_tr_b16 a[172:173], v27 offset:10240
    v_mfma_f32_16x16x32_bf16 v[124:127], a[128:131], a[152:155], v[124:127]
    ds_read_b64_tr_b16 a[174:175], v27 offset:15360
    v_mfma_f32_16x16x32_bf16 v[128:131], a[128:131], a[156:159], v[128:131]
    v_mfma_f32_16x16x32_bf16 v[132:135], a[132:135], a[140:143], v[132:135]
    ds_read_b128 a[192:195], v29 offset:13312
    v_mfma_f32_16x16x32_bf16 v[136:139], a[132:135], a[144:147], v[136:139]
    ds_read_b64_tr_b16 a[176:177], v28 offset:10240
    v_mfma_f32_16x16x32_bf16 v[140:143], a[132:135], a[148:151], v[140:143]
    ds_read_b64_tr_b16 a[178:179], v28 offset:15360
    v_mfma_f32_16x16x32_bf16 v[144:147], a[132:135], a[152:155], v[144:147]
    v_mfma_f32_16x16x32_bf16 v[148:151], a[132:135], a[156:159], v[148:151]
    ds_read_b128 a[196:199], v29 offset:14336
    v_mfma_f32_16x16x32_bf16 v[152:155], a[136:139], a[140:143], v[152:155]
    v_mfma_f32_16x16x32_bf16 v[156:159], a[136:139], a[144:147], v[156:159]
    v_mfma_f32_16x16x32_bf16 v[160:163], a[136:139], a[148:151], v[160:163]
    v_mfma_f32_16x16x32_bf16 v[164:167], a[136:139], a[152:155], v[164:167]
    v_mfma_f32_16x16x32_bf16 v[168:171], a[136:139], a[156:159], v[168:171]
    s_waitcnt lgkmcnt(0)
    s_waitcnt vmcnt(0)
    s_barrier
    v_mfma_f32_16x16x32_bf16 v[72:75], a[160:163], a[180:183], v[72:75]
    v_add_u32 v24, 0, v66
    v_add_u32 v25, 0, v67
    v_mfma_f32_16x16x32_bf16 v[76:79], a[160:163], a[184:187], v[76:79]
    v_mfma_f32_16x16x32_bf16 v[80:83], a[160:163], a[188:191], v[80:83]
    v_add_u32 v26, 0, v68
    v_mfma_f32_16x16x32_bf16 v[84:87], a[160:163], a[192:195], v[84:87]
    v_add_u32 v27, 0, v69
    v_mfma_f32_16x16x32_bf16 v[88:91], a[160:163], a[196:199], v[88:91]
    v_add_u32 v28, 0, v70
    v_mfma_f32_16x16x32_bf16 v[92:95], a[164:167], a[180:183], v[92:95]
    v_add_u32 v29, 0, v71
    v_mfma_f32_16x16x32_bf16 v[96:99], a[164:167], a[184:187], v[96:99]
    ds_read_b64_tr_b16 a[120:121], v24
    v_mfma_f32_16x16x32_bf16 v[100:103], a[164:167], a[188:191], v[100:103]
    ds_read_b64_tr_b16 a[122:123], v24 offset:5120
    v_mfma_f32_16x16x32_bf16 v[104:107], a[164:167], a[192:195], v[104:107]
    ds_read_b128 a[140:143], v29
    v_mfma_f32_16x16x32_bf16 v[108:111], a[164:167], a[196:199], v[108:111]
    ds_read_b64_tr_b16 a[124:125], v25
    v_mfma_f32_16x16x32_bf16 v[112:115], a[168:171], a[180:183], v[112:115]
    ds_read_b64_tr_b16 a[126:127], v25 offset:5120
    v_mfma_f32_16x16x32_bf16 v[116:119], a[168:171], a[184:187], v[116:119]
    ds_read_b128 a[144:147], v29 offset:1024
    v_mfma_f32_16x16x32_bf16 v[120:123], a[168:171], a[188:191], v[120:123]
    ds_read_b64_tr_b16 a[128:129], v26
    v_mfma_f32_16x16x32_bf16 v[124:127], a[168:171], a[192:195], v[124:127]
    ds_read_b64_tr_b16 a[130:131], v26 offset:5120
    v_mfma_f32_16x16x32_bf16 v[128:131], a[168:171], a[196:199], v[128:131]
    ds_read_b128 a[148:151], v29 offset:2048
    v_mfma_f32_16x16x32_bf16 v[132:135], a[172:175], a[180:183], v[132:135]
    v_mfma_f32_16x16x32_bf16 v[136:139], a[172:175], a[184:187], v[136:139]
    ds_read_b64_tr_b16 a[132:133], v27
    ds_read_b64_tr_b16 a[134:135], v27 offset:5120
    v_mfma_f32_16x16x32_bf16 v[140:143], a[172:175], a[188:191], v[140:143]
    ds_read_b128 a[152:155], v29 offset:3072
    v_mfma_f32_16x16x32_bf16 v[144:147], a[172:175], a[192:195], v[144:147]
    ds_read_b64_tr_b16 a[136:137], v28
    v_mfma_f32_16x16x32_bf16 v[148:151], a[172:175], a[196:199], v[148:151]
    v_mfma_f32_16x16x32_bf16 v[152:155], a[176:179], a[180:183], v[152:155]
    ds_read_b64_tr_b16 a[138:139], v28 offset:5120
    v_mfma_f32_16x16x32_bf16 v[156:159], a[176:179], a[184:187], v[156:159]
    ds_read_b128 a[156:159], v29 offset:4096
    v_mfma_f32_16x16x32_bf16 v[160:163], a[176:179], a[188:191], v[160:163]
    v_mfma_f32_16x16x32_bf16 v[164:167], a[176:179], a[192:195], v[164:167]
    v_mfma_f32_16x16x32_bf16 v[168:171], a[176:179], a[196:199], v[168:171]
    s_waitcnt lgkmcnt(12)
    v_mfma_f32_16x16x32_bf16 v[72:75], a[120:123], a[140:143], v[72:75]
    ds_read_b64_tr_b16 a[160:161], v24 offset:10240
    s_waitcnt lgkmcnt(10)
    v_mfma_f32_16x16x32_bf16 v[76:79], a[120:123], a[144:147], v[76:79]
    ds_read_b64_tr_b16 a[162:163], v24 offset:15360
    s_waitcnt lgkmcnt(8)
    v_mfma_f32_16x16x32_bf16 v[80:83], a[120:123], a[148:151], v[80:83]
    s_waitcnt lgkmcnt(5)
    v_mfma_f32_16x16x32_bf16 v[84:87], a[120:123], a[152:155], v[84:87]
    ds_read_b128 a[180:183], v29 offset:10240
    s_waitcnt lgkmcnt(3)
    v_mfma_f32_16x16x32_bf16 v[88:91], a[120:123], a[156:159], v[88:91]
    ds_read_b64_tr_b16 a[164:165], v25 offset:10240
    v_mfma_f32_16x16x32_bf16 v[92:95], a[124:127], a[140:143], v[92:95]
    ds_read_b64_tr_b16 a[166:167], v25 offset:15360
    v_mfma_f32_16x16x32_bf16 v[96:99], a[124:127], a[144:147], v[96:99]
    v_mfma_f32_16x16x32_bf16 v[100:103], a[124:127], a[148:151], v[100:103]
    ds_read_b128 a[184:187], v29 offset:11264
    v_mfma_f32_16x16x32_bf16 v[104:107], a[124:127], a[152:155], v[104:107]
    ds_read_b64_tr_b16 a[168:169], v26 offset:10240
    v_mfma_f32_16x16x32_bf16 v[108:111], a[124:127], a[156:159], v[108:111]
    ds_read_b64_tr_b16 a[170:171], v26 offset:15360
    v_mfma_f32_16x16x32_bf16 v[112:115], a[128:131], a[140:143], v[112:115]
    v_mfma_f32_16x16x32_bf16 v[116:119], a[128:131], a[144:147], v[116:119]
    ds_read_b128 a[188:191], v29 offset:12288
    v_mfma_f32_16x16x32_bf16 v[120:123], a[128:131], a[148:151], v[120:123]
    ds_read_b64_tr_b16 a[172:173], v27 offset:10240
    v_mfma_f32_16x16x32_bf16 v[124:127], a[128:131], a[152:155], v[124:127]
    ds_read_b64_tr_b16 a[174:175], v27 offset:15360
    v_mfma_f32_16x16x32_bf16 v[128:131], a[128:131], a[156:159], v[128:131]
    v_mfma_f32_16x16x32_bf16 v[132:135], a[132:135], a[140:143], v[132:135]
    ds_read_b128 a[192:195], v29 offset:13312
    v_mfma_f32_16x16x32_bf16 v[136:139], a[132:135], a[144:147], v[136:139]
    ds_read_b64_tr_b16 a[176:177], v28 offset:10240
    v_mfma_f32_16x16x32_bf16 v[140:143], a[132:135], a[148:151], v[140:143]
    ds_read_b64_tr_b16 a[178:179], v28 offset:15360
    v_mfma_f32_16x16x32_bf16 v[144:147], a[132:135], a[152:155], v[144:147]
    v_mfma_f32_16x16x32_bf16 v[148:151], a[132:135], a[156:159], v[148:151]
    ds_read_b128 a[196:199], v29 offset:14336
    v_mfma_f32_16x16x32_bf16 v[152:155], a[136:139], a[140:143], v[152:155]
    v_mfma_f32_16x16x32_bf16 v[156:159], a[136:139], a[144:147], v[156:159]
    v_mfma_f32_16x16x32_bf16 v[160:163], a[136:139], a[148:151], v[160:163]
    v_mfma_f32_16x16x32_bf16 v[164:167], a[136:139], a[152:155], v[164:167]
    v_mfma_f32_16x16x32_bf16 v[168:171], a[136:139], a[156:159], v[168:171]
    s_waitcnt lgkmcnt(0)
    v_lshlrev_b32 v9, 4, v0
    s_mul_i32 s33, s72, 51200
    s_mul_i32 s3, s28, 12800
    s_add_u32 s33, s33, s3
    v_lshlrev_b32 v10, 3, v0
    v_add_u32 v9, s33, v9
    s_add_u32 s33, s33, 12288
    v_add_u32 v10, s33, v10
    v_mfma_f32_16x16x32_bf16 v[72:75], a[160:163], a[180:183], v[72:75]
    v_mfma_f32_16x16x32_bf16 v[76:79], a[160:163], a[184:187], v[76:79]
    v_mfma_f32_16x16x32_bf16 v[80:83], a[160:163], a[188:191], v[80:83]
    v_mfma_f32_16x16x32_bf16 v[84:87], a[160:163], a[192:195], v[84:87]
    v_mfma_f32_16x16x32_bf16 v[88:91], a[160:163], a[196:199], v[88:91]
    v_mfma_f32_16x16x32_bf16 v[92:95], a[164:167], a[180:183], v[92:95]
    v_mfma_f32_16x16x32_bf16 v[96:99], a[164:167], a[184:187], v[96:99]
    v_mfma_f32_16x16x32_bf16 v[100:103], a[164:167], a[188:191], v[100:103]
    v_mfma_f32_16x16x32_bf16 v[104:107], a[164:167], a[192:195], v[104:107]
    v_mfma_f32_16x16x32_bf16 v[108:111], a[164:167], a[196:199], v[108:111]
    v_mfma_f32_16x16x32_bf16 v[112:115], a[168:171], a[180:183], v[112:115]
    v_cvt_pk_bf16_f32 v40, v72, v73
    v_cvt_pk_bf16_f32 v41, v74, v75
    v_cvt_pk_bf16_f32 v42, v76, v77
    v_cvt_pk_bf16_f32 v43, v78, v79
    buffer_store_dwordx4 v[40:43], v9, s[52:55], 0 offen sc1
    v_mfma_f32_16x16x32_bf16 v[116:119], a[168:171], a[184:187], v[116:119]
    v_mfma_f32_16x16x32_bf16 v[120:123], a[168:171], a[188:191], v[120:123]
    v_cvt_pk_bf16_f32 v44, v80, v81
    v_cvt_pk_bf16_f32 v45, v82, v83
    v_cvt_pk_bf16_f32 v46, v84, v85
    v_cvt_pk_bf16_f32 v47, v86, v87
    buffer_store_dwordx4 v[44:47], v9, s[52:55], 0 offen offset:1024 sc1
    v_mfma_f32_16x16x32_bf16 v[124:127], a[168:171], a[192:195], v[124:127]
    v_mfma_f32_16x16x32_bf16 v[128:131], a[168:171], a[196:199], v[128:131]
    v_cvt_pk_bf16_f32 v48, v88, v89
    v_cvt_pk_bf16_f32 v49, v90, v91
    v_cvt_pk_bf16_f32 v50, v92, v93
    v_cvt_pk_bf16_f32 v51, v94, v95
    buffer_store_dwordx4 v[48:51], v9, s[52:55], 0 offen offset:2048 sc1
    v_mfma_f32_16x16x32_bf16 v[132:135], a[172:175], a[180:183], v[132:135]
    v_mfma_f32_16x16x32_bf16 v[136:139], a[172:175], a[184:187], v[136:139]
    v_cvt_pk_bf16_f32 v40, v96, v97
    v_cvt_pk_bf16_f32 v41, v98, v99
    v_cvt_pk_bf16_f32 v42, v100, v101
    v_cvt_pk_bf16_f32 v43, v102, v103
    buffer_store_dwordx4 v[40:43], v9, s[52:55], 0 offen offset:3072 sc1
    v_mfma_f32_16x16x32_bf16 v[140:143], a[172:175], a[188:191], v[140:143]
    v_mfma_f32_16x16x32_bf16 v[144:147], a[172:175], a[192:195], v[144:147]
    v_cvt_pk_bf16_f32 v44, v104, v105
    v_cvt_pk_bf16_f32 v45, v106, v107
    v_cvt_pk_bf16_f32 v46, v108, v109
    v_cvt_pk_bf16_f32 v47, v110, v111
    v_add_u32 v9, 4096, v9
    buffer_store_dwordx4 v[44:47], v9, s[52:55], 0 offen sc1
    v_mfma_f32_16x16x32_bf16 v[148:151], a[172:175], a[196:199], v[148:151]
    v_mfma_f32_16x16x32_bf16 v[152:155], a[176:179], a[180:183], v[152:155]
    v_cvt_pk_bf16_f32 v48, v112, v113
    v_cvt_pk_bf16_f32 v49, v114, v115
    v_cvt_pk_bf16_f32 v50, v116, v117
    v_cvt_pk_bf16_f32 v51, v118, v119
    buffer_store_dwordx4 v[48:51], v9, s[52:55], 0 offen offset:1024 sc1
    v_mfma_f32_16x16x32_bf16 v[156:159], a[176:179], a[184:187], v[156:159]
    v_mfma_f32_16x16x32_bf16 v[160:163], a[176:179], a[188:191], v[160:163]
    v_cvt_pk_bf16_f32 v40, v120, v121
    v_cvt_pk_bf16_f32 v41, v122, v123
    v_cvt_pk_bf16_f32 v42, v124, v125
    v_cvt_pk_bf16_f32 v43, v126, v127
    buffer_store_dwordx4 v[40:43], v9, s[52:55], 0 offen offset:2048 sc1
    v_mfma_f32_16x16x32_bf16 v[164:167], a[176:179], a[192:195], v[164:167]
    v_mfma_f32_16x16x32_bf16 v[168:171], a[176:179], a[196:199], v[168:171]
    v_cvt_pk_bf16_f32 v44, v128, v129
    v_cvt_pk_bf16_f32 v45, v130, v131
    v_cvt_pk_bf16_f32 v46, v132, v133
    v_cvt_pk_bf16_f32 v47, v134, v135
    buffer_store_dwordx4 v[44:47], v9, s[52:55], 0 offen offset:3072 sc1
    v_cvt_pk_bf16_f32 v48, v136, v137
    v_cvt_pk_bf16_f32 v49, v138, v139
    v_cvt_pk_bf16_f32 v50, v140, v141
    v_cvt_pk_bf16_f32 v51, v142, v143
    v_add_u32 v9, 4096, v9
    buffer_store_dwordx4 v[48:51], v9, s[52:55], 0 offen sc1
    v_cvt_pk_bf16_f32 v40, v144, v145
    v_cvt_pk_bf16_f32 v41, v146, v147
    v_cvt_pk_bf16_f32 v42, v148, v149
    v_cvt_pk_bf16_f32 v43, v150, v151
    buffer_store_dwordx4 v[40:43], v9, s[52:55], 0 offen offset:1024 sc1
    v_cvt_pk_bf16_f32 v44, v152, v153
    v_cvt_pk_bf16_f32 v45, v154, v155
    v_cvt_pk_bf16_f32 v46, v156, v157
    v_cvt_pk_bf16_f32 v47, v158, v159
    buffer_store_dwordx4 v[44:47], v9, s[52:55], 0 offen offset:2048 sc1
    v_cvt_pk_bf16_f32 v48, v160, v161
    v_cvt_pk_bf16_f32 v49, v162, v163
    v_cvt_pk_bf16_f32 v50, v164, v165
    v_cvt_pk_bf16_f32 v51, v166, v167
    buffer_store_dwordx4 v[48:51], v9, s[52:55], 0 offen offset:3072 sc1
    v_cvt_pk_bf16_f32 v52, v168, v169
    v_cvt_pk_bf16_f32 v53, v170, v171
    buffer_store_dwordx2 v[52:53], v10, s[52:55], 0 offen sc1
    s_andn2_b32 s79, s2, 7
    s_lshl_b32 s79, s79, 7
    v_lshlrev_b32 v19, 7, v0
    v_add_u32 v19, s79, v19
    s_waitcnt vmcnt(0)
    s_barrier
    v_mov_b32 v17, 4
    buffer_store_dword v17, v2, s[4:7], 0 offen sc1
    s_lshr_b32 s34, s72, 1
    s_and_b32 s35, s72, 1
    s_mov_b32 s64, 0
    s_mov_b32 s65, 51200
    s_mov_b32 s66, 102400
    s_mov_b32 s67, 153600
    s_mov_b32 s68, 204800
    s_mov_b32 s69, 256000
    s_mov_b32 s70, 307200
    s_mov_b32 s71, 358400
    v_and_b32 v4, 15, v0
    v_mul_u32_u24 v4, 1280, v4
    v_lshrrev_b32 v5, 4, v0
    v_lshl_add_u32 v4, v5, 3, v4
    s_mul_i32 s40, s31, 160
    s_and_b32 s33, s34, 1
    s_mul_i32 s33, s33, 80
    s_add_u32 s40, s40, s33
    s_mul_i32 s40, s40, 1280
    s_mul_i32 s33, s73, 320
    s_add_u32 s40, s40, s33
    s_lshr_b32 s33, s34, 1
    s_mul_i32 s33, s33, 160
    s_add_u32 s40, s40, s33
    s_cmp_eq_u32 s28, 0
    s_cbranch_scc0 RPOLL_DONE
    s_mov_b32 s74, 100000
RPOLL_LOOP:
    buffer_load_dword v16, v19, s[4:7], 0 offen sc1
    s_waitcnt vmcnt(0)
    v_cmp_le_u32 vcc, 4, v16
    s_nop 4
    s_and_b32 s79, vcc_lo, 255
    s_cmp_eq_u32 s79, 255
    s_cbranch_scc1 RPOLL_DONE
    s_sub_u32 s74, s74, 1
    s_cmp_lg_u32 s74, 0
    s_cbranch_scc1 RPOLL_LOOP
RPOLL_DONE:
    s_barrier
    s_mul_i32 s33, s35, 6
    s_add_u32 s33, s33, s28
    s_lshl_b32 s75, s33, 1
    s_lshl_b32 s33, s33, 10
    s_mul_i32 s36, s34, 12800
    s_add_u32 s36, s36, s33
    v_lshlrev_b32 v6, 4, v0
    v_add_u32 v6, s36, v6
    buffer_load_dwordx4 v[72:75], v6, s[52:55], s64 offen sc1
    buffer_load_dwordx4 v[76:79], v6, s[52:55], s65 offen sc1
    buffer_load_dwordx4 v[80:83], v6, s[52:55], s66 offen sc1
    buffer_load_dwordx4 v[84:87], v6, s[52:55], s67 offen sc1
    buffer_load_dwordx4 v[88:91], v6, s[52:55], s68 offen sc1
    buffer_load_dwordx4 v[92:95], v6, s[52:55], s69 offen sc1
    buffer_load_dwordx4 v[96:99], v6, s[52:55], s70 offen sc1
    buffer_load_dwordx4 v[100:103], v6, s[52:55], s71 offen sc1
    s_cmp_lt_u32 s28, 2
    s_cbranch_scc0 RED_NOB
    s_mul_i32 s33, s35, 6
    s_add_u32 s33, s33, s28
    s_add_u32 s33, s33, 4
    s_lshl_b32 s76, s33, 1
    s_lshl_b32 s33, s33, 10
    s_mul_i32 s36, s34, 12800
    s_add_u32 s36, s36, s33
    v_lshlrev_b32 v6, 4, v0
    v_add_u32 v6, s36, v6
    buffer_load_dwordx4 v[104:107], v6, s[52:55], s64 offen sc1
    buffer_load_dwordx4 v[108:111], v6, s[52:55], s65 offen sc1
    buffer_load_dwordx4 v[112:115], v6, s[52:55], s66 offen sc1
    buffer_load_dwordx4 v[116:119], v6, s[52:55], s67 offen sc1
    buffer_load_dwordx4 v[120:123], v6, s[52:55], s68 offen sc1
    buffer_load_dwordx4 v[124:127], v6, s[52:55], s69 offen sc1
    buffer_load_dwordx4 v[128:131], v6, s[52:55], s70 offen sc1
    buffer_load_dwordx4 v[132:135], v6, s[52:55], s71 offen sc1
    s_waitcnt vmcnt(0)
    s_mov_b32 s77, 0x00003f80
    s_mov_b32 s78, 0x3f800000
    v_dot2_f32_bf16 v8, v72, s77, 0
    v_dot2_f32_bf16 v9, v72, s78, 0
    v_dot2_f32_bf16 v10, v73, s77, 0
    v_dot2_f32_bf16 v11, v73, s78, 0
    v_dot2_f32_bf16 v12, v74, s77, 0
    v_dot2_f32_bf16 v13, v74, s78, 0
    v_dot2_f32_bf16 v14, v75, s77, 0
    v_dot2_f32_bf16 v15, v75, s78, 0
    v_dot2_f32_bf16 v8, v76, s77, v8
    v_dot2_f32_bf16 v9, v76, s78, v9
    v_dot2_f32_bf16 v10, v77, s77, v10
    v_dot2_f32_bf16 v11, v77, s78, v11
    v_dot2_f32_bf16 v12, v78, s77, v12
    v_dot2_f32_bf16 v13, v78, s78, v13
    v_dot2_f32_bf16 v14, v79, s77, v14
    v_dot2_f32_bf16 v15, v79, s78, v15
    v_dot2_f32_bf16 v8, v80, s77, v8
    v_dot2_f32_bf16 v9, v80, s78, v9
    v_dot2_f32_bf16 v10, v81, s77, v10
    v_dot2_f32_bf16 v11, v81, s78, v11
    v_dot2_f32_bf16 v12, v82, s77, v12
    v_dot2_f32_bf16 v13, v82, s78, v13
    v_dot2_f32_bf16 v14, v83, s77, v14
    v_dot2_f32_bf16 v15, v83, s78, v15
    v_dot2_f32_bf16 v8, v84, s77, v8
    v_dot2_f32_bf16 v9, v84, s78, v9
    v_dot2_f32_bf16 v10, v85, s77, v10
    v_dot2_f32_bf16 v11, v85, s78, v11
    v_dot2_f32_bf16 v12, v86, s77, v12
    v_dot2_f32_bf16 v13, v86, s78, v13
    v_dot2_f32_bf16 v14, v87, s77, v14
    v_dot2_f32_bf16 v15, v87, s78, v15
    v_dot2_f32_bf16 v8, v88, s77, v8
    v_dot2_f32_bf16 v9, v88, s78, v9
    v_dot2_f32_bf16 v10, v89, s77, v10
    v_dot2_f32_bf16 v11, v89, s78, v11
    v_dot2_f32_bf16 v12, v90, s77, v12
    v_dot2_f32_bf16 v13, v90, s78, v13
    v_dot2_f32_bf16 v14, v91, s77, v14
    v_dot2_f32_bf16 v15, v91, s78, v15
    v_dot2_f32_bf16 v8, v92, s77, v8
    v_dot2_f32_bf16 v9, v92, s78, v9
    v_dot2_f32_bf16 v10, v93, s77, v10
    v_dot2_f32_bf16 v11, v93, s78, v11
    v_dot2_f32_bf16 v12, v94, s77, v12
    v_dot2_f32_bf16 v13, v94, s78, v13
    v_dot2_f32_bf16 v14, v95, s77, v14
    v_dot2_f32_bf16 v15, v95, s78, v15
    v_dot2_f32_bf16 v8, v96, s77, v8
    v_dot2_f32_bf16 v9, v96, s78, v9
    v_dot2_f32_bf16 v10, v97, s77, v10
    v_dot2_f32_bf16 v11, v97, s78, v11
    v_dot2_f32_bf16 v12, v98, s77, v12
    v_dot2_f32_bf16 v13, v98, s78, v13
    v_dot2_f32_bf16 v14, v99, s77, v14
    v_dot2_f32_bf16 v15, v99, s78, v15
    v_dot2_f32_bf16 v8, v100, s77, v8
    v_dot2_f32_bf16 v9, v100, s78, v9
    v_dot2_f32_bf16 v10, v101, s77, v10
    v_dot2_f32_bf16 v11, v101, s78, v11
    v_dot2_f32_bf16 v12, v102, s77, v12
    v_dot2_f32_bf16 v13, v102, s78, v13
    v_dot2_f32_bf16 v14, v103, s77, v14
    v_dot2_f32_bf16 v15, v103, s78, v15
    s_nop 2
    v_cvt_pk_bf16_f32 v18, v8, v9
    v_cvt_pk_bf16_f32 v19, v10, v11
    s_add_u32 s37, s75, 0
    s_mul_i32 s38, s37, 52
    s_lshr_b32 s38, s38, 8
    s_mul_i32 s33, s38, 5
    s_sub_u32 s39, s37, s33
    s_mul_i32 s39, s39, 20480
    s_lshl_b32 s38, s38, 5
    s_add_u32 s39, s39, s38
    s_add_u32 s39, s39, s40
    v_add_u32 v22, s39, v4
    buffer_store_dwordx2 v[18:19], v22, s[56:59], 0 offen
    v_cvt_pk_bf16_f32 v20, v12, v13
    v_cvt_pk_bf16_f32 v21, v14, v15
    s_add_u32 s37, s75, 1
    s_mul_i32 s38, s37, 52
    s_lshr_b32 s38, s38, 8
    s_mul_i32 s33, s38, 5
    s_sub_u32 s39, s37, s33
    s_mul_i32 s39, s39, 20480
    s_lshl_b32 s38, s38, 5
    s_add_u32 s39, s39, s38
    s_add_u32 s39, s39, s40
    v_add_u32 v23, s39, v4
    buffer_store_dwordx2 v[20:21], v23, s[56:59], 0 offen
    s_mov_b32 s77, 0x00003f80
    s_mov_b32 s78, 0x3f800000
    v_dot2_f32_bf16 v8, v104, s77, 0
    v_dot2_f32_bf16 v9, v104, s78, 0
    v_dot2_f32_bf16 v10, v105, s77, 0
    v_dot2_f32_bf16 v11, v105, s78, 0
    v_dot2_f32_bf16 v12, v106, s77, 0
    v_dot2_f32_bf16 v13, v106, s78, 0
    v_dot2_f32_bf16 v14, v107, s77, 0
    v_dot2_f32_bf16 v15, v107, s78, 0
    v_dot2_f32_bf16 v8, v108, s77, v8
    v_dot2_f32_bf16 v9, v108, s78, v9
    v_dot2_f32_bf16 v10, v109, s77, v10
    v_dot2_f32_bf16 v11, v109, s78, v11
    v_dot2_f32_bf16 v12, v110, s77, v12
    v_dot2_f32_bf16 v13, v110, s78, v13
    v_dot2_f32_bf16 v14, v111, s77, v14
    v_dot2_f32_bf16 v15, v111, s78, v15
    v_dot2_f32_bf16 v8, v112, s77, v8
    v_dot2_f32_bf16 v9, v112, s78, v9
    v_dot2_f32_bf16 v10, v113, s77, v10
    v_dot2_f32_bf16 v11, v113, s78, v11
    v_dot2_f32_bf16 v12, v114, s77, v12
    v_dot2_f32_bf16 v13, v114, s78, v13
    v_dot2_f32_bf16 v14, v115, s77, v14
    v_dot2_f32_bf16 v15, v115, s78, v15
    v_dot2_f32_bf16 v8, v116, s77, v8
    v_dot2_f32_bf16 v9, v116, s78, v9
    v_dot2_f32_bf16 v10, v117, s77, v10
    v_dot2_f32_bf16 v11, v117, s78, v11
    v_dot2_f32_bf16 v12, v118, s77, v12
    v_dot2_f32_bf16 v13, v118, s78, v13
    v_dot2_f32_bf16 v14, v119, s77, v14
    v_dot2_f32_bf16 v15, v119, s78, v15
    v_dot2_f32_bf16 v8, v120, s77, v8
    v_dot2_f32_bf16 v9, v120, s78, v9
    v_dot2_f32_bf16 v10, v121, s77, v10
    v_dot2_f32_bf16 v11, v121, s78, v11
    v_dot2_f32_bf16 v12, v122, s77, v12
    v_dot2_f32_bf16 v13, v122, s78, v13
    v_dot2_f32_bf16 v14, v123, s77, v14
    v_dot2_f32_bf16 v15, v123, s78, v15
    v_dot2_f32_bf16 v8, v124, s77, v8
    v_dot2_f32_bf16 v9, v124, s78, v9
    v_dot2_f32_bf16 v10, v125, s77, v10
    v_dot2_f32_bf16 v11, v125, s78, v11
    v_dot2_f32_bf16 v12, v126, s77, v12
    v_dot2_f32_bf16 v13, v126, s78, v13
    v_dot2_f32_bf16 v14, v127, s77, v14
    v_dot2_f32_bf16 v15, v127, s78, v15
    v_dot2_f32_bf16 v8, v128, s77, v8
    v_dot2_f32_bf16 v9, v128, s78, v9
    v_dot2_f32_bf16 v10, v129, s77, v10
    v_dot2_f32_bf16 v11, v129, s78, v11
    v_dot2_f32_bf16 v12, v130, s77, v12
    v_dot2_f32_bf16 v13, v130, s78, v13
    v_dot2_f32_bf16 v14, v131, s77, v14
    v_dot2_f32_bf16 v15, v131, s78, v15
    v_dot2_f32_bf16 v8, v132, s77, v8
    v_dot2_f32_bf16 v9, v132, s78, v9
    v_dot2_f32_bf16 v10, v133, s77, v10
    v_dot2_f32_bf16 v11, v133, s78, v11
    v_dot2_f32_bf16 v12, v134, s77, v12
    v_dot2_f32_bf16 v13, v134, s78, v13
    v_dot2_f32_bf16 v14, v135, s77, v14
    v_dot2_f32_bf16 v15, v135, s78, v15
    s_nop 2
    v_cvt_pk_bf16_f32 v18, v8, v9
    v_cvt_pk_bf16_f32 v19, v10, v11
    s_add_u32 s37, s76, 0
    s_mul_i32 s38, s37, 52
    s_lshr_b32 s38, s38, 8
    s_mul_i32 s33, s38, 5
    s_sub_u32 s39, s37, s33
    s_mul_i32 s39, s39, 20480
    s_lshl_b32 s38, s38, 5
    s_add_u32 s39, s39, s38
    s_add_u32 s39, s39, s40
    v_add_u32 v22, s39, v4
    buffer_store_dwordx2 v[18:19], v22, s[56:59], 0 offen
    v_cvt_pk_bf16_f32 v20, v12, v13
    v_cvt_pk_bf16_f32 v21, v14, v15
    s_add_u32 s37, s76, 1
    s_mul_i32 s38, s37, 52
    s_lshr_b32 s38, s38, 8
    s_mul_i32 s33, s38, 5
    s_sub_u32 s39, s37, s33
    s_mul_i32 s39, s39, 20480
    s_lshl_b32 s38, s38, 5
    s_add_u32 s39, s39, s38
    s_add_u32 s39, s39, s40
    v_add_u32 v23, s39, v4
    buffer_store_dwordx2 v[20:21], v23, s[56:59], 0 offen
    s_branch RED_END
RED_NOB:
    s_cmp_eq_u32 s28, 3
    s_cselect_b32 s77, 1, 0
    s_cmp_eq_u32 s35, 0
    s_cselect_b32 s77, s77, 0
    s_cmp_eq_u32 s77, 1
    s_cbranch_scc0 RED_ONLYA
    s_mov_b32 s76, 24
    s_mul_i32 s36, s34, 12800
    s_add_u32 s36, s36, 12288
    v_lshlrev_b32 v6, 3, v0
    v_add_u32 v6, s36, v6
    buffer_load_dwordx2 v[104:105], v6, s[52:55], s64 offen sc1
    buffer_load_dwordx2 v[108:109], v6, s[52:55], s65 offen sc1
    buffer_load_dwordx2 v[112:113], v6, s[52:55], s66 offen sc1
    buffer_load_dwordx2 v[116:117], v6, s[52:55], s67 offen sc1
    buffer_load_dwordx2 v[120:121], v6, s[52:55], s68 offen sc1
    buffer_load_dwordx2 v[124:125], v6, s[52:55], s69 offen sc1
    buffer_load_dwordx2 v[128:129], v6, s[52:55], s70 offen sc1
    buffer_load_dwordx2 v[132:133], v6, s[52:55], s71 offen sc1
    s_waitcnt vmcnt(0)
    s_mov_b32 s77, 0x00003f80
    s_mov_b32 s78, 0x3f800000
    v_dot2_f32_bf16 v8, v104, s77, 0
    v_dot2_f32_bf16 v9, v104, s78, 0
    v_dot2_f32_bf16 v10, v105, s77, 0
    v_dot2_f32_bf16 v11, v105, s78, 0
    v_dot2_f32_bf16 v8, v108, s77, v8
    v_dot2_f32_bf16 v9, v108, s78, v9
    v_dot2_f32_bf16 v10, v109, s77, v10
    v_dot2_f32_bf16 v11, v109, s78, v11
    v_dot2_f32_bf16 v8, v112, s77, v8
    v_dot2_f32_bf16 v9, v112, s78, v9
    v_dot2_f32_bf16 v10, v113, s77, v10
    v_dot2_f32_bf16 v11, v113, s78, v11
    v_dot2_f32_bf16 v8, v116, s77, v8
    v_dot2_f32_bf16 v9, v116, s78, v9
    v_dot2_f32_bf16 v10, v117, s77, v10
    v_dot2_f32_bf16 v11, v117, s78, v11
    v_dot2_f32_bf16 v8, v120, s77, v8
    v_dot2_f32_bf16 v9, v120, s78, v9
    v_dot2_f32_bf16 v10, v121, s77, v10
    v_dot2_f32_bf16 v11, v121, s78, v11
    v_dot2_f32_bf16 v8, v124, s77, v8
    v_dot2_f32_bf16 v9, v124, s78, v9
    v_dot2_f32_bf16 v10, v125, s77, v10
    v_dot2_f32_bf16 v11, v125, s78, v11
    v_dot2_f32_bf16 v8, v128, s77, v8
    v_dot2_f32_bf16 v9, v128, s78, v9
    v_dot2_f32_bf16 v10, v129, s77, v10
    v_dot2_f32_bf16 v11, v129, s78, v11
    v_dot2_f32_bf16 v8, v132, s77, v8
    v_dot2_f32_bf16 v9, v132, s78, v9
    v_dot2_f32_bf16 v10, v133, s77, v10
    v_dot2_f32_bf16 v11, v133, s78, v11
    s_nop 2
    v_cvt_pk_bf16_f32 v18, v8, v9
    v_cvt_pk_bf16_f32 v19, v10, v11
    s_add_u32 s37, s76, 0
    s_mul_i32 s38, s37, 52
    s_lshr_b32 s38, s38, 8
    s_mul_i32 s33, s38, 5
    s_sub_u32 s39, s37, s33
    s_mul_i32 s39, s39, 20480
    s_lshl_b32 s38, s38, 5
    s_add_u32 s39, s39, s38
    s_add_u32 s39, s39, s40
    v_add_u32 v22, s39, v4
    buffer_store_dwordx2 v[18:19], v22, s[56:59], 0 offen
RED_ONLYA:
    s_waitcnt vmcnt(0)
    s_mov_b32 s77, 0x00003f80
    s_mov_b32 s78, 0x3f800000
    v_dot2_f32_bf16 v8, v72, s77, 0
    v_dot2_f32_bf16 v9, v72, s78, 0
    v_dot2_f32_bf16 v10, v73, s77, 0
    v_dot2_f32_bf16 v11, v73, s78, 0
    v_dot2_f32_bf16 v12, v74, s77, 0
    v_dot2_f32_bf16 v13, v74, s78, 0
    v_dot2_f32_bf16 v14, v75, s77, 0
    v_dot2_f32_bf16 v15, v75, s78, 0
    v_dot2_f32_bf16 v8, v76, s77, v8
    v_dot2_f32_bf16 v9, v76, s78, v9
    v_dot2_f32_bf16 v10, v77, s77, v10
    v_dot2_f32_bf16 v11, v77, s78, v11
    v_dot2_f32_bf16 v12, v78, s77, v12
    v_dot2_f32_bf16 v13, v78, s78, v13
    v_dot2_f32_bf16 v14, v79, s77, v14
    v_dot2_f32_bf16 v15, v79, s78, v15
    v_dot2_f32_bf16 v8, v80, s77, v8
    v_dot2_f32_bf16 v9, v80, s78, v9
    v_dot2_f32_bf16 v10, v81, s77, v10
    v_dot2_f32_bf16 v11, v81, s78, v11
    v_dot2_f32_bf16 v12, v82, s77, v12
    v_dot2_f32_bf16 v13, v82, s78, v13
    v_dot2_f32_bf16 v14, v83, s77, v14
    v_dot2_f32_bf16 v15, v83, s78, v15
    v_dot2_f32_bf16 v8, v84, s77, v8
    v_dot2_f32_bf16 v9, v84, s78, v9
    v_dot2_f32_bf16 v10, v85, s77, v10
    v_dot2_f32_bf16 v11, v85, s78, v11
    v_dot2_f32_bf16 v12, v86, s77, v12
    v_dot2_f32_bf16 v13, v86, s78, v13
    v_dot2_f32_bf16 v14, v87, s77, v14
    v_dot2_f32_bf16 v15, v87, s78, v15
    v_dot2_f32_bf16 v8, v88, s77, v8
    v_dot2_f32_bf16 v9, v88, s78, v9
    v_dot2_f32_bf16 v10, v89, s77, v10
    v_dot2_f32_bf16 v11, v89, s78, v11
    v_dot2_f32_bf16 v12, v90, s77, v12
    v_dot2_f32_bf16 v13, v90, s78, v13
    v_dot2_f32_bf16 v14, v91, s77, v14
    v_dot2_f32_bf16 v15, v91, s78, v15
    v_dot2_f32_bf16 v8, v92, s77, v8
    v_dot2_f32_bf16 v9, v92, s78, v9
    v_dot2_f32_bf16 v10, v93, s77, v10
    v_dot2_f32_bf16 v11, v93, s78, v11
    v_dot2_f32_bf16 v12, v94, s77, v12
    v_dot2_f32_bf16 v13, v94, s78, v13
    v_dot2_f32_bf16 v14, v95, s77, v14
    v_dot2_f32_bf16 v15, v95, s78, v15
    v_dot2_f32_bf16 v8, v96, s77, v8
    v_dot2_f32_bf16 v9, v96, s78, v9
    v_dot2_f32_bf16 v10, v97, s77, v10
    v_dot2_f32_bf16 v11, v97, s78, v11
    v_dot2_f32_bf16 v12, v98, s77, v12
    v_dot2_f32_bf16 v13, v98, s78, v13
    v_dot2_f32_bf16 v14, v99, s77, v14
    v_dot2_f32_bf16 v15, v99, s78, v15
    v_dot2_f32_bf16 v8, v100, s77, v8
    v_dot2_f32_bf16 v9, v100, s78, v9
    v_dot2_f32_bf16 v10, v101, s77, v10
    v_dot2_f32_bf16 v11, v101, s78, v11
    v_dot2_f32_bf16 v12, v102, s77, v12
    v_dot2_f32_bf16 v13, v102, s78, v13
    v_dot2_f32_bf16 v14, v103, s77, v14
    v_dot2_f32_bf16 v15, v103, s78, v15
    s_nop 2
    v_cvt_pk_bf16_f32 v18, v8, v9
    v_cvt_pk_bf16_f32 v19, v10, v11
    s_add_u32 s37, s75, 0
    s_mul_i32 s38, s37, 52
    s_lshr_b32 s38, s38, 8
    s_mul_i32 s33, s38, 5
    s_sub_u32 s39, s37, s33
    s_mul_i32 s39, s39, 20480
    s_lshl_b32 s38, s38, 5
    s_add_u32 s39, s39, s38
    s_add_u32 s39, s39, s40
    v_add_u32 v22, s39, v4
    buffer_store_dwordx2 v[18:19], v22, s[56:59], 0 offen
    v_cvt_pk_bf16_f32 v20, v12, v13
    v_cvt_pk_bf16_f32 v21, v14, v15
    s_add_u32 s37, s75, 1
    s_mul_i32 s38, s37, 52
    s_lshr_b32 s38, s38, 8
    s_mul_i32 s33, s38, 5
    s_sub_u32 s39, s37, s33
    s_mul_i32 s39, s39, 20480
    s_lshl_b32 s38, s38, 5
    s_add_u32 s39, s39, s38
    s_add_u32 s39, s39, s40
    v_add_u32 v23, s39, v4
    buffer_store_dwordx2 v[20:21], v23, s[56:59], 0 offen
RED_END:
K_END:
    s_endpgm
FALLBACK:
    s_waitcnt vmcnt(0) lgkmcnt(0)
    s_barrier
    s_mov_b32 s0, 1
    v_mov_b32 v11, v64
    v_mov_b32 v12, v65
    v_mov_b32 v13, v66
    v_mov_b32 v14, v67
    v_mov_b32 v15, v68
    s_and_b32 s33, s28, 1
    s_lshl_b32 s33, s33, 2
    s_mul_i32 s3, s28, 3072
    v_add_u32 v26, 0, v0
    v_mul_u32_u24 v27, 2731, v26
    v_lshrrev_b32 v27, 16, v27
    v_mul_u32_u24 v24, 24, v27
    v_sub_u32 v28, v26, v24
    v_bfe_u32 v24, v27, 1, 2
    v_or_b32 v24, s33, v24
    v_xor_b32 v24, v24, v28
    v_mul_u32_u24 v25, 384, v27
    v_lshl_add_u32 v24, v24, 4, v25
    v_add_u32 v24, s3, v24
    v_subrev_u32 v2, 0, v24
    v_add_u32 v26, 64, v0
    v_mul_u32_u24 v27, 2731, v26
    v_lshrrev_b32 v27, 16, v27
    v_mul_u32_u24 v24, 24, v27
    v_sub_u32 v28, v26, v24
    v_bfe_u32 v24, v27, 1, 2
    v_or_b32 v24, s33, v24
    v_xor_b32 v24, v24, v28
    v_mul_u32_u24 v25, 384, v27
    v_lshl_add_u32 v24, v24, 4, v25
    v_add_u32 v24, s3, v24
    v_subrev_u32 v3, 1024, v24
    v_add_u32 v26, 128, v0
    v_mul_u32_u24 v27, 2731, v26
    v_lshrrev_b32 v27, 16, v27
    v_mul_u32_u24 v24, 24, v27
    v_sub_u32 v28, v26, v24
    v_bfe_u32 v24, v27, 1, 2
    v_or_b32 v24, s33, v24
    v_xor_b32 v24, v24, v28
    v_mul_u32_u24 v25, 384, v27
    v_lshl_add_u32 v24, v24, 4, v25
    v_add_u32 v24, s3, v24
    v_subrev_u32 v4, 2048, v24
    v_and_b32 v26, 15, v0
    v_lshrrev_b32 v27, 4, v0
    v_lshrrev_b32 v28, 1, v26
    s_lshl_b32 s33, s30, 4
    v_add_u32 v24, s33, v26
    v_mul_u32_u24 v24, 384, v24
    v_xor_b32 v25, v27, v28
    v_lshl_add_u32 v24, v25, 4, v24
    v_add_u32 v9, 135168, v24
    v_xor_b32 v10, 64, v9
    s_mov_b32 s40, 0
    s_add_u32 m0, s36, 135168
    s_nop 0
    buffer_load_dwordx4 v2, s[16:19], s40 offen nt lds
    buffer_load_dwordx4 v3, s[16:19], s40 offen offset:1024 nt lds
    buffer_load_dwordx4 v4, s[16:19], s40 offen offset:2048 nt lds
    s_mov_b32 s40, 12288
    s_add_u32 m0, s36, 147456
    s_nop 0
    buffer_load_dwordx4 v2, s[16:19], s40 offen nt lds
    buffer_load_dwordx4 v3, s[16:19], s40 offen offset:1024 nt lds
    buffer_load_dwordx4 v4, s[16:19], s40 offen offset:2048 nt lds
    s_mov_b32 s40, 24576
    s_add_u32 m0, s36, 0
    s_nop 0
    buffer_load_dwordx4 v2, s[16:19], s40 offen nt lds
    buffer_load_dwordx4 v3, s[16:19], s40 offen offset:1024 nt lds
    buffer_load_dwordx4 v4, s[16:19], s40 offen offset:2048 nt lds
    s_mov_b32 s40, 36864
    s_add_u32 m0, s36, 12288
    s_nop 0
    buffer_load_dwordx4 v2, s[16:19], s40 offen nt lds
    buffer_load_dwordx4 v3, s[16:19], s40 offen offset:1024 nt lds
    buffer_load_dwordx4 v4, s[16:19], s40 offen offset:2048 nt lds
    s_mov_b32 s40, 49152
    s_add_u32 m0, s36, 24576
    s_nop 0
    buffer_load_dwordx4 v2, s[16:19], s40 offen nt lds
    buffer_load_dwordx4 v3, s[16:19], s40 offen offset:1024 nt lds
    buffer_load_dwordx4 v4, s[16:19], s40 offen offset:2048 nt lds
    s_mov_b32 s40, 61440
    s_add_u32 m0, s36, 36864
    s_nop 0
    buffer_load_dwordx4 v2, s[16:19], s40 offen nt lds
    buffer_load_dwordx4 v3, s[16:19], s40 offen offset:1024 nt lds
    s_waitcnt vmcnt(0)
    s_barrier
    ds_read_b128 a[120:123], v9
    ds_read_b128 a[124:127], v10
    ds_read_b128 a[128:131], v9 offset:128
    ds_read_b128 a[132:135], v10 offset:128
    ds_read_b128 a[136:139], v9 offset:256
    ds_read_b128 a[140:143], v10 offset:256
    s_waitcnt lgkmcnt(0)
    s_branch QK_ENTRY
SLOW_I0:
    s_mov_b32 s74, 100000
LOOP_I0:
    v_lshlrev_b32 v16, 6, v0
    buffer_load_dword v16, v16, s[60:63], 0 offen sc1
    s_waitcnt vmcnt(0)
    v_cmp_eq_u32 vcc, 64, v16
    s_nop 4
    s_and_b32 s79, vcc_lo, 15
    s_cmp_eq_u32 s79, 15
    s_cbranch_scc1 BACK_I0
    s_sub_u32 s74, s74, 1
    s_cmp_lg_u32 s74, 0
    s_cbranch_scc1 LOOP_I0
    s_branch BACK_I0
SLOW_P1:
    s_mov_b32 s74, 100000
LOOP_P1:
    buffer_load_dword v16, v19, s[4:7], 0 offen sc1
    s_waitcnt vmcnt(0)
    v_cmp_le_u32 vcc, 1, v16
    s_nop 4
    s_and_b32 s79, vcc_lo, 15
    s_cmp_eq_u32 s79, 15
    s_cbranch_scc1 BACK_P1
    s_sub_u32 s74, s74, 1
    s_cmp_lg_u32 s74, 0
    s_cbranch_scc1 LOOP_P1
    s_branch BACK_P1
SLOW_P2:
    s_mov_b32 s74, 100000
LOOP_P2:
    buffer_load_dword v16, v19, s[4:7], 0 offen sc1
    s_waitcnt vmcnt(0)
    v_cmp_le_u32 vcc, 3, v16
    s_nop 4
    s_and_b32 s79, vcc_lo, 15
    s_cmp_eq_u32 s79, 15
    s_cbranch_scc1 BACK_P2
    s_sub_u32 s74, s74, 1
    s_cmp_lg_u32 s74, 0
    s_cbranch_scc1 LOOP_P2
    s_branch BACK_P2
CODE_END:
    s_endpgm
.section .rodata,"a"
.p2align 6
.amdhsa_kernel standalone__mha_block_cached__near_ridge_kernel
  .amdhsa_next_free_vgpr 512
  .amdhsa_next_free_sgpr 102
  .amdhsa_accum_offset 256
  .amdhsa_group_segment_fixed_size 0
  .amdhsa_kernarg_size 64
  .amdhsa_user_sgpr_count 2
  .amdhsa_user_sgpr_kernarg_segment_ptr 1
  .amdhsa_system_sgpr_workgroup_id_x 1
.end_amdhsa_kernel
```
